```python
import torch

def _softmax(x, axis=-1):
    return torch.softmax(x, dim=axis)

def _gelu(x):
    return torch.nn.functional.gelu(x, approximate='tanh')

def _silu(x):
    return torch.nn.functional.silu(x)

def _sigmoid(x):
    return torch.sigmoid(x)

def _layernorm(x, axis=-1, eps=1e-05):
    m = x.mean(dim=axis, keepdim=True)
    v = x.var(dim=axis, keepdim=True, unbiased=False)
    return (x - m) / torch.sqrt(v + eps)

def _scatter_add(tgt, idx, src, axis=0):
    return tgt.clone().index_add_(axis, idx, src)

def _segment_sum(src, seg, n):
    out = torch.zeros((n,) + src.shape[1:], dtype=src.dtype)
    return out.index_add_(0, seg, src)

def _pad(x, pw):
    flat = tuple((v for pair in reversed(pw) for v in pair))
    return torch.nn.functional.pad(x, flat)
kernel_name = 'interleave_layers__memory_aug_recurrent_mem_tr__swiglu_ffn__prompt'

def setup_inputs():

    _w = lambda a: (lambda t: t.to(torch.bfloat16) if t.is_floating_point() else t)(torch.as_tensor(a))

    def _A_setup():
        B, S, Dm = (1, 2048, 512)
        H, Dh = (32, 128)
        M, seg = (8, 32)
        seg = min(seg, S)
        S = S // seg * seg
        return {'x': _w((lambda *s: torch.randn(*s, dtype=torch.bfloat16) * 0.05)(B, S, Dm)), 'mem0': _w((lambda *s: torch.randn(*s, dtype=torch.bfloat16) * 0.8)(B, M, Dm)), 'Wq': _w((lambda *s: torch.randn(*s, dtype=torch.bfloat16) * 0.8)(Dm, H, Dh) * Dm ** (-0.5)), 'Wk': _w((lambda *s: torch.randn(*s, dtype=torch.bfloat16) * 0.8)(Dm, H, Dh) * Dm ** (-0.5)), 'Wv': _w((lambda *s: torch.randn(*s, dtype=torch.bfloat16) * 0.8)(Dm, H, Dh) * Dm ** (-0.5)), 'Wo': _w((lambda *s: torch.randn(*s, dtype=torch.bfloat16) * 0.8)(H, Dh, Dm) * (H * Dh) ** (-0.5)), 'seg_len': seg}
    _A_in = _A_setup()

    def _B_setup():
        B, S, D, F = (1, 2048, 512, 1792)
        return {'x': _w((lambda *s: torch.randn(*s, dtype=torch.bfloat16) * 0.05)(B, S, D)), 'w_gate': _w((lambda *s: torch.randn(*s, dtype=torch.bfloat16) * 0.05)(D, F)), 'w_up': _w((lambda *s: torch.randn(*s, dtype=torch.bfloat16) * 0.05)(D, F)), 'w_down': _w((lambda *s: torch.randn(*s, dtype=torch.bfloat16) * 0.05)(F, D))}
    _B_in = _B_setup()
    return {'A_x': _A_in['x'], 'A_mem0': _A_in['mem0'], 'A_Wq': _A_in['Wq'], 'A_Wk': _A_in['Wk'], 'A_Wv': _A_in['Wv'], 'A_Wo': _A_in['Wo'], 'A_seg_len': _A_in['seg_len'], 'B_x': _B_in['x'], 'B_w_gate': _B_in['w_gate'], 'B_w_up': _B_in['w_up'], 'B_w_down': _B_in['w_down']}

def reference(A_x, A_mem0, A_Wq, A_Wk, A_Wv, A_Wo, A_seg_len, B_x, B_w_gate, B_w_up, B_w_down):

    def _A_ref(x, mem0, Wq, Wk, Wv, Wo, seg_len):
        B, S, Dm = x.shape
        H, Dh = (Wq.shape[1], Wq.shape[2])
        M = mem0.shape[1]
        scale = Dh ** (-0.5)
        n_seg = S // seg_len
        L = M + seg_len
        idx = torch.arange(L)
        mask = (idx[:, None] < M) | (idx[:, None] >= idx[None, :])
        mem = mem0
        outs = []
        for s in range(n_seg):
            xs = x[:, s * seg_len:(s + 1) * seg_len, :].clone()
            h = torch.concatenate([mem, xs], axis=1)
            q = torch.einsum('btd,dhe->bhte', h, Wq)
            k = torch.einsum('btd,dhe->bhte', h, Wk)
            v = torch.einsum('btd,dhe->bhte', h, Wv)
            scores = torch.einsum('bhqe,bhke->bhqk', q, k) * scale
            scores = torch.where(mask[None, None], scores, -1000000000.0)
            p = _softmax(scores, axis=-1)
            o = torch.einsum('bhqk,bhke->bhqe', p, v)
            o = torch.einsum('bhte,hed->btd', o, Wo)
            mem = o[:, :M, :].clone()
            outs.append(o[:, M:, :])
        return torch.concatenate(outs, axis=1)

    def _B_ref(x, w_gate, w_up, w_down):
        g = _silu(x @ w_gate)
        u = x @ w_up
        return g * u @ w_down
    x = A_x
    x = x + _A_ref(_layernorm(x, axis=-1), A_mem0, A_Wq, A_Wk, A_Wv, A_Wo, A_seg_len)
    x = x + _B_ref(_layernorm(x, axis=-1), B_w_gate, B_w_up, B_w_down)
    x = x + _A_ref(_layernorm(x, axis=-1), A_mem0, A_Wq, A_Wk, A_Wv, A_Wo, A_seg_len)
    x = x + _B_ref(_layernorm(x, axis=-1), B_w_gate, B_w_up, B_w_down)
    return x
```

```asm
; @launch grid=(256,1,1) block=(256,1,1) lds=163840
.amdgcn_target "amdgcn-amd-amdhsa--gfx950"
.text
.globl interleave_layers__memory_aug_recurrent_mem_tr__swiglu_ffn__prompt_kernel
.p2align 8
.type interleave_layers__memory_aug_recurrent_mem_tr__swiglu_ffn__prompt_kernel,@function
interleave_layers__memory_aug_recurrent_mem_tr__swiglu_ffn__prompt_kernel:
  s_cmp_ge_u32 s2, 256
  s_cbranch_scc1 MAIN_END
  s_load_dwordx2 s[4:5], s[0:1], 104
  s_load_dwordx2 s[6:7], s[0:1], 96
  v_lshrrev_b32 v1, 6, v0
  s_getreg_b32 s3, hwreg(HW_REG_XCC_ID)
  v_readfirstlane_b32 s16, v1
  s_and_b32 s3, s3, 15
  s_mov_b32 s19, 400000
  s_waitcnt lgkmcnt(0)
  s_mov_b32 s8, s4
  s_and_b32 s9, s5, 0xffff
  s_mov_b32 s10, 268435456
  s_mov_b32 s11, 0x20000
  s_mov_b32 s12, s6
  s_and_b32 s13, s7, 0xffff
  s_mov_b32 s14, 256
  s_mov_b32 s15, 0x20000
  s_getpc_b64 s[30:31]
PF_BASE:
  v_and_b32 v2, 63, v0
  v_lshlrev_b32 v2, 7, v2
  s_lshl_b32 s32, s16, 13
  v_add_u32 v2, s32, v2
  v_min_u32 v4, TEXT_END-PF_BASE-8, v2
  global_load_dword v3, v4, s[30:31]
  v_add_u32 v2, 0x8000, v2
  v_min_u32 v4, TEXT_END-PF_BASE-8, v2
  global_load_dword v3, v4, s[30:31]
  v_add_u32 v2, 0x8000, v2
  s_load_dwordx2 s[64:65], s[0:1], 0
  v_and_b32 v2, 63, v0
  v_and_b32 v3, 15, v2
  v_lshrrev_b32 v4, 4, v2
  v_lshlrev_b32 v5, 4, v2
  s_waitcnt lgkmcnt(0)
  s_mov_b32 s68, s64
  s_and_b32 s69, s65, 0xffff
  s_mov_b32 s70, 2097152
  s_mov_b32 s71, 0x20000
  s_lshl_b32 s72, s2, 2
  s_add_u32 s72, s72, s16
  s_lshl_b32 s72, s72, 11
  buffer_load_dwordx4 v[104:107], v5, s[68:71], s72 offen offset:0
  buffer_load_dwordx4 v[108:111], v5, s[68:71], s72 offen offset:1024
  s_lshl_b32 s73, s2, 2
  s_add_u32 s73, s73, s16
  s_lshl_b32 s73, s73, 10
  s_add_u32 s73, s73, 22282240
  s_mov_b32 s74, 0
  s_cmp_ge_u32 s73, 24674304
  s_cselect_b32 s75, 1, 0
  s_cmp_lt_u32 s73, 24739840
  s_cselect_b32 s74, s75, 0
  s_cmp_ge_u32 s73, 25165824
  s_cselect_b32 s74, -1, s74
  s_cmp_lt_u32 s73, 26247168
  s_cselect_b32 s75, s73, 268435456
  v_mov_b32 v112, s74
  v_mov_b32 v113, s74
  v_mov_b32 v114, s74
  v_mov_b32 v115, s74
  buffer_store_dwordx4 v[112:115], v5, s[8:11], s75 offen sc1
  s_add_u32 s73, s73, 1048576
  s_mov_b32 s74, 0
  s_cmp_ge_u32 s73, 24674304
  s_cselect_b32 s75, 1, 0
  s_cmp_lt_u32 s73, 24739840
  s_cselect_b32 s74, s75, 0
  s_cmp_ge_u32 s73, 25165824
  s_cselect_b32 s74, -1, s74
  s_cmp_lt_u32 s73, 26247168
  s_cselect_b32 s75, s73, 268435456
  v_mov_b32 v116, s74
  v_mov_b32 v117, s74
  v_mov_b32 v118, s74
  v_mov_b32 v119, s74
  buffer_store_dwordx4 v[116:119], v5, s[8:11], s75 offen sc1
  s_add_u32 s73, s73, 1048576
  s_mov_b32 s74, 0
  s_cmp_ge_u32 s73, 24674304
  s_cselect_b32 s75, 1, 0
  s_cmp_lt_u32 s73, 24739840
  s_cselect_b32 s74, s75, 0
  s_cmp_ge_u32 s73, 25165824
  s_cselect_b32 s74, -1, s74
  s_cmp_lt_u32 s73, 26247168
  s_cselect_b32 s75, s73, 268435456
  v_mov_b32 v112, s74
  v_mov_b32 v113, s74
  v_mov_b32 v114, s74
  v_mov_b32 v115, s74
  buffer_store_dwordx4 v[112:115], v5, s[8:11], s75 offen sc1
  s_add_u32 s73, s73, 1048576
  s_mov_b32 s74, 0
  s_cmp_ge_u32 s73, 24674304
  s_cselect_b32 s75, 1, 0
  s_cmp_lt_u32 s73, 24739840
  s_cselect_b32 s74, s75, 0
  s_cmp_ge_u32 s73, 25165824
  s_cselect_b32 s74, -1, s74
  s_cmp_lt_u32 s73, 26247168
  s_cselect_b32 s75, s73, 268435456
  v_mov_b32 v116, s74
  v_mov_b32 v117, s74
  v_mov_b32 v118, s74
  v_mov_b32 v119, s74
  buffer_store_dwordx4 v[116:119], v5, s[8:11], s75 offen sc1
  s_add_u32 s73, s73, 1048576
  s_mov_b32 s66, 0x05040100
  s_mov_b32 s67, 0x07060302
  s_waitcnt vmcnt(4)
  v_lshlrev_b32 v136, 16, v104
  v_and_b32 v137, 0xffff0000, v104
  v_lshlrev_b32 v138, 16, v105
  v_and_b32 v139, 0xffff0000, v105
  v_lshlrev_b32 v140, 16, v106
  v_and_b32 v141, 0xffff0000, v106
  v_lshlrev_b32 v142, 16, v107
  v_and_b32 v143, 0xffff0000, v107
  v_add_f32 v148, v136, v137
  v_add_f32 v148, v148, v138
  v_add_f32 v148, v148, v139
  v_add_f32 v148, v148, v140
  v_add_f32 v148, v148, v141
  v_add_f32 v148, v148, v142
  v_add_f32 v148, v148, v143
  s_nop 1
  v_add_f32_dpp v148, v148, v148 row_ror:8 row_mask:0xf bank_mask:0xf
  s_nop 1
  v_add_f32_dpp v148, v148, v148 row_ror:4 row_mask:0xf bank_mask:0xf
  s_nop 1
  v_add_f32_dpp v148, v148, v148 row_ror:2 row_mask:0xf bank_mask:0xf
  s_nop 1
  v_add_f32_dpp v148, v148, v148 row_ror:1 row_mask:0xf bank_mask:0xf
  v_mov_b32 v149, v148
  s_nop 1
  v_permlane16_swap_b32 v148, v149
  v_add_f32 v148, v148, v149
  v_mov_b32 v149, v148
  s_nop 1
  v_permlane32_swap_b32 v148, v149
  v_add_f32 v148, v148, v149
  v_mul_f32 v150, 0x3b000000, v148
  v_sub_f32 v149, v136, v150
  v_mul_f32 v151, v149, v149
  v_sub_f32 v149, v137, v150
  v_fmac_f32 v151, v149, v149
  v_sub_f32 v149, v138, v150
  v_fmac_f32 v151, v149, v149
  v_sub_f32 v149, v139, v150
  v_fmac_f32 v151, v149, v149
  v_sub_f32 v149, v140, v150
  v_fmac_f32 v151, v149, v149
  v_sub_f32 v149, v141, v150
  v_fmac_f32 v151, v149, v149
  v_sub_f32 v149, v142, v150
  v_fmac_f32 v151, v149, v149
  v_sub_f32 v149, v143, v150
  v_fmac_f32 v151, v149, v149
  s_nop 1
  v_add_f32_dpp v151, v151, v151 row_ror:8 row_mask:0xf bank_mask:0xf
  s_nop 1
  v_add_f32_dpp v151, v151, v151 row_ror:4 row_mask:0xf bank_mask:0xf
  s_nop 1
  v_add_f32_dpp v151, v151, v151 row_ror:2 row_mask:0xf bank_mask:0xf
  s_nop 1
  v_add_f32_dpp v151, v151, v151 row_ror:1 row_mask:0xf bank_mask:0xf
  v_mov_b32 v149, v151
  s_nop 1
  v_permlane16_swap_b32 v151, v149
  v_add_f32 v151, v151, v149
  v_mov_b32 v149, v151
  s_nop 1
  v_permlane32_swap_b32 v151, v149
  v_add_f32 v151, v151, v149
  v_mul_f32 v151, 0x3b000000, v151
  v_cvt_pk_bf16_f32 v151, v151, v151
  v_lshlrev_b32 v151, 16, v151
  v_add_f32 v151, 0x3727c5ac, v151
  v_cvt_pk_bf16_f32 v151, v151, v151
  v_lshlrev_b32 v151, 16, v151
  v_sqrt_f32 v151, v151
  s_nop 0
  v_cvt_pk_bf16_f32 v151, v151, v151
  v_lshlrev_b32 v151, 16, v151
  v_rcp_f32 v151, v151
  v_cvt_pk_bf16_f32 v150, v150, v150
  v_lshlrev_b32 v150, 16, v150
  v_sub_f32 v136, v136, v150
  v_sub_f32 v137, v137, v150
  v_cvt_pk_bf16_f32 v149, v136, v137
  v_lshlrev_b32 v136, 16, v149
  v_and_b32 v137, 0xffff0000, v149
  v_mul_f32 v136, v136, v151
  v_mul_f32 v137, v137, v151
  v_cvt_pk_bf16_f32 v144, v136, v137
  v_sub_f32 v138, v138, v150
  v_sub_f32 v139, v139, v150
  v_cvt_pk_bf16_f32 v149, v138, v139
  v_lshlrev_b32 v138, 16, v149
  v_and_b32 v139, 0xffff0000, v149
  v_mul_f32 v138, v138, v151
  v_mul_f32 v139, v139, v151
  v_cvt_pk_bf16_f32 v145, v138, v139
  v_sub_f32 v140, v140, v150
  v_sub_f32 v141, v141, v150
  v_cvt_pk_bf16_f32 v149, v140, v141
  v_lshlrev_b32 v140, 16, v149
  v_and_b32 v141, 0xffff0000, v149
  v_mul_f32 v140, v140, v151
  v_mul_f32 v141, v141, v151
  v_cvt_pk_bf16_f32 v146, v140, v141
  v_sub_f32 v142, v142, v150
  v_sub_f32 v143, v143, v150
  v_cvt_pk_bf16_f32 v149, v142, v143
  v_lshlrev_b32 v142, 16, v149
  v_and_b32 v143, 0xffff0000, v149
  v_mul_f32 v142, v142, v151
  v_mul_f32 v143, v143, v151
  v_cvt_pk_bf16_f32 v147, v142, v143
  s_add_u32 s74, s72, 26247168
  buffer_store_dwordx4 v[144:147], v5, s[8:11], s74 offen offset:0 sc1
  v_lshlrev_b32 v136, 16, v108
  v_and_b32 v137, 0xffff0000, v108
  v_lshlrev_b32 v138, 16, v109
  v_and_b32 v139, 0xffff0000, v109
  v_lshlrev_b32 v140, 16, v110
  v_and_b32 v141, 0xffff0000, v110
  v_lshlrev_b32 v142, 16, v111
  v_and_b32 v143, 0xffff0000, v111
  v_add_f32 v148, v136, v137
  v_add_f32 v148, v148, v138
  v_add_f32 v148, v148, v139
  v_add_f32 v148, v148, v140
  v_add_f32 v148, v148, v141
  v_add_f32 v148, v148, v142
  v_add_f32 v148, v148, v143
  s_nop 1
  v_add_f32_dpp v148, v148, v148 row_ror:8 row_mask:0xf bank_mask:0xf
  s_nop 1
  v_add_f32_dpp v148, v148, v148 row_ror:4 row_mask:0xf bank_mask:0xf
  s_nop 1
  v_add_f32_dpp v148, v148, v148 row_ror:2 row_mask:0xf bank_mask:0xf
  s_nop 1
  v_add_f32_dpp v148, v148, v148 row_ror:1 row_mask:0xf bank_mask:0xf
  v_mov_b32 v149, v148
  s_nop 1
  v_permlane16_swap_b32 v148, v149
  v_add_f32 v148, v148, v149
  v_mov_b32 v149, v148
  s_nop 1
  v_permlane32_swap_b32 v148, v149
  v_add_f32 v148, v148, v149
  v_mul_f32 v150, 0x3b000000, v148
  v_sub_f32 v149, v136, v150
  v_mul_f32 v151, v149, v149
  v_sub_f32 v149, v137, v150
  v_fmac_f32 v151, v149, v149
  v_sub_f32 v149, v138, v150
  v_fmac_f32 v151, v149, v149
  v_sub_f32 v149, v139, v150
  v_fmac_f32 v151, v149, v149
  v_sub_f32 v149, v140, v150
  v_fmac_f32 v151, v149, v149
  v_sub_f32 v149, v141, v150
  v_fmac_f32 v151, v149, v149
  v_sub_f32 v149, v142, v150
  v_fmac_f32 v151, v149, v149
  v_sub_f32 v149, v143, v150
  v_fmac_f32 v151, v149, v149
  s_nop 1
  v_add_f32_dpp v151, v151, v151 row_ror:8 row_mask:0xf bank_mask:0xf
  s_nop 1
  v_add_f32_dpp v151, v151, v151 row_ror:4 row_mask:0xf bank_mask:0xf
  s_nop 1
  v_add_f32_dpp v151, v151, v151 row_ror:2 row_mask:0xf bank_mask:0xf
  s_nop 1
  v_add_f32_dpp v151, v151, v151 row_ror:1 row_mask:0xf bank_mask:0xf
  v_mov_b32 v149, v151
  s_nop 1
  v_permlane16_swap_b32 v151, v149
  v_add_f32 v151, v151, v149
  v_mov_b32 v149, v151
  s_nop 1
  v_permlane32_swap_b32 v151, v149
  v_add_f32 v151, v151, v149
  v_mul_f32 v151, 0x3b000000, v151
  v_cvt_pk_bf16_f32 v151, v151, v151
  v_lshlrev_b32 v151, 16, v151
  v_add_f32 v151, 0x3727c5ac, v151
  v_cvt_pk_bf16_f32 v151, v151, v151
  v_lshlrev_b32 v151, 16, v151
  v_sqrt_f32 v151, v151
  s_nop 0
  v_cvt_pk_bf16_f32 v151, v151, v151
  v_lshlrev_b32 v151, 16, v151
  v_rcp_f32 v151, v151
  v_cvt_pk_bf16_f32 v150, v150, v150
  v_lshlrev_b32 v150, 16, v150
  v_sub_f32 v136, v136, v150
  v_sub_f32 v137, v137, v150
  v_cvt_pk_bf16_f32 v149, v136, v137
  v_lshlrev_b32 v136, 16, v149
  v_and_b32 v137, 0xffff0000, v149
  v_mul_f32 v136, v136, v151
  v_mul_f32 v137, v137, v151
  v_cvt_pk_bf16_f32 v144, v136, v137
  v_sub_f32 v138, v138, v150
  v_sub_f32 v139, v139, v150
  v_cvt_pk_bf16_f32 v149, v138, v139
  v_lshlrev_b32 v138, 16, v149
  v_and_b32 v139, 0xffff0000, v149
  v_mul_f32 v138, v138, v151
  v_mul_f32 v139, v139, v151
  v_cvt_pk_bf16_f32 v145, v138, v139
  v_sub_f32 v140, v140, v150
  v_sub_f32 v141, v141, v150
  v_cvt_pk_bf16_f32 v149, v140, v141
  v_lshlrev_b32 v140, 16, v149
  v_and_b32 v141, 0xffff0000, v149
  v_mul_f32 v140, v140, v151
  v_mul_f32 v141, v141, v151
  v_cvt_pk_bf16_f32 v146, v140, v141
  v_sub_f32 v142, v142, v150
  v_sub_f32 v143, v143, v150
  v_cvt_pk_bf16_f32 v149, v142, v143
  v_lshlrev_b32 v142, 16, v149
  v_and_b32 v143, 0xffff0000, v149
  v_mul_f32 v142, v142, v151
  v_mul_f32 v143, v143, v151
  v_cvt_pk_bf16_f32 v147, v142, v143
  s_add_u32 s74, s72, 26247168
  buffer_store_dwordx4 v[144:147], v5, s[8:11], s74 offen offset:1024 sc1
  s_waitcnt vmcnt(0)
  s_barrier
  s_cmp_lg_u32 s16, 0
  s_cbranch_scc1 PRO_NOREG
  s_add_u32 s30, s3, 1
  s_and_b32 s31, s2, 3
  s_lshl_b32 s31, s31, 3
  s_lshl_b32 s30, s30, s31
  s_and_b32 s31, s2, 0xfffffffc
  v_mov_b32 v2, s30
  v_mov_b32 v3, s31
  s_mov_b64 exec, 1
  buffer_atomic_or v2, v3, s[12:15], 0 offen
  s_mov_b64 exec, -1
PRO_NOREG:
  s_lshr_b32 s30, s2, 3
  s_lshl_b32 s31, s3, 5
  s_add_u32 s94, s31, s30
  s_min_u32 s94, s94, 255
  s_lshr_b32 s95, s3, 8
  s_or_b32 s95, s95, 3
DISPATCH:
  s_mov_b32 s45, s94
  s_and_b32 s48, s95, 1
  s_cmp_lt_u32 s45, 64
  s_cbranch_scc0 PRO_W
  s_mov_b32 s17, s45
  s_branch ROLE_CHAIN
PRO_W:
  s_sub_u32 s17, s45, 64
  s_cmp_lt_u32 s17, 64
  s_cbranch_scc1 ROLE_QA
  s_sub_u32 s17, s17, 64
  s_cmp_lt_u32 s17, 64
  s_cbranch_scc0 PRO_F
  s_lshr_b32 s30, s17, 5
  s_and_b32 s31, s17, 31
  s_cmp_lt_u32 s31, 16
  s_cbranch_scc0 PRO_L1
  s_lshl_b32 s17, s30, 4
  s_add_u32 s17, s17, s31
  s_cmp_eq_u32 s48, 1
  s_cbranch_scc1 ROLE_CL
  s_branch ROLE_CG
PRO_L1:
  s_sub_u32 s31, s31, 16
  s_lshl_b32 s31, s31, 1
  s_cmp_lt_u32 s16, 2
  s_cbranch_scc0 PRO_R1
  s_lshl_b32 s17, s30, 5
  s_add_u32 s17, s17, s31
  s_add_u32 s17, s17, s16
  s_cmp_eq_u32 s48, 1
  s_cbranch_scc1 ROLE_BL
  s_branch ROLE_BG
PRO_R1:
  s_lshl_b32 s17, s30, 6
  s_add_u32 s17, s17, s31
  s_add_u32 s17, s17, s16
  s_sub_u32 s17, s17, 2
  s_branch ROLE_R
PRO_F:
  s_sub_u32 s17, s17, 64
  s_lshr_b32 s30, s17, 5
  s_and_b32 s31, s17, 31
  s_cmp_lt_u32 s31, 28
  s_cbranch_scc0 PRO_R2
  s_mul_i32 s17, s30, 28
  s_add_u32 s17, s17, s31
  s_cmp_eq_u32 s48, 1
  s_cbranch_scc1 ROLE_FL
  s_branch ROLE_FG
PRO_R2:
  s_sub_u32 s31, s31, 28
  s_lshl_b32 s31, s31, 2
  s_add_u32 s31, s31, s16
  s_add_u32 s17, s30, 2
  s_lshl_b32 s17, s17, 6
  s_add_u32 s17, s17, s31
  s_branch ROLE_R
ROLE_CHAIN:
  s_lshr_b32 s20, s17, 5
  s_and_b32 s21, s17, 31
  v_and_b32 v14, 63, v0
  v_lshlrev_b32 v1, 4, v14
  s_lshl_b32 s34, s16, 12
  v_add_u32 v2, s34, v1
  v_lshrrev_b32 v15, 4, v14
  v_and_b32 v13, 7, v14
  v_lshlrev_b32 v12, 7, v15
  v_lshl_add_u32 v12, v13, 4, v12
  s_lshl_b32 s34, s16, 11
  v_add_u32 v12, s34, v12
  v_lshrrev_b32 v0, 1, v15
  v_lshlrev_b32 v3, 13, v0
  v_and_b32 v0, 1, v15
  v_lshl_add_u32 v3, v0, 7, v3
  v_lshl_add_u32 v3, v13, 4, v3
  s_lshl_b32 s34, s21, 8
  v_add_u32 v3, s34, v3
  v_lshrrev_b32 v0, 2, v14
  v_lshlrev_b32 v4, 9, v0
  v_and_b32 v0, 3, v14
  v_lshl_add_u32 v4, v0, 4, v4
  s_lshl_b32 s34, s21, 13
  s_lshl_b32 s35, s16, 6
  s_add_u32 s34, s34, s35
  v_add_u32 v4, s34, v4
  v_lshlrev_b32 v5, 4, v0
  v_lshl_add_u32 v5, v15, 3, v5
  s_lshr_b32 s34, s21, 1
  s_lshl_b32 s34, s34, 9
  s_and_b32 s35, s21, 1
  s_lshl_b32 s35, s35, 1
  s_lshr_b32 s36, s16, 1
  s_add_u32 s35, s35, s36
  s_lshl_b32 s35, s35, 7
  s_add_u32 s34, s34, s35
  s_and_b32 s35, s16, 1
  s_lshl_b32 s35, s35, 6
  s_add_u32 s34, s34, s35
  v_add_u32 v5, s34, v5
  s_load_dwordx2 s[38:39], s[0:1], 8
  s_waitcnt lgkmcnt(0)
  s_mov_b32 s12, s38
  s_and_b32 s13, s39, 0xffff
  s_mov_b32 s14, 8192
  s_mov_b32 s15, 0x20000
  v_lshlrev_b32 v0, 10, v13
  v_lshl_add_u32 v0, v15, 4, v0
  s_lshl_b32 s34, s16, 8
  buffer_load_dwordx4 v[72:75], v0, s[12:15], s34 offen offset:0
  buffer_load_dwordx4 v[76:79], v0, s[12:15], s34 offen offset:64
  buffer_load_dwordx4 v[80:83], v0, s[12:15], s34 offen offset:128
  buffer_load_dwordx4 v[84:87], v0, s[12:15], s34 offen offset:192
  s_lshl_b32 s34, s21, 2
  s_add_u32 s34, s34, s16
  s_lshl_b32 s35, s34, 12
  v_add_u32 v6, s35, v1
  s_lshl_b32 s35, s34, 11
  v_add_u32 v7, s35, v1
  v_lshlrev_b32 v8, 3, v14
  s_add_u32 s35, s35, 1024
  v_add_u32 v8, s35, v8
  s_lshl_b32 s35, s34, 6
  v_mov_b32 v9, s35
  s_lshl_b32 s34, s16, 15
  s_add_u32 s34, s34, 32768
  v_add_u32 v10, s34, v1
  s_mul_i32 s34, s16, 3072
  v_add_u32 v11, s34, v1
  s_lshl_b32 s47, s16, 10
  s_add_u32 s47, s47, 28672
  s_add_u32 s34, s16, 1
  s_and_b32 s34, s34, 3
  s_lshl_b32 s44, s34, 12
  s_lshl_b32 s48, s34, 10
  s_add_u32 s48, s48, 28672
  s_add_u32 s34, s16, 2
  s_and_b32 s34, s34, 3
  s_lshl_b32 s45, s34, 12
  s_lshl_b32 s49, s34, 10
  s_add_u32 s49, s49, 28672
  s_add_u32 s34, s16, 3
  s_and_b32 s34, s34, 3
  s_lshl_b32 s46, s34, 12
  s_lshl_b32 s50, s34, 10
  s_add_u32 s50, s50, 28672
  v_lshrrev_b32 v0, 3, v14
  v_and_b32 v0, 1, v0
  v_lshl_add_u32 v120, v0, 10, v1
  s_mov_b32 s22, 0x00ff00ff
  s_mov_b32 s23, 0x00ff00ff
  s_mov_b32 s24, 0x000f000f
  s_mov_b32 s25, 0
  s_mov_b32 s60, 1040356334
  s_mov_b32 s34, -1
  s_mov_b32 s35, 0
  v_mov_b32 v0, 0xf149f2ca
  v_cndmask_b32 v124, v0, 0, s[34:35]
  v_cndmask_b32 v125, v0, 0, s[34:35]
  v_cndmask_b32 v126, v0, 0, s[34:35]
  v_cndmask_b32 v127, v0, 0, s[34:35]
  v_and_b32 v15, 15, v14
  v_and_b32 v0, 1, v15
  v_lshlrev_b32 v0, 4, v0
  v_mov_b32 v123, 0x3f80
  v_lshlrev_b32 v123, v0, v123
  v_lshrrev_b32 v0, 1, v15
  v_cmp_eq_u32 s[26:27], 0, v0
  v_cmp_eq_u32 s[28:29], 1, v0
  v_cmp_eq_u32 s[30:31], 2, v0
  v_cmp_eq_u32 s[32:33], 3, v0
  s_cmp_eq_u32 s20, 0
  s_cbranch_scc1 CH_NOSTAGE_1
  s_call_b64 s[100:101], VERIFY
  s_cbranch_scc1 VER_OK_3
  v_mov_b32 v0, v116
  s_waitcnt vmcnt(0) lgkmcnt(0)
  s_barrier
  s_branch DISPATCH
VER_OK_3:
  v_mbcnt_lo_u32_b32 v116, -1, 0
  v_mbcnt_hi_u32_b32 v116, -1, v116
  v_and_b32 v116, 31, v116
  v_lshlrev_b32 v116, 6, v116
  s_mov_b32 s44, 24805376
CH_GOSPIN_2:
  buffer_load_dword v117, v116, s[8:11], s44 offen sc1
  s_waitcnt vmcnt(0)
  v_cmp_eq_u32 vcc, 0, v117
  s_nop 0
  s_cbranch_vccz CH_NOSTAGE_1
  s_cmp_eq_u32 s19, 0
  s_cbranch_scc1 CH_NOSTAGE_1
  s_sub_u32 s19, s19, 1
  s_sleep 8
  s_branch CH_GOSPIN_2
CH_NOSTAGE_1:
  s_lshl_b32 s41, s16, 15
  s_add_u32 s41, s41, 32768
  v_lshrrev_b32 v100, 4, v14
  v_lshlrev_b32 v100, 3, v100
  v_lshrrev_b32 v102, 2, v14
  v_and_b32 v102, 3, v102
  v_add_u32 v100, v100, v102
  v_lshlrev_b32 v100, 6, v100
  v_and_b32 v102, 3, v14
  v_lshl_add_u32 v100, v102, 4, v100
  v_add_u32 v100, s41, v100
  v_lshrrev_b32 v102, 2, v14
  s_mov_b32 s40, 8192
  v_mul_lo_u32 v102, v102, s40
  v_and_b32 v101, 3, v14
  v_lshl_add_u32 v102, v101, 4, v102
  v_lshrrev_b32 v103, 2, v14
  s_mov_b32 s40, 1024
  v_mul_lo_u32 v103, v103, s40
  v_and_b32 v101, 3, v14
  v_lshl_add_u32 v103, v101, 4, v103
  s_lshl_b32 s44, s21, 8
  s_lshl_b32 s45, s16, 6
  s_add_u32 s44, s44, s45
  s_lshl_b32 s45, s16, 2
  s_lshl_b32 s46, s21, 17
  s_lshl_b32 s47, s16, 8
  s_add_u32 s46, s46, s47
  s_load_dwordx2 s[42:43], s[0:1], 16
  s_waitcnt lgkmcnt(0)
  s_mov_b32 s36, s42
  s_and_b32 s37, s43, 0xffff
  s_mov_b32 s38, 4194304
  s_mov_b32 s39, 0x20000
  s_add_u32 s40, s45, 0
  s_and_b32 s40, s40, 15
  s_lshl_b32 s40, s40, 18
  s_add_u32 s40, s40, s44
  s_add_u32 m0, s41, 0
  s_nop 0
  buffer_load_dwordx4 v102, s[36:39], s40 offen lds
  s_add_u32 s40, s40, 131072
  s_add_u32 m0, s41, 1024
  s_nop 0
  buffer_load_dwordx4 v102, s[36:39], s40 offen lds
  s_add_u32 s40, s45, 1
  s_and_b32 s40, s40, 15
  s_lshl_b32 s40, s40, 18
  s_add_u32 s40, s40, s44
  s_add_u32 m0, s41, 2048
  s_nop 0
  buffer_load_dwordx4 v102, s[36:39], s40 offen lds
  s_add_u32 s40, s40, 131072
  s_add_u32 m0, s41, 3072
  s_nop 0
  buffer_load_dwordx4 v102, s[36:39], s40 offen lds
  s_add_u32 s40, s45, 2
  s_and_b32 s40, s40, 15
  s_lshl_b32 s40, s40, 18
  s_add_u32 s40, s40, s44
  s_add_u32 m0, s41, 4096
  s_nop 0
  buffer_load_dwordx4 v102, s[36:39], s40 offen lds
  s_add_u32 s40, s40, 131072
  s_add_u32 m0, s41, 5120
  s_nop 0
  buffer_load_dwordx4 v102, s[36:39], s40 offen lds
  s_add_u32 s40, s45, 3
  s_and_b32 s40, s40, 15
  s_lshl_b32 s40, s40, 18
  s_add_u32 s40, s40, s44
  s_add_u32 m0, s41, 6144
  s_nop 0
  buffer_load_dwordx4 v102, s[36:39], s40 offen lds
  s_add_u32 s40, s40, 131072
  s_add_u32 m0, s41, 7168
  s_nop 0
  buffer_load_dwordx4 v102, s[36:39], s40 offen lds
  s_add_u32 s40, s45, 4
  s_and_b32 s40, s40, 15
  s_lshl_b32 s40, s40, 18
  s_add_u32 s40, s40, s44
  s_add_u32 m0, s41, 8192
  s_nop 0
  buffer_load_dwordx4 v102, s[36:39], s40 offen lds
  s_add_u32 s40, s40, 131072
  s_add_u32 m0, s41, 9216
  s_nop 0
  buffer_load_dwordx4 v102, s[36:39], s40 offen lds
  s_add_u32 s40, s45, 6
  s_and_b32 s40, s40, 15
  s_lshl_b32 s40, s40, 18
  s_add_u32 s40, s40, s44
  s_add_u32 m0, s41, 10240
  s_nop 0
  buffer_load_dwordx4 v102, s[36:39], s40 offen lds
  s_add_u32 s40, s40, 131072
  s_add_u32 m0, s41, 11264
  s_nop 0
  buffer_load_dwordx4 v102, s[36:39], s40 offen lds
  s_add_u32 s40, s45, 8
  s_and_b32 s40, s40, 15
  s_lshl_b32 s40, s40, 18
  s_add_u32 s40, s40, s44
  s_add_u32 m0, s41, 12288
  s_nop 0
  buffer_load_dwordx4 v102, s[36:39], s40 offen lds
  s_add_u32 s40, s40, 131072
  s_add_u32 m0, s41, 13312
  s_nop 0
  buffer_load_dwordx4 v102, s[36:39], s40 offen lds
  s_add_u32 s40, s45, 10
  s_and_b32 s40, s40, 15
  s_lshl_b32 s40, s40, 18
  s_add_u32 s40, s40, s44
  s_add_u32 m0, s41, 14336
  s_nop 0
  buffer_load_dwordx4 v102, s[36:39], s40 offen lds
  s_add_u32 s40, s40, 131072
  s_add_u32 m0, s41, 15360
  s_nop 0
  buffer_load_dwordx4 v102, s[36:39], s40 offen lds
  s_add_u32 s40, s45, 12
  s_and_b32 s40, s40, 15
  s_lshl_b32 s40, s40, 18
  s_add_u32 s40, s40, s44
  s_add_u32 m0, s41, 16384
  s_nop 0
  buffer_load_dwordx4 v102, s[36:39], s40 offen lds
  s_add_u32 s40, s40, 131072
  s_add_u32 m0, s41, 17408
  s_nop 0
  buffer_load_dwordx4 v102, s[36:39], s40 offen lds
  s_add_u32 s40, s45, 14
  s_and_b32 s40, s40, 15
  s_lshl_b32 s40, s40, 18
  s_add_u32 s40, s40, s44
  s_add_u32 m0, s41, 18432
  s_nop 0
  buffer_load_dwordx4 v102, s[36:39], s40 offen lds
  s_add_u32 s40, s40, 131072
  s_add_u32 m0, s41, 19456
  s_nop 0
  buffer_load_dwordx4 v102, s[36:39], s40 offen lds
  s_load_dwordx2 s[42:43], s[0:1], 24
  s_waitcnt lgkmcnt(0)
  s_mov_b32 s36, s42
  s_and_b32 s37, s43, 0xffff
  s_mov_b32 s38, 4194304
  s_mov_b32 s39, 0x20000
  s_add_u32 s40, s45, 0
  s_and_b32 s40, s40, 15
  s_lshl_b32 s40, s40, 18
  s_add_u32 s40, s40, s44
  s_add_u32 m0, s41, 20480
  s_nop 0
  buffer_load_dwordx4 v102, s[36:39], s40 offen lds
  s_add_u32 s40, s40, 131072
  s_add_u32 m0, s41, 21504
  s_nop 0
  buffer_load_dwordx4 v102, s[36:39], s40 offen lds
  s_add_u32 s40, s45, 1
  s_and_b32 s40, s40, 15
  s_lshl_b32 s40, s40, 18
  s_add_u32 s40, s40, s44
  s_add_u32 m0, s41, 22528
  s_nop 0
  buffer_load_dwordx4 v102, s[36:39], s40 offen lds
  s_add_u32 s40, s40, 131072
  s_add_u32 m0, s41, 23552
  s_nop 0
  buffer_load_dwordx4 v102, s[36:39], s40 offen lds
  s_add_u32 s40, s45, 2
  s_and_b32 s40, s40, 15
  s_lshl_b32 s40, s40, 18
  s_add_u32 s40, s40, s44
  s_add_u32 m0, s41, 24576
  s_nop 0
  buffer_load_dwordx4 v102, s[36:39], s40 offen lds
  s_add_u32 s40, s40, 131072
  s_add_u32 m0, s41, 25600
  s_nop 0
  buffer_load_dwordx4 v102, s[36:39], s40 offen lds
  s_add_u32 s40, s45, 3
  s_and_b32 s40, s40, 15
  s_lshl_b32 s40, s40, 18
  s_add_u32 s40, s40, s44
  s_add_u32 m0, s41, 26624
  s_nop 0
  buffer_load_dwordx4 v102, s[36:39], s40 offen lds
  s_add_u32 s40, s40, 131072
  s_add_u32 m0, s41, 27648
  s_nop 0
  buffer_load_dwordx4 v102, s[36:39], s40 offen lds
  s_add_u32 s40, s45, 4
  s_and_b32 s40, s40, 15
  s_lshl_b32 s40, s40, 18
  s_add_u32 s40, s40, s44
  s_add_u32 m0, s41, 28672
  s_nop 0
  buffer_load_dwordx4 v102, s[36:39], s40 offen lds
  s_add_u32 s40, s40, 131072
  s_add_u32 m0, s41, 29696
  s_nop 0
  buffer_load_dwordx4 v102, s[36:39], s40 offen lds
  s_add_u32 s40, s45, 5
  s_and_b32 s40, s40, 15
  s_lshl_b32 s40, s40, 18
  s_add_u32 s40, s40, s44
  s_add_u32 m0, s41, 30720
  s_nop 0
  buffer_load_dwordx4 v102, s[36:39], s40 offen lds
  s_add_u32 s40, s40, 131072
  s_add_u32 m0, s41, 31744
  s_nop 0
  buffer_load_dwordx4 v102, s[36:39], s40 offen lds
  s_waitcnt vmcnt(16)
  ds_read_b64_tr_b16 v[128:129], v100 offset:0
  ds_read_b64_tr_b16 v[130:131], v100 offset:256
  ds_read_b64_tr_b16 v[132:133], v100 offset:8
  ds_read_b64_tr_b16 v[134:135], v100 offset:264
  ds_read_b64_tr_b16 v[136:137], v100 offset:2048
  ds_read_b64_tr_b16 v[138:139], v100 offset:2304
  ds_read_b64_tr_b16 v[140:141], v100 offset:2056
  ds_read_b64_tr_b16 v[142:143], v100 offset:2312
  s_waitcnt lgkmcnt(4)
  ds_read_b64_tr_b16 v[144:145], v100 offset:4096
  ds_read_b64_tr_b16 v[146:147], v100 offset:4352
  ds_read_b64_tr_b16 v[148:149], v100 offset:4104
  ds_read_b64_tr_b16 v[150:151], v100 offset:4360
  ds_read_b64_tr_b16 v[152:153], v100 offset:6144
  ds_read_b64_tr_b16 v[154:155], v100 offset:6400
  ds_read_b64_tr_b16 v[156:157], v100 offset:6152
  ds_read_b64_tr_b16 v[158:159], v100 offset:6408
  s_waitcnt lgkmcnt(4)
  ds_read_b64_tr_b16 v[160:161], v100 offset:8192
  ds_read_b64_tr_b16 v[162:163], v100 offset:8448
  ds_read_b64_tr_b16 v[164:165], v100 offset:8200
  ds_read_b64_tr_b16 v[166:167], v100 offset:8456
  ds_read_b64_tr_b16 v[168:169], v100 offset:10240
  ds_read_b64_tr_b16 v[170:171], v100 offset:10496
  ds_read_b64_tr_b16 v[172:173], v100 offset:10248
  ds_read_b64_tr_b16 v[174:175], v100 offset:10504
  s_waitcnt lgkmcnt(4)
  ds_read_b64_tr_b16 v[176:177], v100 offset:12288
  ds_read_b64_tr_b16 v[178:179], v100 offset:12544
  ds_read_b64_tr_b16 v[180:181], v100 offset:12296
  ds_read_b64_tr_b16 v[182:183], v100 offset:12552
  ds_read_b64_tr_b16 v[184:185], v100 offset:14336
  ds_read_b64_tr_b16 v[186:187], v100 offset:14592
  ds_read_b64_tr_b16 v[188:189], v100 offset:14344
  ds_read_b64_tr_b16 v[190:191], v100 offset:14600
  s_waitcnt lgkmcnt(4)
  s_waitcnt lgkmcnt(0)
  s_add_u32 s40, s45, 6
  s_and_b32 s40, s40, 15
  s_lshl_b32 s40, s40, 18
  s_add_u32 s40, s40, s44
  s_add_u32 m0, s41, 0
  s_nop 0
  buffer_load_dwordx4 v102, s[36:39], s40 offen lds
  s_add_u32 s40, s40, 131072
  s_add_u32 m0, s41, 1024
  s_nop 0
  buffer_load_dwordx4 v102, s[36:39], s40 offen lds
  s_add_u32 s40, s45, 7
  s_and_b32 s40, s40, 15
  s_lshl_b32 s40, s40, 18
  s_add_u32 s40, s40, s44
  s_add_u32 m0, s41, 2048
  s_nop 0
  buffer_load_dwordx4 v102, s[36:39], s40 offen lds
  s_add_u32 s40, s40, 131072
  s_add_u32 m0, s41, 3072
  s_nop 0
  buffer_load_dwordx4 v102, s[36:39], s40 offen lds
  s_add_u32 s40, s45, 8
  s_and_b32 s40, s40, 15
  s_lshl_b32 s40, s40, 18
  s_add_u32 s40, s40, s44
  s_add_u32 m0, s41, 4096
  s_nop 0
  buffer_load_dwordx4 v102, s[36:39], s40 offen lds
  s_add_u32 s40, s40, 131072
  s_add_u32 m0, s41, 5120
  s_nop 0
  buffer_load_dwordx4 v102, s[36:39], s40 offen lds
  s_add_u32 s40, s45, 9
  s_and_b32 s40, s40, 15
  s_lshl_b32 s40, s40, 18
  s_add_u32 s40, s40, s44
  s_add_u32 m0, s41, 6144
  s_nop 0
  buffer_load_dwordx4 v102, s[36:39], s40 offen lds
  s_add_u32 s40, s40, 131072
  s_add_u32 m0, s41, 7168
  s_nop 0
  buffer_load_dwordx4 v102, s[36:39], s40 offen lds
  s_add_u32 s40, s45, 10
  s_and_b32 s40, s40, 15
  s_lshl_b32 s40, s40, 18
  s_add_u32 s40, s40, s44
  s_add_u32 m0, s41, 8192
  s_nop 0
  buffer_load_dwordx4 v102, s[36:39], s40 offen lds
  s_add_u32 s40, s40, 131072
  s_add_u32 m0, s41, 9216
  s_nop 0
  buffer_load_dwordx4 v102, s[36:39], s40 offen lds
  s_add_u32 s40, s45, 11
  s_and_b32 s40, s40, 15
  s_lshl_b32 s40, s40, 18
  s_add_u32 s40, s40, s44
  s_add_u32 m0, s41, 10240
  s_nop 0
  buffer_load_dwordx4 v102, s[36:39], s40 offen lds
  s_add_u32 s40, s40, 131072
  s_add_u32 m0, s41, 11264
  s_nop 0
  buffer_load_dwordx4 v102, s[36:39], s40 offen lds
  s_add_u32 s40, s45, 12
  s_and_b32 s40, s40, 15
  s_lshl_b32 s40, s40, 18
  s_add_u32 s40, s40, s44
  s_add_u32 m0, s41, 12288
  s_nop 0
  buffer_load_dwordx4 v102, s[36:39], s40 offen lds
  s_add_u32 s40, s40, 131072
  s_add_u32 m0, s41, 13312
  s_nop 0
  buffer_load_dwordx4 v102, s[36:39], s40 offen lds
  s_add_u32 s40, s45, 13
  s_and_b32 s40, s40, 15
  s_lshl_b32 s40, s40, 18
  s_add_u32 s40, s40, s44
  s_add_u32 m0, s41, 14336
  s_nop 0
  buffer_load_dwordx4 v102, s[36:39], s40 offen lds
  s_add_u32 s40, s40, 131072
  s_add_u32 m0, s41, 15360
  s_nop 0
  buffer_load_dwordx4 v102, s[36:39], s40 offen lds
  s_waitcnt vmcnt(16)
  ds_read_b64_tr_b16 v[192:193], v100 offset:16384
  ds_read_b64_tr_b16 v[194:195], v100 offset:16640
  ds_read_b64_tr_b16 v[196:197], v100 offset:16392
  ds_read_b64_tr_b16 v[198:199], v100 offset:16648
  ds_read_b64_tr_b16 v[200:201], v100 offset:18432
  ds_read_b64_tr_b16 v[202:203], v100 offset:18688
  ds_read_b64_tr_b16 v[204:205], v100 offset:18440
  ds_read_b64_tr_b16 v[206:207], v100 offset:18696
  s_waitcnt lgkmcnt(4)
  ds_read_b64_tr_b16 a[0:1], v100 offset:20480
  ds_read_b64_tr_b16 a[2:3], v100 offset:20736
  ds_read_b64_tr_b16 a[64:65], v100 offset:20488
  ds_read_b64_tr_b16 a[66:67], v100 offset:20744
  ds_read_b64_tr_b16 a[4:5], v100 offset:22528
  ds_read_b64_tr_b16 a[6:7], v100 offset:22784
  ds_read_b64_tr_b16 a[68:69], v100 offset:22536
  ds_read_b64_tr_b16 a[70:71], v100 offset:22792
  s_waitcnt lgkmcnt(4)
  ds_read_b64_tr_b16 a[8:9], v100 offset:24576
  ds_read_b64_tr_b16 a[10:11], v100 offset:24832
  ds_read_b64_tr_b16 a[72:73], v100 offset:24584
  ds_read_b64_tr_b16 a[74:75], v100 offset:24840
  ds_read_b64_tr_b16 a[12:13], v100 offset:26624
  ds_read_b64_tr_b16 a[14:15], v100 offset:26880
  ds_read_b64_tr_b16 a[76:77], v100 offset:26632
  ds_read_b64_tr_b16 a[78:79], v100 offset:26888
  s_waitcnt lgkmcnt(4)
  ds_read_b64_tr_b16 a[16:17], v100 offset:28672
  ds_read_b64_tr_b16 a[18:19], v100 offset:28928
  ds_read_b64_tr_b16 a[80:81], v100 offset:28680
  ds_read_b64_tr_b16 a[82:83], v100 offset:28936
  ds_read_b64_tr_b16 a[20:21], v100 offset:30720
  ds_read_b64_tr_b16 a[22:23], v100 offset:30976
  ds_read_b64_tr_b16 a[84:85], v100 offset:30728
  ds_read_b64_tr_b16 a[86:87], v100 offset:30984
  s_waitcnt lgkmcnt(4)
  s_waitcnt lgkmcnt(0)
  s_add_u32 s40, s45, 14
  s_and_b32 s40, s40, 15
  s_lshl_b32 s40, s40, 18
  s_add_u32 s40, s40, s44
  s_add_u32 m0, s41, 16384
  s_nop 0
  buffer_load_dwordx4 v102, s[36:39], s40 offen lds
  s_add_u32 s40, s40, 131072
  s_add_u32 m0, s41, 17408
  s_nop 0
  buffer_load_dwordx4 v102, s[36:39], s40 offen lds
  s_add_u32 s40, s45, 15
  s_and_b32 s40, s40, 15
  s_lshl_b32 s40, s40, 18
  s_add_u32 s40, s40, s44
  s_add_u32 m0, s41, 18432
  s_nop 0
  buffer_load_dwordx4 v102, s[36:39], s40 offen lds
  s_add_u32 s40, s40, 131072
  s_add_u32 m0, s41, 19456
  s_nop 0
  buffer_load_dwordx4 v102, s[36:39], s40 offen lds
  s_load_dwordx2 s[42:43], s[0:1], 32
  s_waitcnt lgkmcnt(0)
  s_mov_b32 s36, s42
  s_and_b32 s37, s43, 0xffff
  s_mov_b32 s38, 4194304
  s_mov_b32 s39, 0x20000
  s_add_u32 s40, s45, 0
  s_and_b32 s40, s40, 15
  s_lshl_b32 s40, s40, 18
  s_add_u32 s40, s40, s44
  s_add_u32 m0, s41, 20480
  s_nop 0
  buffer_load_dwordx4 v102, s[36:39], s40 offen lds
  s_add_u32 s40, s40, 131072
  s_add_u32 m0, s41, 21504
  s_nop 0
  buffer_load_dwordx4 v102, s[36:39], s40 offen lds
  s_add_u32 s40, s45, 1
  s_and_b32 s40, s40, 15
  s_lshl_b32 s40, s40, 18
  s_add_u32 s40, s40, s44
  s_add_u32 m0, s41, 22528
  s_nop 0
  buffer_load_dwordx4 v102, s[36:39], s40 offen lds
  s_add_u32 s40, s40, 131072
  s_add_u32 m0, s41, 23552
  s_nop 0
  buffer_load_dwordx4 v102, s[36:39], s40 offen lds
  s_add_u32 s40, s45, 2
  s_and_b32 s40, s40, 15
  s_lshl_b32 s40, s40, 18
  s_add_u32 s40, s40, s44
  s_add_u32 m0, s41, 24576
  s_nop 0
  buffer_load_dwordx4 v102, s[36:39], s40 offen lds
  s_add_u32 s40, s40, 131072
  s_add_u32 m0, s41, 25600
  s_nop 0
  buffer_load_dwordx4 v102, s[36:39], s40 offen lds
  s_add_u32 s40, s45, 3
  s_and_b32 s40, s40, 15
  s_lshl_b32 s40, s40, 18
  s_add_u32 s40, s40, s44
  s_add_u32 m0, s41, 26624
  s_nop 0
  buffer_load_dwordx4 v102, s[36:39], s40 offen lds
  s_add_u32 s40, s40, 131072
  s_add_u32 m0, s41, 27648
  s_nop 0
  buffer_load_dwordx4 v102, s[36:39], s40 offen lds
  s_add_u32 s40, s45, 4
  s_and_b32 s40, s40, 15
  s_lshl_b32 s40, s40, 18
  s_add_u32 s40, s40, s44
  s_add_u32 m0, s41, 28672
  s_nop 0
  buffer_load_dwordx4 v102, s[36:39], s40 offen lds
  s_add_u32 s40, s40, 131072
  s_add_u32 m0, s41, 29696
  s_nop 0
  buffer_load_dwordx4 v102, s[36:39], s40 offen lds
  s_add_u32 s40, s45, 5
  s_and_b32 s40, s40, 15
  s_lshl_b32 s40, s40, 18
  s_add_u32 s40, s40, s44
  s_add_u32 m0, s41, 30720
  s_nop 0
  buffer_load_dwordx4 v102, s[36:39], s40 offen lds
  s_add_u32 s40, s40, 131072
  s_add_u32 m0, s41, 31744
  s_nop 0
  buffer_load_dwordx4 v102, s[36:39], s40 offen lds
  s_waitcnt vmcnt(16)
  ds_read_b64_tr_b16 a[24:25], v100 offset:0
  ds_read_b64_tr_b16 a[26:27], v100 offset:256
  ds_read_b64_tr_b16 a[88:89], v100 offset:8
  ds_read_b64_tr_b16 a[90:91], v100 offset:264
  ds_read_b64_tr_b16 a[28:29], v100 offset:2048
  ds_read_b64_tr_b16 a[30:31], v100 offset:2304
  ds_read_b64_tr_b16 a[92:93], v100 offset:2056
  ds_read_b64_tr_b16 a[94:95], v100 offset:2312
  s_waitcnt lgkmcnt(4)
  ds_read_b64_tr_b16 a[32:33], v100 offset:4096
  ds_read_b64_tr_b16 a[34:35], v100 offset:4352
  ds_read_b64_tr_b16 a[96:97], v100 offset:4104
  ds_read_b64_tr_b16 a[98:99], v100 offset:4360
  ds_read_b64_tr_b16 a[36:37], v100 offset:6144
  ds_read_b64_tr_b16 a[38:39], v100 offset:6400
  ds_read_b64_tr_b16 a[100:101], v100 offset:6152
  ds_read_b64_tr_b16 a[102:103], v100 offset:6408
  s_waitcnt lgkmcnt(4)
  ds_read_b64_tr_b16 a[40:41], v100 offset:8192
  ds_read_b64_tr_b16 a[42:43], v100 offset:8448
  ds_read_b64_tr_b16 a[104:105], v100 offset:8200
  ds_read_b64_tr_b16 a[106:107], v100 offset:8456
  ds_read_b64_tr_b16 a[44:45], v100 offset:10240
  ds_read_b64_tr_b16 a[46:47], v100 offset:10496
  ds_read_b64_tr_b16 a[108:109], v100 offset:10248
  ds_read_b64_tr_b16 a[110:111], v100 offset:10504
  s_waitcnt lgkmcnt(4)
  ds_read_b64_tr_b16 a[48:49], v100 offset:12288
  ds_read_b64_tr_b16 a[50:51], v100 offset:12544
  ds_read_b64_tr_b16 a[112:113], v100 offset:12296
  ds_read_b64_tr_b16 a[114:115], v100 offset:12552
  ds_read_b64_tr_b16 a[52:53], v100 offset:14336
  ds_read_b64_tr_b16 a[54:55], v100 offset:14592
  ds_read_b64_tr_b16 a[116:117], v100 offset:14344
  ds_read_b64_tr_b16 a[118:119], v100 offset:14600
  s_waitcnt lgkmcnt(4)
  s_waitcnt lgkmcnt(0)
  s_add_u32 s40, s45, 6
  s_and_b32 s40, s40, 15
  s_lshl_b32 s40, s40, 18
  s_add_u32 s40, s40, s44
  s_add_u32 m0, s41, 0
  s_nop 0
  buffer_load_dwordx4 v102, s[36:39], s40 offen lds
  s_add_u32 s40, s40, 131072
  s_add_u32 m0, s41, 1024
  s_nop 0
  buffer_load_dwordx4 v102, s[36:39], s40 offen lds
  s_add_u32 s40, s45, 7
  s_and_b32 s40, s40, 15
  s_lshl_b32 s40, s40, 18
  s_add_u32 s40, s40, s44
  s_add_u32 m0, s41, 2048
  s_nop 0
  buffer_load_dwordx4 v102, s[36:39], s40 offen lds
  s_add_u32 s40, s40, 131072
  s_add_u32 m0, s41, 3072
  s_nop 0
  buffer_load_dwordx4 v102, s[36:39], s40 offen lds
  s_add_u32 s40, s45, 8
  s_and_b32 s40, s40, 15
  s_lshl_b32 s40, s40, 18
  s_add_u32 s40, s40, s44
  s_add_u32 m0, s41, 4096
  s_nop 0
  buffer_load_dwordx4 v102, s[36:39], s40 offen lds
  s_add_u32 s40, s40, 131072
  s_add_u32 m0, s41, 5120
  s_nop 0
  buffer_load_dwordx4 v102, s[36:39], s40 offen lds
  s_add_u32 s40, s45, 9
  s_and_b32 s40, s40, 15
  s_lshl_b32 s40, s40, 18
  s_add_u32 s40, s40, s44
  s_add_u32 m0, s41, 6144
  s_nop 0
  buffer_load_dwordx4 v102, s[36:39], s40 offen lds
  s_add_u32 s40, s40, 131072
  s_add_u32 m0, s41, 7168
  s_nop 0
  buffer_load_dwordx4 v102, s[36:39], s40 offen lds
  s_add_u32 s40, s45, 10
  s_and_b32 s40, s40, 15
  s_lshl_b32 s40, s40, 18
  s_add_u32 s40, s40, s44
  s_add_u32 m0, s41, 8192
  s_nop 0
  buffer_load_dwordx4 v102, s[36:39], s40 offen lds
  s_add_u32 s40, s40, 131072
  s_add_u32 m0, s41, 9216
  s_nop 0
  buffer_load_dwordx4 v102, s[36:39], s40 offen lds
  s_add_u32 s40, s45, 11
  s_and_b32 s40, s40, 15
  s_lshl_b32 s40, s40, 18
  s_add_u32 s40, s40, s44
  s_add_u32 m0, s41, 10240
  s_nop 0
  buffer_load_dwordx4 v102, s[36:39], s40 offen lds
  s_add_u32 s40, s40, 131072
  s_add_u32 m0, s41, 11264
  s_nop 0
  buffer_load_dwordx4 v102, s[36:39], s40 offen lds
  s_add_u32 s40, s45, 12
  s_and_b32 s40, s40, 15
  s_lshl_b32 s40, s40, 18
  s_add_u32 s40, s40, s44
  s_add_u32 m0, s41, 12288
  s_nop 0
  buffer_load_dwordx4 v102, s[36:39], s40 offen lds
  s_add_u32 s40, s40, 131072
  s_add_u32 m0, s41, 13312
  s_nop 0
  buffer_load_dwordx4 v102, s[36:39], s40 offen lds
  s_add_u32 s40, s45, 13
  s_and_b32 s40, s40, 15
  s_lshl_b32 s40, s40, 18
  s_add_u32 s40, s40, s44
  s_add_u32 m0, s41, 14336
  s_nop 0
  buffer_load_dwordx4 v102, s[36:39], s40 offen lds
  s_add_u32 s40, s40, 131072
  s_add_u32 m0, s41, 15360
  s_nop 0
  buffer_load_dwordx4 v102, s[36:39], s40 offen lds
  s_waitcnt vmcnt(16)
  ds_read_b64_tr_b16 a[56:57], v100 offset:16384
  ds_read_b64_tr_b16 a[58:59], v100 offset:16640
  ds_read_b64_tr_b16 a[120:121], v100 offset:16392
  ds_read_b64_tr_b16 a[122:123], v100 offset:16648
  ds_read_b64_tr_b16 a[60:61], v100 offset:18432
  ds_read_b64_tr_b16 a[62:63], v100 offset:18688
  ds_read_b64_tr_b16 a[124:125], v100 offset:18440
  ds_read_b64_tr_b16 a[126:127], v100 offset:18696
  s_waitcnt lgkmcnt(4)
  ds_read_b64_tr_b16 a[128:129], v100 offset:20480
  ds_read_b64_tr_b16 a[130:131], v100 offset:20736
  ds_read_b64_tr_b16 a[192:193], v100 offset:20488
  ds_read_b64_tr_b16 a[194:195], v100 offset:20744
  ds_read_b64_tr_b16 a[132:133], v100 offset:22528
  ds_read_b64_tr_b16 a[134:135], v100 offset:22784
  ds_read_b64_tr_b16 a[196:197], v100 offset:22536
  ds_read_b64_tr_b16 a[198:199], v100 offset:22792
  s_waitcnt lgkmcnt(4)
  ds_read_b64_tr_b16 a[136:137], v100 offset:24576
  ds_read_b64_tr_b16 a[138:139], v100 offset:24832
  ds_read_b64_tr_b16 a[200:201], v100 offset:24584
  ds_read_b64_tr_b16 a[202:203], v100 offset:24840
  ds_read_b64_tr_b16 a[140:141], v100 offset:26624
  ds_read_b64_tr_b16 a[142:143], v100 offset:26880
  ds_read_b64_tr_b16 a[204:205], v100 offset:26632
  ds_read_b64_tr_b16 a[206:207], v100 offset:26888
  s_waitcnt lgkmcnt(4)
  ds_read_b64_tr_b16 a[144:145], v100 offset:28672
  ds_read_b64_tr_b16 a[146:147], v100 offset:28928
  ds_read_b64_tr_b16 a[208:209], v100 offset:28680
  ds_read_b64_tr_b16 a[210:211], v100 offset:28936
  ds_read_b64_tr_b16 a[148:149], v100 offset:30720
  ds_read_b64_tr_b16 a[150:151], v100 offset:30976
  ds_read_b64_tr_b16 a[212:213], v100 offset:30728
  ds_read_b64_tr_b16 a[214:215], v100 offset:30984
  s_waitcnt lgkmcnt(4)
  s_waitcnt lgkmcnt(0)
  s_add_u32 s40, s45, 14
  s_and_b32 s40, s40, 15
  s_lshl_b32 s40, s40, 18
  s_add_u32 s40, s40, s44
  s_add_u32 m0, s41, 16384
  s_nop 0
  buffer_load_dwordx4 v102, s[36:39], s40 offen lds
  s_add_u32 s40, s40, 131072
  s_add_u32 m0, s41, 17408
  s_nop 0
  buffer_load_dwordx4 v102, s[36:39], s40 offen lds
  s_add_u32 s40, s45, 15
  s_and_b32 s40, s40, 15
  s_lshl_b32 s40, s40, 18
  s_add_u32 s40, s40, s44
  s_add_u32 m0, s41, 18432
  s_nop 0
  buffer_load_dwordx4 v102, s[36:39], s40 offen lds
  s_add_u32 s40, s40, 131072
  s_add_u32 m0, s41, 19456
  s_nop 0
  buffer_load_dwordx4 v102, s[36:39], s40 offen lds
  s_load_dwordx2 s[42:43], s[0:1], 40
  s_waitcnt lgkmcnt(0)
  s_mov_b32 s36, s42
  s_and_b32 s37, s43, 0xffff
  s_mov_b32 s38, 4194304
  s_mov_b32 s39, 0x20000
  s_add_u32 s40, s16, 0
  s_and_b32 s40, s40, 3
  s_lshl_b32 s40, s40, 15
  s_add_u32 s40, s40, s46
  s_add_u32 s40, s40, 0
  s_add_u32 m0, s41, 20480
  s_nop 0
  buffer_load_dwordx4 v103, s[36:39], s40 offen lds
  s_add_u32 s40, s40, 16384
  s_add_u32 m0, s41, 21504
  s_nop 0
  buffer_load_dwordx4 v103, s[36:39], s40 offen lds
  s_add_u32 s40, s16, 0
  s_and_b32 s40, s40, 3
  s_lshl_b32 s40, s40, 15
  s_add_u32 s40, s40, s46
  s_add_u32 s40, s40, 64
  s_add_u32 m0, s41, 22528
  s_nop 0
  buffer_load_dwordx4 v103, s[36:39], s40 offen lds
  s_add_u32 s40, s40, 16384
  s_add_u32 m0, s41, 23552
  s_nop 0
  buffer_load_dwordx4 v103, s[36:39], s40 offen lds
  s_add_u32 s40, s16, 0
  s_and_b32 s40, s40, 3
  s_lshl_b32 s40, s40, 15
  s_add_u32 s40, s40, s46
  s_add_u32 s40, s40, 128
  s_add_u32 m0, s41, 24576
  s_nop 0
  buffer_load_dwordx4 v103, s[36:39], s40 offen lds
  s_add_u32 s40, s40, 16384
  s_add_u32 m0, s41, 25600
  s_nop 0
  buffer_load_dwordx4 v103, s[36:39], s40 offen lds
  s_add_u32 s40, s16, 0
  s_and_b32 s40, s40, 3
  s_lshl_b32 s40, s40, 15
  s_add_u32 s40, s40, s46
  s_add_u32 s40, s40, 192
  s_add_u32 m0, s41, 26624
  s_nop 0
  buffer_load_dwordx4 v103, s[36:39], s40 offen lds
  s_add_u32 s40, s40, 16384
  s_add_u32 m0, s41, 27648
  s_nop 0
  buffer_load_dwordx4 v103, s[36:39], s40 offen lds
  s_add_u32 s40, s16, 1
  s_and_b32 s40, s40, 3
  s_lshl_b32 s40, s40, 15
  s_add_u32 s40, s40, s46
  s_add_u32 s40, s40, 0
  s_add_u32 m0, s41, 28672
  s_nop 0
  buffer_load_dwordx4 v103, s[36:39], s40 offen lds
  s_add_u32 s40, s40, 16384
  s_add_u32 m0, s41, 29696
  s_nop 0
  buffer_load_dwordx4 v103, s[36:39], s40 offen lds
  s_add_u32 s40, s16, 2
  s_and_b32 s40, s40, 3
  s_lshl_b32 s40, s40, 15
  s_add_u32 s40, s40, s46
  s_add_u32 s40, s40, 0
  s_add_u32 m0, s41, 30720
  s_nop 0
  buffer_load_dwordx4 v103, s[36:39], s40 offen lds
  s_add_u32 s40, s40, 16384
  s_add_u32 m0, s41, 31744
  s_nop 0
  buffer_load_dwordx4 v103, s[36:39], s40 offen lds
  s_waitcnt vmcnt(16)
  ds_read_b64_tr_b16 a[152:153], v100 offset:0
  ds_read_b64_tr_b16 a[154:155], v100 offset:256
  ds_read_b64_tr_b16 a[216:217], v100 offset:8
  ds_read_b64_tr_b16 a[218:219], v100 offset:264
  ds_read_b64_tr_b16 a[156:157], v100 offset:2048
  ds_read_b64_tr_b16 a[158:159], v100 offset:2304
  ds_read_b64_tr_b16 a[220:221], v100 offset:2056
  ds_read_b64_tr_b16 a[222:223], v100 offset:2312
  s_waitcnt lgkmcnt(4)
  ds_read_b64_tr_b16 a[160:161], v100 offset:4096
  ds_read_b64_tr_b16 a[162:163], v100 offset:4352
  ds_read_b64_tr_b16 a[224:225], v100 offset:4104
  ds_read_b64_tr_b16 a[226:227], v100 offset:4360
  ds_read_b64_tr_b16 a[164:165], v100 offset:6144
  ds_read_b64_tr_b16 a[166:167], v100 offset:6400
  ds_read_b64_tr_b16 a[228:229], v100 offset:6152
  ds_read_b64_tr_b16 a[230:231], v100 offset:6408
  s_waitcnt lgkmcnt(4)
  ds_read_b64_tr_b16 a[168:169], v100 offset:8192
  ds_read_b64_tr_b16 a[170:171], v100 offset:8448
  ds_read_b64_tr_b16 a[232:233], v100 offset:8200
  ds_read_b64_tr_b16 a[234:235], v100 offset:8456
  ds_read_b64_tr_b16 a[172:173], v100 offset:10240
  ds_read_b64_tr_b16 a[174:175], v100 offset:10496
  ds_read_b64_tr_b16 a[236:237], v100 offset:10248
  ds_read_b64_tr_b16 a[238:239], v100 offset:10504
  s_waitcnt lgkmcnt(4)
  ds_read_b64_tr_b16 a[176:177], v100 offset:12288
  ds_read_b64_tr_b16 a[178:179], v100 offset:12544
  ds_read_b64_tr_b16 a[240:241], v100 offset:12296
  ds_read_b64_tr_b16 a[242:243], v100 offset:12552
  ds_read_b64_tr_b16 a[180:181], v100 offset:14336
  ds_read_b64_tr_b16 a[182:183], v100 offset:14592
  ds_read_b64_tr_b16 a[244:245], v100 offset:14344
  ds_read_b64_tr_b16 a[246:247], v100 offset:14600
  s_waitcnt lgkmcnt(4)
  s_waitcnt lgkmcnt(0)
  s_waitcnt vmcnt(0)
  ds_read_b64_tr_b16 a[184:185], v100 offset:16384
  ds_read_b64_tr_b16 a[186:187], v100 offset:16640
  ds_read_b64_tr_b16 a[248:249], v100 offset:16392
  ds_read_b64_tr_b16 a[250:251], v100 offset:16648
  ds_read_b64_tr_b16 a[188:189], v100 offset:18432
  ds_read_b64_tr_b16 a[190:191], v100 offset:18688
  ds_read_b64_tr_b16 a[252:253], v100 offset:18440
  ds_read_b64_tr_b16 a[254:255], v100 offset:18696
  s_waitcnt lgkmcnt(4)
  ds_read_b64_tr_b16 v[208:209], v100 offset:20480
  ds_read_b64_tr_b16 v[210:211], v100 offset:20736
  ds_read_b64_tr_b16 v[212:213], v100 offset:20488
  ds_read_b64_tr_b16 v[214:215], v100 offset:20744
  ds_read_b64_tr_b16 v[216:217], v100 offset:22528
  ds_read_b64_tr_b16 v[218:219], v100 offset:22784
  ds_read_b64_tr_b16 v[220:221], v100 offset:22536
  ds_read_b64_tr_b16 v[222:223], v100 offset:22792
  s_waitcnt lgkmcnt(4)
  ds_read_b64_tr_b16 v[224:225], v100 offset:24576
  ds_read_b64_tr_b16 v[226:227], v100 offset:24832
  ds_read_b64_tr_b16 v[228:229], v100 offset:24584
  ds_read_b64_tr_b16 v[230:231], v100 offset:24840
  ds_read_b64_tr_b16 v[232:233], v100 offset:26624
  ds_read_b64_tr_b16 v[234:235], v100 offset:26880
  ds_read_b64_tr_b16 v[236:237], v100 offset:26632
  ds_read_b64_tr_b16 v[238:239], v100 offset:26888
  s_waitcnt lgkmcnt(4)
  ds_read_b64_tr_b16 v[240:241], v100 offset:28672
  ds_read_b64_tr_b16 v[242:243], v100 offset:28928
  ds_read_b64_tr_b16 v[244:245], v100 offset:28680
  ds_read_b64_tr_b16 v[246:247], v100 offset:28936
  ds_read_b64_tr_b16 v[248:249], v100 offset:30720
  ds_read_b64_tr_b16 v[250:251], v100 offset:30976
  ds_read_b64_tr_b16 v[252:253], v100 offset:30728
  ds_read_b64_tr_b16 v[254:255], v100 offset:30984
  s_waitcnt lgkmcnt(4)
  s_waitcnt lgkmcnt(0)
  s_load_dwordx2 s[42:43], s[0:1], 16
  s_waitcnt lgkmcnt(0)
  s_mov_b32 s36, s42
  s_and_b32 s37, s43, 0xffff
  s_mov_b32 s38, 4194304
  s_mov_b32 s39, 0x20000
  s_add_u32 s40, s45, 5
  s_and_b32 s40, s40, 15
  s_lshl_b32 s40, s40, 18
  s_add_u32 s40, s40, s44
  s_add_u32 m0, s41, 0
  s_nop 0
  buffer_load_dwordx4 v102, s[36:39], s40 offen lds
  s_add_u32 s40, s40, 131072
  s_add_u32 m0, s41, 1024
  s_nop 0
  buffer_load_dwordx4 v102, s[36:39], s40 offen lds
  s_add_u32 s40, s45, 7
  s_and_b32 s40, s40, 15
  s_lshl_b32 s40, s40, 18
  s_add_u32 s40, s40, s44
  s_add_u32 m0, s41, 2048
  s_nop 0
  buffer_load_dwordx4 v102, s[36:39], s40 offen lds
  s_add_u32 s40, s40, 131072
  s_add_u32 m0, s41, 3072
  s_nop 0
  buffer_load_dwordx4 v102, s[36:39], s40 offen lds
  s_add_u32 s40, s45, 9
  s_and_b32 s40, s40, 15
  s_lshl_b32 s40, s40, 18
  s_add_u32 s40, s40, s44
  s_add_u32 m0, s41, 4096
  s_nop 0
  buffer_load_dwordx4 v102, s[36:39], s40 offen lds
  s_add_u32 s40, s40, 131072
  s_add_u32 m0, s41, 5120
  s_nop 0
  buffer_load_dwordx4 v102, s[36:39], s40 offen lds
  s_add_u32 s40, s45, 11
  s_and_b32 s40, s40, 15
  s_lshl_b32 s40, s40, 18
  s_add_u32 s40, s40, s44
  s_add_u32 m0, s41, 6144
  s_nop 0
  buffer_load_dwordx4 v102, s[36:39], s40 offen lds
  s_add_u32 s40, s40, 131072
  s_add_u32 m0, s41, 7168
  s_nop 0
  buffer_load_dwordx4 v102, s[36:39], s40 offen lds
  s_add_u32 s40, s45, 13
  s_and_b32 s40, s40, 15
  s_lshl_b32 s40, s40, 18
  s_add_u32 s40, s40, s44
  s_add_u32 m0, s41, 8192
  s_nop 0
  buffer_load_dwordx4 v102, s[36:39], s40 offen lds
  s_add_u32 s40, s40, 131072
  s_add_u32 m0, s41, 9216
  s_nop 0
  buffer_load_dwordx4 v102, s[36:39], s40 offen lds
  s_add_u32 s40, s45, 15
  s_and_b32 s40, s40, 15
  s_lshl_b32 s40, s40, 18
  s_add_u32 s40, s40, s44
  s_add_u32 m0, s41, 10240
  s_nop 0
  buffer_load_dwordx4 v102, s[36:39], s40 offen lds
  s_add_u32 s40, s40, 131072
  s_add_u32 m0, s41, 11264
  s_nop 0
  buffer_load_dwordx4 v102, s[36:39], s40 offen lds
  s_load_dwordx2 s[42:43], s[0:1], 40
  s_waitcnt lgkmcnt(0)
  s_mov_b32 s36, s42
  s_and_b32 s37, s43, 0xffff
  s_mov_b32 s38, 4194304
  s_mov_b32 s39, 0x20000
  s_add_u32 s40, s16, 3
  s_and_b32 s40, s40, 3
  s_lshl_b32 s40, s40, 15
  s_add_u32 s40, s40, s46
  s_add_u32 s40, s40, 0
  s_add_u32 m0, s41, 12288
  s_nop 0
  buffer_load_dwordx4 v103, s[36:39], s40 offen lds
  s_add_u32 s40, s40, 16384
  s_add_u32 m0, s41, 13312
  s_nop 0
  buffer_load_dwordx4 v103, s[36:39], s40 offen lds
  s_add_u32 s40, s16, 1
  s_and_b32 s40, s40, 3
  s_lshl_b32 s40, s40, 15
  s_add_u32 s40, s40, s46
  s_add_u32 s40, s40, 64
  s_add_u32 m0, s41, 14336
  s_nop 0
  buffer_load_dwordx4 v103, s[36:39], s40 offen lds
  s_add_u32 s40, s40, 16384
  s_add_u32 m0, s41, 15360
  s_nop 0
  buffer_load_dwordx4 v103, s[36:39], s40 offen lds
  s_add_u32 s40, s16, 2
  s_and_b32 s40, s40, 3
  s_lshl_b32 s40, s40, 15
  s_add_u32 s40, s40, s46
  s_add_u32 s40, s40, 64
  s_add_u32 m0, s41, 16384
  s_nop 0
  buffer_load_dwordx4 v103, s[36:39], s40 offen lds
  s_add_u32 s40, s40, 16384
  s_add_u32 m0, s41, 17408
  s_nop 0
  buffer_load_dwordx4 v103, s[36:39], s40 offen lds
  s_add_u32 s40, s16, 3
  s_and_b32 s40, s40, 3
  s_lshl_b32 s40, s40, 15
  s_add_u32 s40, s40, s46
  s_add_u32 s40, s40, 64
  s_add_u32 m0, s41, 18432
  s_nop 0
  buffer_load_dwordx4 v103, s[36:39], s40 offen lds
  s_add_u32 s40, s40, 16384
  s_add_u32 m0, s41, 19456
  s_nop 0
  buffer_load_dwordx4 v103, s[36:39], s40 offen lds
  s_add_u32 s40, s16, 1
  s_and_b32 s40, s40, 3
  s_lshl_b32 s40, s40, 15
  s_add_u32 s40, s40, s46
  s_add_u32 s40, s40, 128
  s_add_u32 m0, s41, 20480
  s_nop 0
  buffer_load_dwordx4 v103, s[36:39], s40 offen lds
  s_add_u32 s40, s40, 16384
  s_add_u32 m0, s41, 21504
  s_nop 0
  buffer_load_dwordx4 v103, s[36:39], s40 offen lds
  s_add_u32 s40, s16, 2
  s_and_b32 s40, s40, 3
  s_lshl_b32 s40, s40, 15
  s_add_u32 s40, s40, s46
  s_add_u32 s40, s40, 128
  s_add_u32 m0, s41, 22528
  s_nop 0
  buffer_load_dwordx4 v103, s[36:39], s40 offen lds
  s_add_u32 s40, s40, 16384
  s_add_u32 m0, s41, 23552
  s_nop 0
  buffer_load_dwordx4 v103, s[36:39], s40 offen lds
  s_add_u32 s40, s16, 3
  s_and_b32 s40, s40, 3
  s_lshl_b32 s40, s40, 15
  s_add_u32 s40, s40, s46
  s_add_u32 s40, s40, 128
  s_add_u32 m0, s41, 24576
  s_nop 0
  buffer_load_dwordx4 v103, s[36:39], s40 offen lds
  s_add_u32 s40, s40, 16384
  s_add_u32 m0, s41, 25600
  s_nop 0
  buffer_load_dwordx4 v103, s[36:39], s40 offen lds
  s_add_u32 s40, s16, 1
  s_and_b32 s40, s40, 3
  s_lshl_b32 s40, s40, 15
  s_add_u32 s40, s40, s46
  s_add_u32 s40, s40, 192
  s_add_u32 m0, s41, 26624
  s_nop 0
  buffer_load_dwordx4 v103, s[36:39], s40 offen lds
  s_add_u32 s40, s40, 16384
  s_add_u32 m0, s41, 27648
  s_nop 0
  buffer_load_dwordx4 v103, s[36:39], s40 offen lds
  s_add_u32 s40, s16, 2
  s_and_b32 s40, s40, 3
  s_lshl_b32 s40, s40, 15
  s_add_u32 s40, s40, s46
  s_add_u32 s40, s40, 192
  s_add_u32 m0, s41, 28672
  s_nop 0
  buffer_load_dwordx4 v103, s[36:39], s40 offen lds
  s_add_u32 s40, s40, 16384
  s_add_u32 m0, s41, 29696
  s_nop 0
  buffer_load_dwordx4 v103, s[36:39], s40 offen lds
  s_add_u32 s40, s16, 3
  s_and_b32 s40, s40, 3
  s_lshl_b32 s40, s40, 15
  s_add_u32 s40, s40, s46
  s_add_u32 s40, s40, 192
  s_add_u32 m0, s41, 30720
  s_nop 0
  buffer_load_dwordx4 v103, s[36:39], s40 offen lds
  s_add_u32 s40, s40, 16384
  s_add_u32 m0, s41, 31744
  s_nop 0
  buffer_load_dwordx4 v103, s[36:39], s40 offen lds
  s_waitcnt vmcnt(0)
  ds_read_b64_tr_b16 v[104:105], v100 offset:0
  ds_read_b64_tr_b16 v[106:107], v100 offset:256
  ds_read_b64_tr_b16 v[108:109], v100 offset:8
  ds_read_b64_tr_b16 v[110:111], v100 offset:264
  s_waitcnt lgkmcnt(0)
  ds_write_b128 v10, v[104:107] offset:0
  ds_write_b128 v10, v[108:111] offset:1024
  ds_read_b64_tr_b16 v[112:113], v100 offset:2048
  ds_read_b64_tr_b16 v[114:115], v100 offset:2304
  ds_read_b64_tr_b16 v[116:117], v100 offset:2056
  ds_read_b64_tr_b16 v[118:119], v100 offset:2312
  s_waitcnt lgkmcnt(0)
  ds_write_b128 v10, v[112:115] offset:2048
  ds_write_b128 v10, v[116:119] offset:3072
  ds_read_b64_tr_b16 v[104:105], v100 offset:4096
  ds_read_b64_tr_b16 v[106:107], v100 offset:4352
  ds_read_b64_tr_b16 v[108:109], v100 offset:4104
  ds_read_b64_tr_b16 v[110:111], v100 offset:4360
  s_waitcnt lgkmcnt(0)
  ds_write_b128 v10, v[104:107] offset:4096
  ds_write_b128 v10, v[108:111] offset:5120
  ds_read_b64_tr_b16 v[112:113], v100 offset:6144
  ds_read_b64_tr_b16 v[114:115], v100 offset:6400
  ds_read_b64_tr_b16 v[116:117], v100 offset:6152
  ds_read_b64_tr_b16 v[118:119], v100 offset:6408
  s_waitcnt lgkmcnt(0)
  ds_write_b128 v10, v[112:115] offset:6144
  ds_write_b128 v10, v[116:119] offset:7168
  ds_read_b64_tr_b16 v[104:105], v100 offset:8192
  ds_read_b64_tr_b16 v[106:107], v100 offset:8448
  ds_read_b64_tr_b16 v[108:109], v100 offset:8200
  ds_read_b64_tr_b16 v[110:111], v100 offset:8456
  s_waitcnt lgkmcnt(0)
  ds_write_b128 v10, v[104:107] offset:8192
  ds_write_b128 v10, v[108:111] offset:9216
  ds_read_b64_tr_b16 v[112:113], v100 offset:10240
  ds_read_b64_tr_b16 v[114:115], v100 offset:10496
  ds_read_b64_tr_b16 v[116:117], v100 offset:10248
  ds_read_b64_tr_b16 v[118:119], v100 offset:10504
  s_waitcnt lgkmcnt(0)
  ds_write_b128 v10, v[112:115] offset:10240
  ds_write_b128 v10, v[116:119] offset:11264
  ds_read_b64_tr_b16 v[104:105], v100 offset:12288
  ds_read_b64_tr_b16 v[106:107], v100 offset:12544
  ds_read_b64_tr_b16 v[108:109], v100 offset:12296
  ds_read_b64_tr_b16 v[110:111], v100 offset:12552
  s_waitcnt lgkmcnt(0)
  ds_write_b128 v10, v[104:107] offset:12288
  ds_write_b128 v10, v[108:111] offset:13312
  ds_read_b64_tr_b16 v[112:113], v100 offset:14336
  ds_read_b64_tr_b16 v[114:115], v100 offset:14592
  ds_read_b64_tr_b16 v[116:117], v100 offset:14344
  ds_read_b64_tr_b16 v[118:119], v100 offset:14600
  s_waitcnt lgkmcnt(0)
  ds_write_b128 v10, v[112:115] offset:14336
  ds_write_b128 v10, v[116:119] offset:15360
  ds_read_b64_tr_b16 v[104:105], v100 offset:16384
  ds_read_b64_tr_b16 v[106:107], v100 offset:16640
  ds_read_b64_tr_b16 v[108:109], v100 offset:16392
  ds_read_b64_tr_b16 v[110:111], v100 offset:16648
  s_waitcnt lgkmcnt(0)
  ds_write_b128 v10, v[104:107] offset:16384
  ds_write_b128 v10, v[108:111] offset:17408
  ds_read_b64_tr_b16 v[112:113], v100 offset:18432
  ds_read_b64_tr_b16 v[114:115], v100 offset:18688
  ds_read_b64_tr_b16 v[116:117], v100 offset:18440
  ds_read_b64_tr_b16 v[118:119], v100 offset:18696
  s_waitcnt lgkmcnt(0)
  ds_write_b128 v10, v[112:115] offset:18432
  ds_write_b128 v10, v[116:119] offset:19456
  ds_read_b64_tr_b16 v[104:105], v100 offset:20480
  ds_read_b64_tr_b16 v[106:107], v100 offset:20736
  ds_read_b64_tr_b16 v[108:109], v100 offset:20488
  ds_read_b64_tr_b16 v[110:111], v100 offset:20744
  s_waitcnt lgkmcnt(0)
  ds_write_b128 v10, v[104:107] offset:20480
  ds_write_b128 v10, v[108:111] offset:21504
  ds_read_b64_tr_b16 v[112:113], v100 offset:22528
  ds_read_b64_tr_b16 v[114:115], v100 offset:22784
  ds_read_b64_tr_b16 v[116:117], v100 offset:22536
  ds_read_b64_tr_b16 v[118:119], v100 offset:22792
  s_waitcnt lgkmcnt(0)
  ds_write_b128 v10, v[112:115] offset:22528
  ds_write_b128 v10, v[116:119] offset:23552
  ds_read_b64_tr_b16 v[104:105], v100 offset:24576
  ds_read_b64_tr_b16 v[106:107], v100 offset:24832
  ds_read_b64_tr_b16 v[108:109], v100 offset:24584
  ds_read_b64_tr_b16 v[110:111], v100 offset:24840
  s_waitcnt lgkmcnt(0)
  ds_write_b128 v10, v[104:107] offset:24576
  ds_write_b128 v10, v[108:111] offset:25600
  ds_read_b64_tr_b16 v[112:113], v100 offset:26624
  ds_read_b64_tr_b16 v[114:115], v100 offset:26880
  ds_read_b64_tr_b16 v[116:117], v100 offset:26632
  ds_read_b64_tr_b16 v[118:119], v100 offset:26888
  s_waitcnt lgkmcnt(0)
  ds_write_b128 v10, v[112:115] offset:26624
  ds_write_b128 v10, v[116:119] offset:27648
  ds_read_b64_tr_b16 v[104:105], v100 offset:28672
  ds_read_b64_tr_b16 v[106:107], v100 offset:28928
  ds_read_b64_tr_b16 v[108:109], v100 offset:28680
  ds_read_b64_tr_b16 v[110:111], v100 offset:28936
  s_waitcnt lgkmcnt(0)
  ds_write_b128 v10, v[104:107] offset:28672
  ds_write_b128 v10, v[108:111] offset:29696
  ds_read_b64_tr_b16 v[112:113], v100 offset:30720
  ds_read_b64_tr_b16 v[114:115], v100 offset:30976
  ds_read_b64_tr_b16 v[116:117], v100 offset:30728
  ds_read_b64_tr_b16 v[118:119], v100 offset:30984
  s_waitcnt lgkmcnt(0)
  ds_write_b128 v10, v[112:115] offset:30720
  ds_write_b128 v10, v[116:119] offset:31744
  s_waitcnt lgkmcnt(0)
  s_call_b64 s[100:101], VERIFY
  s_cbranch_scc1 VER_OK_4
  v_mov_b32 v0, v116
  s_waitcnt vmcnt(0) lgkmcnt(0)
  s_barrier
  s_branch DISPATCH
VER_OK_4:
  s_lshl_b32 s44, s21, 6
  s_add_u32 s44, s44, 24805376
  s_cmp_eq_u32 s20, 0
  s_cselect_b32 s44, s44, 268435456
  v_mov_b32 v116, 1
  v_mov_b32 v117, 0
  s_mov_b64 exec, 1
  buffer_store_dword v116, v117, s[8:11], s44 offen sc1
  s_mov_b64 exec, -1
  s_add_u32 s34, s16, 1
  s_and_b32 s34, s34, 3
  s_lshl_b32 s44, s34, 12
  s_lshl_b32 s48, s34, 10
  s_add_u32 s48, s48, 28672
  s_add_u32 s34, s16, 2
  s_and_b32 s34, s34, 3
  s_lshl_b32 s45, s34, 12
  s_lshl_b32 s49, s34, 10
  s_add_u32 s49, s49, 28672
  s_add_u32 s34, s16, 3
  s_and_b32 s34, s34, 3
  s_lshl_b32 s46, s34, 12
  s_lshl_b32 s50, s34, 10
  s_add_u32 s50, s50, 28672
  s_lshl_b32 s47, s16, 10
  s_add_u32 s47, s47, 28672
  s_mov_b32 s18, 0
  s_lshl_b32 s34, s20, 6
  s_lshl_b32 s54, s34, 19
  s_add_u32 s54, s54, 43024384
  s_add_u32 s55, s54, 524288
  s_lshl_b32 s61, s34, 13
  s_add_u32 s61, s61, 22290432
  s_lshl_b32 s62, s34, 18
  s_add_u32 s62, s62, 110133248
  s_mov_b32 s63, 268435456
  s_mov_b32 s59, 1
  s_lshl_b32 s51, s20, 19
  s_add_u32 s51, s51, 25165824
  s_lshl_b32 s53, s20, 14
  s_add_u32 s53, s53, 26222592
  s_mov_b32 s52, s53
  s_lshl_b32 s34, s16, 16
  s_add_u32 s34, s34, s51
  s_add_u32 s64, s34, 0
  s_add_u32 s65, s34, 16384
  s_add_u32 s66, s34, 32768
  s_add_u32 s67, s34, 49152
  s_mov_b32 s69, 0
  s_mov_b32 s75, 0
  s_mov_b32 s76, 0
  s_waitcnt vmcnt(0)
  ds_read_b128 v[104:107], v10 offset:0
  ds_read_b128 v[108:111], v10 offset:1024
  ds_read_b128 v[112:115], v10 offset:2048
  ds_read_b128 v[116:119], v10 offset:3072
  s_waitcnt lgkmcnt(0)
  s_barrier
CH_LOOP:
  s_waitcnt vmcnt(3)
  v_max3_u32 v122, v72, v73, v74
  v_max_u32 v122, v122, v75
  v_cmp_eq_u32 vcc, -1, v122
  s_nop 0
  s_cbranch_vccnz CH_GSLOW0
CH_GOK0:
  ds_write_b128 v2, v[72:75] offset:0
  v_mfma_f32_16x16x32_bf16 v[48:51], v[128:131], v[72:75], 0
  v_add_u32 v14, s44, v1
  v_add_u32 v15, s45, v1
  v_mfma_f32_16x16x32_bf16 v[56:59], a[0:3], v[72:75], 0
  v_add_u32 v0, s46, v1
  s_waitcnt vmcnt(2)
  v_max3_u32 v122, v76, v77, v78
  v_mfma_f32_16x16x32_bf16 v[52:55], v[132:135], v[72:75], 0
  v_max_u32 v122, v122, v79
  v_mfma_f32_16x16x32_bf16 v[60:63], a[64:67], v[72:75], 0
  v_cmp_eq_u32 vcc, -1, v122
  s_nop 0
  s_cbranch_vccnz CH_GSLOW1
CH_GOK1:
  ds_write_b128 v2, v[76:79] offset:1024
  v_mfma_f32_16x16x32_bf16 v[48:51], v[136:139], v[76:79], v[48:51]
  v_mfma_f32_16x16x32_bf16 v[56:59], a[4:7], v[76:79], v[56:59]
  s_waitcnt vmcnt(1)
  v_max3_u32 v122, v80, v81, v82
  v_mfma_f32_16x16x32_bf16 v[52:55], v[140:143], v[76:79], v[52:55]
  v_max_u32 v122, v122, v83
  v_mfma_f32_16x16x32_bf16 v[60:63], a[68:71], v[76:79], v[60:63]
  v_cmp_eq_u32 vcc, -1, v122
  s_nop 0
  s_cbranch_vccnz CH_GSLOW2
CH_GOK2:
  ds_write_b128 v2, v[80:83] offset:2048
  v_mfma_f32_16x16x32_bf16 v[48:51], v[144:147], v[80:83], v[48:51]
  v_mfma_f32_16x16x32_bf16 v[56:59], a[8:11], v[80:83], v[56:59]
  s_waitcnt vmcnt(0)
  v_max3_u32 v122, v84, v85, v86
  v_mfma_f32_16x16x32_bf16 v[52:55], v[148:151], v[80:83], v[52:55]
  v_max_u32 v122, v122, v87
  v_mfma_f32_16x16x32_bf16 v[60:63], a[72:75], v[80:83], v[60:63]
  v_cmp_eq_u32 vcc, -1, v122
  s_nop 0
  s_cbranch_vccnz CH_GSLOW3
CH_GOK3:
  ds_write_b128 v2, v[84:87] offset:3072
  s_cmp_eq_u32 s59, 0
  s_cbranch_scc0 CH_LATE
CH_NOLATE:
  v_mfma_f32_16x16x32_bf16 v[48:51], v[152:155], v[84:87], v[48:51]
  s_waitcnt lgkmcnt(0)
  s_barrier
  v_mov_b32 v68, 1
  ds_read_b128 v[88:91], v14 offset:0
  v_mfma_f32_16x16x32_bf16 v[52:55], v[156:159], v[84:87], v[52:55]
  ds_read_b128 v[92:95], v14 offset:1024
  ds_read_b128 v[96:99], v14 offset:2048
  ds_read_b128 v[100:103], v14 offset:3072
  v_mfma_f32_16x16x32_bf16 v[56:59], a[12:15], v[84:87], v[56:59]
  ds_read_b128 v[32:35], v15 offset:0
  ds_read_b128 v[36:39], v15 offset:1024
  v_mov_b32 v64, -1
  v_mfma_f32_16x16x32_bf16 v[60:63], a[76:79], v[84:87], v[60:63]
  s_lshl_b32 s34, s20, 6
  v_mov_b32 v65, -1
  s_add_u32 s34, s34, s18
  s_waitcnt lgkmcnt(5)
  v_mfma_f32_16x16x32_bf16 v[48:51], v[160:163], v[88:91], v[48:51]
  v_mfma_f32_16x16x32_bf16 v[56:59], a[16:19], v[88:91], v[56:59]
  v_mfma_f32_16x16x32_bf16 v[52:55], v[164:167], v[88:91], v[52:55]
  v_mfma_f32_16x16x32_bf16 v[60:63], a[80:83], v[88:91], v[60:63]
  ds_read_b128 v[88:91], v15 offset:2048
  s_waitcnt lgkmcnt(5)
  v_mfma_f32_16x16x32_bf16 v[48:51], v[104:107], v[92:95], v[48:51]
  ds_read_b128 v[104:107], v10 offset:4096
  v_mfma_f32_16x16x32_bf16 v[56:59], a[20:23], v[92:95], v[56:59]
  v_mfma_f32_16x16x32_bf16 v[52:55], v[108:111], v[92:95], v[52:55]
  s_mov_b64 exec, 1
  buffer_store_dword v68, v9, s[8:11], s63 offen sc1
  s_mov_b64 exec, -1
  s_nop 0
  v_mfma_f32_16x16x32_bf16 v[60:63], a[84:87], v[92:95], v[60:63]
  ds_read_b128 v[108:111], v10 offset:5120
  buffer_load_dword v13, v9, s[8:11], s61 offen sc1
  s_waitcnt lgkmcnt(6)
  v_mfma_f32_16x16x32_bf16 v[48:51], v[168:171], v[96:99], v[48:51]
  buffer_load_dwordx4 v[24:27], v6, s[8:11], s54 offen offset:2048 sc1
  v_mfma_f32_16x16x32_bf16 v[56:59], a[24:27], v[96:99], v[56:59]
  ds_read_b128 v[92:95], v15 offset:3072
  s_lshl_b32 s63, s34, 13
  s_add_u32 s63, s63, 23330816
  v_mfma_f32_16x16x32_bf16 v[52:55], v[172:175], v[96:99], v[52:55]
  v_mfma_f32_16x16x32_bf16 v[60:63], a[88:91], v[96:99], v[60:63]
  ds_read_b128 v[96:99], v0 offset:0
  s_waitcnt lgkmcnt(7)
  v_mfma_f32_16x16x32_bf16 v[48:51], v[112:115], v[100:103], v[48:51]
  ds_read_b128 v[112:115], v10 offset:6144
  buffer_load_dwordx4 v[28:31], v6, s[8:11], s54 offen offset:3072 sc1
  v_mfma_f32_16x16x32_bf16 v[56:59], a[28:31], v[100:103], v[56:59]
  s_mov_b32 s54, s55
  v_mfma_f32_16x16x32_bf16 v[52:55], v[116:119], v[100:103], v[52:55]
  ds_read_b128 v[116:119], v10 offset:7168
  v_mfma_f32_16x16x32_bf16 v[60:63], a[92:95], v[100:103], v[60:63]
  ds_read_b128 v[100:103], v0 offset:1024
  s_waitcnt lgkmcnt(9)
  v_mfma_f32_16x16x32_bf16 v[48:51], v[176:179], v[32:35], v[48:51]
  s_mov_b64 exec, s[24:25]
  buffer_store_dwordx2 v[64:65], v5, s[8:11], s53 offen
  s_mov_b64 exec, -1
  s_nop 0
  v_mfma_f32_16x16x32_bf16 v[56:59], a[32:35], v[32:35], v[56:59]
  v_mfma_f32_16x16x32_bf16 v[52:55], v[180:183], v[32:35], v[52:55]
  v_mfma_f32_16x16x32_bf16 v[60:63], a[96:99], v[32:35], v[60:63]
  ds_read_b128 v[32:35], v0 offset:2048
  s_waitcnt lgkmcnt(7)
  v_mfma_f32_16x16x32_bf16 v[48:51], v[104:107], v[36:39], v[48:51]
  ds_read_b128 v[104:107], v10 offset:8192
  v_mfma_f32_16x16x32_bf16 v[56:59], a[36:39], v[36:39], v[56:59]
  s_waitcnt lgkmcnt(7)
  v_mfma_f32_16x16x32_bf16 v[52:55], v[108:111], v[36:39], v[52:55]
  ds_read_b128 v[108:111], v10 offset:9216
  v_mfma_f32_16x16x32_bf16 v[60:63], a[100:103], v[36:39], v[60:63]
  ds_read_b128 v[36:39], v0 offset:3072
  v_mfma_f32_16x16x32_bf16 v[48:51], v[184:187], v[88:91], v[48:51]
  v_mfma_f32_16x16x32_bf16 v[56:59], a[40:43], v[88:91], v[56:59]
  v_mfma_f32_16x16x32_bf16 v[52:55], v[188:191], v[88:91], v[52:55]
  v_mfma_f32_16x16x32_bf16 v[60:63], a[104:107], v[88:91], v[60:63]
  ds_read_b128 v[88:91], v2 offset:0
  s_waitcnt lgkmcnt(7)
  v_mfma_f32_16x16x32_bf16 v[48:51], v[112:115], v[92:95], v[48:51]
  ds_read_b128 v[112:115], v10 offset:10240
  v_mfma_f32_16x16x32_bf16 v[56:59], a[44:47], v[92:95], v[56:59]
  s_waitcnt lgkmcnt(7)
  v_mfma_f32_16x16x32_bf16 v[52:55], v[116:119], v[92:95], v[52:55]
  ds_read_b128 v[116:119], v10 offset:11264
  v_mfma_f32_16x16x32_bf16 v[60:63], a[108:111], v[92:95], v[60:63]
  ds_read_b128 v[92:95], v2 offset:1024
  v_mfma_f32_16x16x32_bf16 v[48:51], v[192:195], v[96:99], v[48:51]
  v_mfma_f32_16x16x32_bf16 v[56:59], a[48:51], v[96:99], v[56:59]
  v_mfma_f32_16x16x32_bf16 v[52:55], v[196:199], v[96:99], v[52:55]
  v_mfma_f32_16x16x32_bf16 v[60:63], a[112:115], v[96:99], v[60:63]
  ds_read_b128 v[96:99], v2 offset:2048
  s_waitcnt lgkmcnt(7)
  v_mfma_f32_16x16x32_bf16 v[48:51], v[104:107], v[100:103], v[48:51]
  v_mfma_f32_16x16x32_bf16 v[56:59], a[52:55], v[100:103], v[56:59]
  s_waitcnt lgkmcnt(6)
  v_mfma_f32_16x16x32_bf16 v[52:55], v[108:111], v[100:103], v[52:55]
  v_mfma_f32_16x16x32_bf16 v[60:63], a[116:119], v[100:103], v[60:63]
  ds_read_b128 v[100:103], v2 offset:3072
  v_mfma_f32_16x16x32_bf16 v[48:51], v[200:203], v[32:35], v[48:51]
  v_mfma_f32_16x16x32_bf16 v[56:59], a[56:59], v[32:35], v[56:59]
  v_mfma_f32_16x16x32_bf16 v[52:55], v[204:207], v[32:35], v[52:55]
  v_mfma_f32_16x16x32_bf16 v[60:63], a[120:123], v[32:35], v[60:63]
  ds_read_b128 v[32:35], v14 offset:0
  s_waitcnt lgkmcnt(5)
  v_mfma_f32_16x16x32_bf16 v[48:51], v[112:115], v[36:39], v[48:51]
  v_mfma_f32_16x16x32_bf16 v[56:59], a[60:63], v[36:39], v[56:59]
  s_waitcnt lgkmcnt(4)
  v_mfma_f32_16x16x32_bf16 v[52:55], v[116:119], v[36:39], v[52:55]
  v_mfma_f32_16x16x32_bf16 v[60:63], a[124:127], v[36:39], v[60:63]
  ds_read_b128 v[36:39], v14 offset:1024
  s_nop 2
  v_cvt_pk_bf16_f32 v104, v48, v49
  v_mfma_f32_16x16x32_bf16 v[64:67], v[88:91], a[128:131], 0
  v_cvt_pk_bf16_f32 v105, v50, v51
  v_mfma_f32_16x16x32_bf16 v[68:71], v[88:91], a[192:195], 0
  ds_read_b128 v[88:91], v14 offset:2048
  v_cvt_pk_bf16_f32 v106, v52, v53
  s_waitcnt lgkmcnt(5)
  v_mfma_f32_16x16x32_bf16 v[64:67], v[92:95], a[132:135], v[64:67]
  v_cvt_pk_bf16_f32 v107, v54, v55
  v_mfma_f32_16x16x32_bf16 v[68:71], v[92:95], a[196:199], v[68:71]
  ds_read_b128 v[92:95], v14 offset:3072
  v_cvt_pk_bf16_f32 v108, v56, v57
  v_mfma_f32_16x16x32_bf16 v[72:75], v[16:19], v[104:107], 0
  v_cvt_pk_bf16_f32 v109, v58, v59
  v_mfma_f32_16x16x32_bf16 v[76:79], v[20:23], v[104:107], 0
  v_cvt_pk_bf16_f32 v110, v60, v61
  s_waitcnt lgkmcnt(5)
  v_mfma_f32_16x16x32_bf16 v[64:67], v[96:99], a[136:139], v[64:67]
  v_cvt_pk_bf16_f32 v111, v62, v63
  v_mfma_f32_16x16x32_bf16 v[68:71], v[96:99], a[200:203], v[68:71]
  s_nop 0
  ds_write_b128 v11, v[72:75] offset:16384
  ds_read_b128 v[96:99], v15 offset:0
  v_add_u32 v14, s47, v1
  v_mfma_f32_16x16x32_bf16 v[80:83], v[108:111], v[104:107], v[124:127]
  ds_write_b128 v11, v[76:79] offset:17408
  buffer_store_dwordx4 v[108:111], v7, s[8:11], s62 offen sc1
  s_waitcnt lgkmcnt(7)
  v_mfma_f32_16x16x32_bf16 v[64:67], v[100:103], a[140:143], v[64:67]
  v_mfma_f32_16x16x32_bf16 v[68:71], v[100:103], a[204:207], v[68:71]
  ds_read_b128 v[100:103], v15 offset:1024
  s_waitcnt lgkmcnt(7)
  v_mfma_f32_16x16x32_bf16 v[64:67], v[32:35], a[144:147], v[64:67]
  ds_write_b128 v11, v[80:83] offset:18432
  v_mfma_f32_16x16x32_bf16 v[68:71], v[32:35], a[208:211], v[68:71]
  ds_read_b128 v[32:35], v15 offset:2048
  s_waitcnt lgkmcnt(8)
  v_mfma_f32_16x16x32_bf16 v[64:67], v[36:39], a[148:151], v[64:67]
  v_mfma_f32_16x16x32_bf16 v[68:71], v[36:39], a[212:215], v[68:71]
  ds_read_b128 v[36:39], v15 offset:3072
  v_add_u32 v15, s49, v1
  s_waitcnt lgkmcnt(8)
  v_mfma_f32_16x16x32_bf16 v[64:67], v[88:91], a[152:155], v[64:67]
  v_mfma_f32_16x16x32_bf16 v[68:71], v[88:91], a[216:219], v[68:71]
  ds_read_b128 v[88:91], v0 offset:0
  s_waitcnt lgkmcnt(3)
  s_barrier
  v_mfma_f32_16x16x32_bf16 v[64:67], v[92:95], a[156:159], v[64:67]
  ds_read_b128 v[48:51], v120 offset:16384
  ds_read_b128 v[52:55], v120 offset:19456
  ds_read_b128 v[56:59], v120 offset:22528
  v_mfma_f32_16x16x32_bf16 v[68:71], v[92:95], a[220:223], v[68:71]
  ds_read_b128 v[60:63], v120 offset:25600
  ds_read_b128 v[72:75], v1 offset:18432
  ds_read_b128 v[76:79], v1 offset:21504
  v_mfma_f32_16x16x32_bf16 v[64:67], v[96:99], a[160:163], v[64:67]
  ds_read_b128 v[80:83], v1 offset:24576
  ds_read_b128 v[84:87], v1 offset:27648
  ds_read_b128 v[92:95], v0 offset:1024
  v_mfma_f32_16x16x32_bf16 v[68:71], v[96:99], a[224:227], v[68:71]
  ds_read_b128 v[96:99], v0 offset:2048
  s_waitcnt vmcnt(4)
  v_cmp_ne_u32 vcc, 0, v13
  ds_read_b128 v[40:43], v10 offset:17408
  v_mfma_f32_16x16x32_bf16 v[64:67], v[100:103], a[164:167], v[64:67]
  s_cmp_lg_u32 vcc_lo, 0
  s_cselect_b32 s56, s55, 268435456
  ds_read_b128 v[44:47], v10 offset:19456
  v_mfma_f32_16x16x32_bf16 v[68:71], v[100:103], a[228:231], v[68:71]
  ds_read_b128 v[100:103], v0 offset:3072
  buffer_load_dwordx4 v[16:19], v6, s[8:11], s56 offen offset:0 sc1
  s_waitcnt lgkmcnt(15)
  v_mfma_f32_16x16x32_bf16 v[64:67], v[32:35], a[168:171], v[64:67]
  s_cselect_b32 s59, 0, 1
  s_waitcnt lgkmcnt(11)
  v_add_f32 v48, v48, v52
  v_mfma_f32_16x16x32_bf16 v[68:71], v[32:35], a[232:235], v[68:71]
  ds_read_b128 v[32:35], v10 offset:18432
  v_add_f32 v49, v49, v53
  v_add_f32 v50, v50, v54
  v_mfma_f32_16x16x32_bf16 v[64:67], v[36:39], a[172:175], v[64:67]
  s_add_u32 s55, s55, 524288
  s_waitcnt lgkmcnt(10)
  v_add_f32 v56, v56, v60
  v_mfma_f32_16x16x32_bf16 v[68:71], v[36:39], a[236:239], v[68:71]
  ds_read_b128 v[36:39], v10 offset:15360
  v_add_f32 v57, v57, v61
  v_add_f32 v58, v58, v62
  v_mfma_f32_16x16x32_bf16 v[64:67], v[88:91], a[176:179], v[64:67]
  buffer_load_dwordx4 v[20:23], v6, s[8:11], s56 offen offset:1024 sc1
  v_mfma_f32_16x16x32_bf16 v[68:71], v[88:91], a[240:243], v[68:71]
  ds_read_b128 v[88:91], v10 offset:12288
  v_add_f32 v112, v48, v56
  v_add_f32 v113, v49, v57
  s_waitcnt lgkmcnt(7)
  v_mfma_f32_16x16x32_bf16 v[64:67], v[92:95], a[180:183], v[64:67]
  s_cmp_lt_u32 s18, 62
  v_add_f32 v114, v50, v58
  v_add_f32 v51, v51, v55
  v_mfma_f32_16x16x32_bf16 v[68:71], v[92:95], a[244:247], v[68:71]
  ds_read_b128 v[92:95], v10 offset:13312
  v_add_f32 v59, v59, v63
  v_add_f32 v72, v72, v76
  s_waitcnt lgkmcnt(7)
  v_mfma_f32_16x16x32_bf16 v[64:67], v[96:99], a[184:187], v[64:67]
  s_cselect_b32 s55, s55, 268435456
  v_add_f32 v80, v80, v84
  v_max3_f32 v122, v112, v113, v114
  v_mfma_f32_16x16x32_bf16 v[68:71], v[96:99], a[248:251], v[68:71]
  ds_read_b128 v[96:99], v10 offset:14336
  v_add_f32 v115, v51, v59
  v_add_f32 v116, v72, v80
  s_waitcnt lgkmcnt(5)
  v_mfma_f32_16x16x32_bf16 v[64:67], v[100:103], a[188:191], v[64:67]
  s_add_u32 s61, s61, 8192
  v_add_f32 v73, v73, v77
  v_add_f32 v74, v74, v78
  v_mfma_f32_16x16x32_bf16 v[68:71], v[100:103], a[252:255], v[68:71]
  ds_read_b128 v[100:103], v10 offset:16384
  v_add_f32 v81, v81, v85
  v_add_f32 v82, v82, v86
  v_max3_f32 v122, v122, v115, v116
  v_add_f32 v117, v73, v81
  v_add_f32 v118, v74, v82
  v_add_f32 v75, v75, v79
  v_add_f32 v83, v83, v87
  v_max3_f32 v122, v122, v117, v118
  v_add_f32 v119, v75, v83
  v_max_f32 v122, v122, v119
  v_mov_b32 v56, 0x3f803f80
  s_nop 0
  v_max_f32_dpp v122, v122, v122 row_ror:8 row_mask:0xf bank_mask:0xf
  v_mov_b32 v48, v122
  v_mov_b32 v57, 0x3f803f80
  s_nop 0
  v_permlane16_swap_b32 v122, v48
  v_max_f32 v122, v122, v48
  v_mov_b32 v48, v122
  v_mov_b32 v58, 0x3f803f80
  s_nop 0
  v_permlane32_swap_b32 v122, v48
  v_max_f32 v122, v122, v48
  v_mul_f32 v122, s60, v122
  v_fma_f32 v112, v112, s60, -v122
  v_fma_f32 v113, v113, s60, -v122
  v_fma_f32 v114, v114, s60, -v122
  v_fma_f32 v115, v115, s60, -v122
  v_exp_f32 v112, v112
  v_exp_f32 v113, v113
  v_exp_f32 v114, v114
  v_exp_f32 v115, v115
  v_cvt_pk_bf16_f32 v48, v112, v113
  v_cvt_pk_bf16_f32 v49, v114, v115
  v_fma_f32 v116, v116, s60, -v122
  v_fma_f32 v117, v117, s60, -v122
  v_fma_f32 v118, v118, s60, -v122
  v_fma_f32 v119, v119, s60, -v122
  v_mov_b32_dpp v50, v48 row_ror:8 row_mask:0xf bank_mask:0xf
  v_mov_b32_dpp v51, v49 row_ror:8 row_mask:0xf bank_mask:0xf
  v_mov_b32 v59, 0x3f803f80
  s_waitcnt vmcnt(5)
  v_mfma_f32_16x16x32_bf16 v[72:75], v[24:27], v[48:51], 0
  v_exp_f32 v116, v116
  v_mfma_f32_16x16x32_bf16 v[60:63], v[56:59], v[48:51], 0
  v_exp_f32 v117, v117
  s_waitcnt vmcnt(4)
  v_mfma_f32_16x16x32_bf16 v[76:79], v[28:31], v[48:51], 0
  v_exp_f32 v118, v118
  v_exp_f32 v119, v119
  v_cvt_pk_bf16_f32 v52, v116, v117
  v_cvt_pk_bf16_f32 v53, v118, v119
  v_mov_b32 v54, 0
  v_mov_b32 v55, 0
  v_cvt_pk_bf16_f32 v80, v64, v65
  s_nop 0
  v_mfma_f32_16x16x32_bf16 v[60:63], v[56:59], v[52:55], v[60:63]
  v_cvt_pk_bf16_f32 v81, v66, v67
  v_cvt_pk_bf16_f32 v82, v68, v69
  v_cvt_pk_bf16_f32 v83, v70, v71
  v_mov_b32 v84, 0
  v_mov_b32 v85, 0
  v_mfma_f32_16x16x32_bf16 v[72:75], v[80:83], v[52:55], v[72:75]
  buffer_store_dwordx2 v[80:81], v8, s[8:11], s62 offen offset:0 sc1
  v_mfma_f32_16x16x32_bf16 v[76:79], v[82:85], v[52:55], v[76:79]
  v_rcp_f32 v122, v60
  v_add_u32 v0, s50, v1
  v_cndmask_b32 v84, 0, v123, s[26:27]
  v_cndmask_b32 v85, 0, v123, s[28:29]
  s_nop 1
  v_mul_f32 v72, v72, v122
  v_mul_f32 v73, v73, v122
  v_mul_f32 v74, v74, v122
  v_mul_f32 v75, v75, v122
  v_mul_f32 v76, v76, v122
  v_mul_f32 v77, v77, v122
  v_mul_f32 v78, v78, v122
  v_mul_f32 v79, v79, v122
  v_cvt_pk_bf16_f32 v104, v72, v73
  v_cvt_pk_bf16_f32 v105, v74, v75
  v_cvt_pk_bf16_f32 v106, v76, v77
  v_cvt_pk_bf16_f32 v107, v78, v79
  ds_write_b128 v14, v[104:107]
  v_add_u32 v14, s48, v1
  v_mfma_f32_16x16x32_bf16 v[48:51], v[208:211], v[104:107], 0
  buffer_store_dwordx2 v[82:83], v8, s[8:11], s62 offen offset:512 sc1
  v_cndmask_b32 v86, 0, v123, s[30:31]
  v_mfma_f32_16x16x32_bf16 v[52:55], v[212:215], v[104:107], 0
  s_add_u32 s62, s62, 262144
  v_cndmask_b32 v87, 0, v123, s[32:33]
  v_mfma_f32_16x16x32_bf16 v[56:59], v[216:219], v[104:107], 0
  v_mfma_f32_16x16x32_bf16 v[60:63], v[220:223], v[104:107], 0
  s_waitcnt lgkmcnt(0)
  s_barrier
  ds_read_b128 v[80:83], v14
  v_mfma_f32_16x16x32_bf16 v[64:67], v[224:227], v[104:107], 0
  ds_read_b128 v[108:111], v15
  ds_read_b128 v[76:79], v0
  v_mfma_f32_16x16x32_bf16 v[68:71], v[228:231], v[104:107], 0
  v_mfma_f32_16x16x32_bf16 v[112:115], v[232:235], v[104:107], 0
  v_mfma_f32_16x16x32_bf16 v[116:119], v[236:239], v[104:107], 0
  s_waitcnt lgkmcnt(2)
  v_mfma_f32_16x16x32_bf16 v[48:51], v[240:243], v[80:83], v[48:51]
  s_waitcnt lgkmcnt(1)
  v_mfma_f32_16x16x32_bf16 v[48:51], v[248:251], v[108:111], v[48:51]
  s_waitcnt lgkmcnt(0)
  v_mfma_f32_16x16x32_bf16 v[48:51], v[88:91], v[76:79], v[48:51]
  ds_read_b128 v[88:91], v10 offset:20480
  v_mfma_f32_16x16x32_bf16 v[52:55], v[244:247], v[80:83], v[52:55]
  v_mfma_f32_16x16x32_bf16 v[52:55], v[252:255], v[108:111], v[52:55]
  v_mfma_f32_16x16x32_bf16 v[52:55], v[92:95], v[76:79], v[52:55]
  ds_read_b128 v[92:95], v10 offset:22528
  s_nop 2
  v_cvt_pk_bf16_f32 v24, v48, v49
  v_mfma_f32_16x16x32_bf16 v[56:59], v[96:99], v[80:83], v[56:59]
  ds_read_b128 v[96:99], v10 offset:24576
  v_cvt_pk_bf16_f32 v25, v50, v51
  v_mfma_f32_16x16x32_bf16 v[56:59], v[100:103], v[108:111], v[56:59]
  ds_read_b128 v[100:103], v10 offset:21504
  v_bfi_b32 v24, 1, s69, v24
  v_mfma_f32_16x16x32_bf16 v[56:59], v[32:35], v[76:79], v[56:59]
  ds_read_b128 v[32:35], v10 offset:23552
  v_cvt_pk_bf16_f32 v26, v52, v53
  v_mfma_f32_16x16x32_bf16 v[60:63], v[36:39], v[80:83], v[60:63]
  ds_read_b128 v[36:39], v10 offset:25600
  v_cvt_pk_bf16_f32 v27, v54, v55
  v_mfma_f32_16x16x32_bf16 v[60:63], v[40:43], v[108:111], v[60:63]
  s_waitcnt vmcnt(5)
  s_mov_b64 exec, s[22:23]
  buffer_store_dwordx4 v[24:27], v3, s[8:11], s64 offen
  s_mov_b64 exec, -1
  s_nop 0
  v_mfma_f32_16x16x32_bf16 v[60:63], v[44:47], v[76:79], v[60:63]
  ds_read_b128 v[40:43], v10 offset:26624
  v_cvt_pk_bf16_f32 v28, v56, v57
  s_waitcnt lgkmcnt(6)
  v_mfma_f32_16x16x32_bf16 v[64:67], v[88:91], v[80:83], v[64:67]
  ds_read_b128 v[44:47], v10 offset:28672
  v_cvt_pk_bf16_f32 v29, v58, v59
  s_waitcnt lgkmcnt(6)
  v_mfma_f32_16x16x32_bf16 v[64:67], v[92:95], v[108:111], v[64:67]
  ds_read_b128 v[88:91], v10 offset:30720
  v_bfi_b32 v28, 1, s69, v28
  ds_read_b128 v[92:95], v10 offset:27648
  s_waitcnt lgkmcnt(7)
  v_mfma_f32_16x16x32_bf16 v[64:67], v[96:99], v[76:79], v[64:67]
  ds_read_b128 v[96:99], v10 offset:29696
  v_cvt_pk_bf16_f32 v30, v60, v61
  s_waitcnt lgkmcnt(7)
  v_mfma_f32_16x16x32_bf16 v[68:71], v[100:103], v[80:83], v[68:71]
  ds_read_b128 v[100:103], v10 offset:31744
  v_cvt_pk_bf16_f32 v31, v62, v63
  s_waitcnt lgkmcnt(7)
  v_mfma_f32_16x16x32_bf16 v[68:71], v[32:35], v[108:111], v[68:71]
  s_mov_b64 exec, s[22:23]
  buffer_store_dwordx4 v[28:31], v3, s[8:11], s65 offen
  s_mov_b64 exec, -1
  s_waitcnt lgkmcnt(6)
  v_mfma_f32_16x16x32_bf16 v[68:71], v[36:39], v[76:79], v[68:71]
  v_cvt_pk_bf16_f32 v24, v64, v65
  s_waitcnt lgkmcnt(5)
  v_mfma_f32_16x16x32_bf16 v[112:115], v[40:43], v[80:83], v[112:115]
  v_cvt_pk_bf16_f32 v25, v66, v67
  s_waitcnt lgkmcnt(4)
  v_mfma_f32_16x16x32_bf16 v[112:115], v[44:47], v[108:111], v[112:115]
  v_bfi_b32 v24, 1, s69, v24
  s_waitcnt lgkmcnt(3)
  v_mfma_f32_16x16x32_bf16 v[112:115], v[88:91], v[76:79], v[112:115]
  v_cvt_pk_bf16_f32 v26, v68, v69
  s_waitcnt lgkmcnt(2)
  v_mfma_f32_16x16x32_bf16 v[116:119], v[92:95], v[80:83], v[116:119]
  v_cvt_pk_bf16_f32 v27, v70, v71
  s_waitcnt lgkmcnt(1)
  v_mfma_f32_16x16x32_bf16 v[116:119], v[96:99], v[108:111], v[116:119]
  s_mov_b64 exec, s[22:23]
  buffer_store_dwordx4 v[24:27], v3, s[8:11], s66 offen
  s_mov_b64 exec, -1
  s_waitcnt lgkmcnt(0)
  v_mfma_f32_16x16x32_bf16 v[116:119], v[100:103], v[76:79], v[116:119]
  v_cvt_pk_bf16_f32 v28, v112, v113
  v_cvt_pk_bf16_f32 v29, v114, v115
  v_bfi_b32 v28, 1, s69, v28
  s_nop 4
  v_cvt_pk_bf16_f32 v30, v116, v117
  v_cvt_pk_bf16_f32 v31, v118, v119
  s_mov_b64 exec, s[22:23]
  buffer_store_dwordx4 v[28:31], v3, s[8:11], s67 offen
  s_mov_b64 exec, -1
  s_waitcnt vmcnt(0)
  s_cmp_eq_u32 s18, 63
  s_cbranch_scc1 CH_LAST
  buffer_load_dwordx4 v[88:91], v4, s[8:11], s51 offen offset:0 sc1
  buffer_load_dwordx4 v[92:95], v4, s[8:11], s51 offen offset:256 sc1
  s_waitcnt lgkmcnt(0)
  s_waitcnt vmcnt(1)
  v_and_b32 v122, 1, v88
  v_cmp_ne_u32 vcc, s69, v122
  s_nop 0
  s_cbranch_vccnz CH_RSLOW0
CH_ROK0:
  v_mfma_f32_16x16x32_bf16 v[48:51], v[84:87], v[88:91], 0
  s_waitcnt vmcnt(0)
  v_and_b32 v122, 1, v92
  v_cmp_ne_u32 vcc, s69, v122
  s_nop 0
  s_cbranch_vccnz CH_RSLOW1
CH_ROK1:
  v_mfma_f32_16x16x32_bf16 v[48:51], v[84:87], v[92:95], v[48:51]
  s_mov_b32 s52, s53
  s_add_u32 s18, s18, 1
  s_xor_b32 s51, s51, 0x40000
  s_lshr_b32 s69, s18, 1
  s_and_b32 s69, s69, 1
  s_xor_b32 s53, s53, 0x2000
  s_xor_b32 s64, s64, 0x40000
  s_xor_b32 s65, s65, 0x40000
  s_xor_b32 s66, s66, 0x40000
  s_xor_b32 s67, s67, 0x40000
  v_add_f32_dpp v48, v48, v48 row_ror:4 row_mask:0xf bank_mask:0xf
  v_add_f32_dpp v49, v49, v49 row_ror:4 row_mask:0xf bank_mask:0xf
  v_add_f32_dpp v50, v50, v50 row_ror:4 row_mask:0xf bank_mask:0xf
  v_add_f32_dpp v51, v51, v51 row_ror:4 row_mask:0xf bank_mask:0xf
  v_add_f32_dpp v48, v48, v48 row_ror:8 row_mask:0xf bank_mask:0xf
  v_add_f32_dpp v49, v49, v49 row_ror:8 row_mask:0xf bank_mask:0xf
  v_add_f32_dpp v50, v50, v50 row_ror:8 row_mask:0xf bank_mask:0xf
  v_add_f32_dpp v51, v51, v51 row_ror:8 row_mask:0xf bank_mask:0xf
  v_cvt_pk_bf16_f32 v48, v48, v49
  v_cvt_pk_bf16_f32 v49, v50, v51
  v_min_u32 v48, 0xfffffffe, v48
  v_min_u32 v49, 0xfffffffe, v49
  s_mov_b64 exec, s[24:25]
  buffer_store_dwordx2 v[48:49], v5, s[8:11], s52 offen
  s_mov_b64 exec, -1
  ds_read_b128 v[104:107], v10 offset:0
  ds_read_b128 v[108:111], v10 offset:1024
  ds_read_b128 v[112:115], v10 offset:2048
  ds_read_b128 v[116:119], v10 offset:3072
  s_waitcnt vmcnt(0)
  buffer_load_dwordx4 v[72:75], v12, s[8:11], s52 offen offset:0 sc1
  buffer_load_dwordx4 v[76:79], v12, s[8:11], s52 offen offset:512 sc1
  buffer_load_dwordx4 v[80:83], v12, s[8:11], s52 offen offset:1024 sc1
  buffer_load_dwordx4 v[84:87], v12, s[8:11], s52 offen offset:1536 sc1
  s_waitcnt lgkmcnt(0)
  s_branch CH_LOOP
CH_LAST:
  v_mov_b32 v121, 1
  s_mov_b64 exec, 1
  buffer_store_dword v121, v9, s[8:11], s63 offen sc1
  s_mov_b64 exec, -1
  s_endpgm
CH_GSLOW0:
  buffer_load_dwordx4 v[72:75], v12, s[8:11], s52 offen offset:0 sc1
  buffer_load_dwordx4 v[76:79], v12, s[8:11], s52 offen offset:512 sc1
  buffer_load_dwordx4 v[80:83], v12, s[8:11], s52 offen offset:1024 sc1
  buffer_load_dwordx4 v[84:87], v12, s[8:11], s52 offen offset:1536 sc1
  s_waitcnt vmcnt(3)
  v_max3_u32 v122, v72, v73, v74
  v_max_u32 v122, v122, v75
  v_cmp_eq_u32 vcc, -1, v122
  s_nop 0
  s_cbranch_vccz CH_GOK0
  s_cmp_eq_u32 s19, 0
  s_cbranch_scc1 CH_GOK0
  s_sub_u32 s19, s19, 1
  s_branch CH_GSLOW0
CH_GSLOW1:
  buffer_load_dwordx4 v[76:79], v12, s[8:11], s52 offen offset:512 sc1
  buffer_load_dwordx4 v[80:83], v12, s[8:11], s52 offen offset:1024 sc1
  buffer_load_dwordx4 v[84:87], v12, s[8:11], s52 offen offset:1536 sc1
  s_waitcnt vmcnt(2)
  v_max3_u32 v122, v76, v77, v78
  v_max_u32 v122, v122, v79
  v_cmp_eq_u32 vcc, -1, v122
  s_nop 0
  s_cbranch_vccz CH_GOK1
  s_cmp_eq_u32 s19, 0
  s_cbranch_scc1 CH_GOK1
  s_sub_u32 s19, s19, 1
  s_branch CH_GSLOW1
CH_GSLOW2:
  buffer_load_dwordx4 v[80:83], v12, s[8:11], s52 offen offset:1024 sc1
  buffer_load_dwordx4 v[84:87], v12, s[8:11], s52 offen offset:1536 sc1
  s_waitcnt vmcnt(1)
  v_max3_u32 v122, v80, v81, v82
  v_max_u32 v122, v122, v83
  v_cmp_eq_u32 vcc, -1, v122
  s_nop 0
  s_cbranch_vccz CH_GOK2
  s_cmp_eq_u32 s19, 0
  s_cbranch_scc1 CH_GOK2
  s_sub_u32 s19, s19, 1
  s_branch CH_GSLOW2
CH_GSLOW3:
  buffer_load_dwordx4 v[84:87], v12, s[8:11], s52 offen offset:1536 sc1
  s_waitcnt vmcnt(0)
  v_max3_u32 v122, v84, v85, v86
  v_max_u32 v122, v122, v87
  v_cmp_eq_u32 vcc, -1, v122
  s_nop 0
  s_cbranch_vccz CH_GOK3
  s_cmp_eq_u32 s19, 0
  s_cbranch_scc1 CH_GOK3
  s_sub_u32 s19, s19, 1
  s_branch CH_GSLOW3
CH_RSLOW0:
  buffer_load_dwordx4 v[88:91], v4, s[8:11], s51 offen offset:0 sc1
  buffer_load_dwordx4 v[92:95], v4, s[8:11], s51 offen offset:256 sc1
  s_waitcnt vmcnt(1)
  v_and_b32 v122, 1, v88
  v_cmp_ne_u32 vcc, s69, v122
  s_nop 0
  s_cbranch_vccz CH_ROK0
  s_cmp_eq_u32 s19, 0
  s_cbranch_scc1 CH_ROK0
  s_sub_u32 s19, s19, 1
  s_branch CH_RSLOW0
CH_RSLOW1:
  buffer_load_dwordx4 v[92:95], v4, s[8:11], s51 offen offset:256 sc1
  s_waitcnt vmcnt(0)
  v_and_b32 v122, 1, v92
  v_cmp_ne_u32 vcc, s69, v122
  s_nop 0
  s_cbranch_vccz CH_ROK1
  s_cmp_eq_u32 s19, 0
  s_cbranch_scc1 CH_ROK1
  s_sub_u32 s19, s19, 1
  s_branch CH_RSLOW1
CH_LATE:
  s_sub_u32 s35, s61, 8192
CH_LATE_SPIN:
  buffer_load_dword v88, v9, s[8:11], s35 offen sc1
  s_waitcnt vmcnt(0)
  v_cmp_ne_u32 vcc, 0, v88
  s_nop 0
  s_cmp_lg_u32 vcc_lo, 0
  s_cbranch_scc1 CH_LATE_OK
  s_cmp_eq_u32 s19, 0
  s_cbranch_scc1 CH_LATE_OK
  s_sub_u32 s19, s19, 1
  s_sleep 1
  s_branch CH_LATE_SPIN
CH_LATE_OK:
  buffer_load_dwordx4 v[16:19], v6, s[8:11], s54 offen offset:0 sc1
  buffer_load_dwordx4 v[20:23], v6, s[8:11], s54 offen offset:1024 sc1
  s_waitcnt vmcnt(0)
  s_branch CH_NOLATE
ROLE_QA:
  s_and_b32 s70, s17, 31
  s_lshr_b32 s71, s17, 5
  v_and_b32 v14, 63, v0
  v_lshlrev_b32 v1, 4, v14
  v_and_b32 v15, 15, v14
  v_lshrrev_b32 v13, 4, v14
  v_lshlrev_b32 v2, 10, v15
  v_lshl_add_u32 v2, v13, 4, v2
  v_and_b32 v3, 15, v14
  v_lshlrev_b32 v3, 6, v3
  v_and_b32 v4, 3, v14
  v_lshlrev_b32 v4, 2, v4
  s_lshl_b32 s34, s70, 4
  v_add_u32 v4, s34, v4
  v_mov_b32 v5, 1
  s_lshl_b32 s34, s70, 2
  s_add_u32 s34, s34, s16
  s_lshl_b32 s35, s34, 12
  v_add_u32 v6, s35, v1
  s_lshl_b32 s35, s34, 6
  v_mov_b32 v7, s35
  s_and_b32 s35, s16, 1
  s_lshl_b32 s35, s35, 12
  s_lshl_b32 s36, s70, 13
  s_add_u32 s35, s35, s36
  s_lshr_b32 s36, s16, 1
  s_lshl_b32 s36, s36, 11
  s_add_u32 s35, s35, s36
  v_add_u32 v9, s35, v1
  s_lshl_b32 s36, s70, 13
  v_add_u32 v10, s36, v1
  v_lshlrev_b32 v11, 3, v14
  s_lshr_b32 s37, s16, 1
  s_lshl_b32 s37, s37, 12
  s_add_u32 s36, s36, s37
  s_add_u32 s36, s36, 1024
  v_add_u32 v11, s36, v11
  s_lshl_b32 s36, s16, 10
  v_add_u32 v12, s36, v1
  s_and_b32 s35, s16, 1
  s_lshl_b32 s35, s35, 4
  v_add_u32 v15, s35, v15
  v_lshlrev_b32 v13, 2, v13
  v_mov_b32 v8, 0xf149f2ca
  v_add_u32 v14, 0, v13
  v_cmp_le_u32 vcc, v14, v15
  s_nop 1
  v_cndmask_b32 v16, v8, 0, vcc
  v_add_u32 v14, 1, v13
  v_cmp_le_u32 vcc, v14, v15
  s_nop 1
  v_cndmask_b32 v17, v8, 0, vcc
  v_add_u32 v14, 2, v13
  v_cmp_le_u32 vcc, v14, v15
  s_nop 1
  v_cndmask_b32 v18, v8, 0, vcc
  v_add_u32 v14, 3, v13
  v_cmp_le_u32 vcc, v14, v15
  s_nop 1
  v_cndmask_b32 v19, v8, 0, vcc
  v_add_u32 v14, 16, v13
  v_cmp_le_u32 vcc, v14, v15
  s_nop 1
  v_cndmask_b32 v20, v8, 0, vcc
  v_add_u32 v14, 17, v13
  v_cmp_le_u32 vcc, v14, v15
  s_nop 1
  v_cndmask_b32 v21, v8, 0, vcc
  v_add_u32 v14, 18, v13
  v_cmp_le_u32 vcc, v14, v15
  s_nop 1
  v_cndmask_b32 v22, v8, 0, vcc
  v_add_u32 v14, 19, v13
  v_cmp_le_u32 vcc, v14, v15
  s_nop 1
  v_cndmask_b32 v23, v8, 0, vcc
  s_mov_b32 s20, -1
  s_mov_b32 s21, 0
  s_mov_b32 s22, 0
  s_mov_b32 s23, -1
  s_mov_b32 s60, 1040356334
  s_cmp_eq_u32 s71, 0
  s_cbranch_scc1 QA_NOSTAGE_5
  s_call_b64 s[100:101], VERIFY
  s_cbranch_scc1 VER_OK_7
  v_mov_b32 v0, v116
  s_waitcnt vmcnt(0) lgkmcnt(0)
  s_barrier
  s_branch DISPATCH
VER_OK_7:
  v_mbcnt_lo_u32_b32 v116, -1, 0
  v_mbcnt_hi_u32_b32 v116, -1, v116
  v_and_b32 v116, 31, v116
  v_lshlrev_b32 v116, 6, v116
  s_mov_b32 s44, 24805376
QA_GOSPIN_6:
  buffer_load_dword v117, v116, s[8:11], s44 offen sc1
  s_waitcnt vmcnt(0)
  v_cmp_eq_u32 vcc, 0, v117
  s_nop 0
  s_cbranch_vccz QA_NOSTAGE_5
  s_cmp_eq_u32 s19, 0
  s_cbranch_scc1 QA_NOSTAGE_5
  s_sub_u32 s19, s19, 1
  s_sleep 8
  s_branch QA_GOSPIN_6
QA_NOSTAGE_5:
  s_lshl_b32 s41, s16, 15
  v_and_b32 v14, 63, v0
  v_lshrrev_b32 v100, 4, v14
  v_lshlrev_b32 v100, 3, v100
  v_lshrrev_b32 v102, 2, v14
  v_and_b32 v102, 3, v102
  v_add_u32 v100, v100, v102
  v_lshlrev_b32 v100, 6, v100
  v_and_b32 v102, 3, v14
  v_lshl_add_u32 v100, v102, 4, v100
  v_add_u32 v100, s41, v100
  v_lshrrev_b32 v102, 2, v14
  s_mov_b32 s40, 8192
  v_mul_lo_u32 v102, v102, s40
  v_and_b32 v101, 3, v14
  v_lshl_add_u32 v102, v101, 4, v102
  s_lshl_b32 s44, s70, 8
  s_lshl_b32 s45, s16, 6
  s_add_u32 s44, s44, s45
  s_load_dwordx2 s[42:43], s[0:1], 24
  s_waitcnt lgkmcnt(0)
  s_mov_b32 s36, s42
  s_and_b32 s37, s43, 0xffff
  s_mov_b32 s38, 4194304
  s_mov_b32 s39, 0x20000
  s_add_u32 s40, s44, 0
  s_add_u32 m0, s41, 0
  s_nop 0
  buffer_load_dwordx4 v102, s[36:39], s40 offen lds
  s_add_u32 s40, s40, 131072
  s_add_u32 m0, s41, 1024
  s_nop 0
  buffer_load_dwordx4 v102, s[36:39], s40 offen lds
  s_add_u32 s40, s44, 262144
  s_add_u32 m0, s41, 2048
  s_nop 0
  buffer_load_dwordx4 v102, s[36:39], s40 offen lds
  s_add_u32 s40, s40, 131072
  s_add_u32 m0, s41, 3072
  s_nop 0
  buffer_load_dwordx4 v102, s[36:39], s40 offen lds
  s_add_u32 s40, s44, 524288
  s_add_u32 m0, s41, 4096
  s_nop 0
  buffer_load_dwordx4 v102, s[36:39], s40 offen lds
  s_add_u32 s40, s40, 131072
  s_add_u32 m0, s41, 5120
  s_nop 0
  buffer_load_dwordx4 v102, s[36:39], s40 offen lds
  s_add_u32 s40, s44, 786432
  s_add_u32 m0, s41, 6144
  s_nop 0
  buffer_load_dwordx4 v102, s[36:39], s40 offen lds
  s_add_u32 s40, s40, 131072
  s_add_u32 m0, s41, 7168
  s_nop 0
  buffer_load_dwordx4 v102, s[36:39], s40 offen lds
  s_add_u32 s40, s44, 1048576
  s_add_u32 m0, s41, 8192
  s_nop 0
  buffer_load_dwordx4 v102, s[36:39], s40 offen lds
  s_add_u32 s40, s40, 131072
  s_add_u32 m0, s41, 9216
  s_nop 0
  buffer_load_dwordx4 v102, s[36:39], s40 offen lds
  s_add_u32 s40, s44, 1310720
  s_add_u32 m0, s41, 10240
  s_nop 0
  buffer_load_dwordx4 v102, s[36:39], s40 offen lds
  s_add_u32 s40, s40, 131072
  s_add_u32 m0, s41, 11264
  s_nop 0
  buffer_load_dwordx4 v102, s[36:39], s40 offen lds
  s_add_u32 s40, s44, 1572864
  s_add_u32 m0, s41, 12288
  s_nop 0
  buffer_load_dwordx4 v102, s[36:39], s40 offen lds
  s_add_u32 s40, s40, 131072
  s_add_u32 m0, s41, 13312
  s_nop 0
  buffer_load_dwordx4 v102, s[36:39], s40 offen lds
  s_add_u32 s40, s44, 1835008
  s_add_u32 m0, s41, 14336
  s_nop 0
  buffer_load_dwordx4 v102, s[36:39], s40 offen lds
  s_add_u32 s40, s40, 131072
  s_add_u32 m0, s41, 15360
  s_nop 0
  buffer_load_dwordx4 v102, s[36:39], s40 offen lds
  s_add_u32 s40, s44, 2097152
  s_add_u32 m0, s41, 16384
  s_nop 0
  buffer_load_dwordx4 v102, s[36:39], s40 offen lds
  s_add_u32 s40, s40, 131072
  s_add_u32 m0, s41, 17408
  s_nop 0
  buffer_load_dwordx4 v102, s[36:39], s40 offen lds
  s_add_u32 s40, s44, 2359296
  s_add_u32 m0, s41, 18432
  s_nop 0
  buffer_load_dwordx4 v102, s[36:39], s40 offen lds
  s_add_u32 s40, s40, 131072
  s_add_u32 m0, s41, 19456
  s_nop 0
  buffer_load_dwordx4 v102, s[36:39], s40 offen lds
  s_add_u32 s40, s44, 2621440
  s_add_u32 m0, s41, 20480
  s_nop 0
  buffer_load_dwordx4 v102, s[36:39], s40 offen lds
  s_add_u32 s40, s40, 131072
  s_add_u32 m0, s41, 21504
  s_nop 0
  buffer_load_dwordx4 v102, s[36:39], s40 offen lds
  s_add_u32 s40, s44, 2883584
  s_add_u32 m0, s41, 22528
  s_nop 0
  buffer_load_dwordx4 v102, s[36:39], s40 offen lds
  s_add_u32 s40, s40, 131072
  s_add_u32 m0, s41, 23552
  s_nop 0
  buffer_load_dwordx4 v102, s[36:39], s40 offen lds
  s_add_u32 s40, s44, 3145728
  s_add_u32 m0, s41, 24576
  s_nop 0
  buffer_load_dwordx4 v102, s[36:39], s40 offen lds
  s_add_u32 s40, s40, 131072
  s_add_u32 m0, s41, 25600
  s_nop 0
  buffer_load_dwordx4 v102, s[36:39], s40 offen lds
  s_add_u32 s40, s44, 3407872
  s_add_u32 m0, s41, 26624
  s_nop 0
  buffer_load_dwordx4 v102, s[36:39], s40 offen lds
  s_add_u32 s40, s40, 131072
  s_add_u32 m0, s41, 27648
  s_nop 0
  buffer_load_dwordx4 v102, s[36:39], s40 offen lds
  s_add_u32 s40, s44, 3670016
  s_add_u32 m0, s41, 28672
  s_nop 0
  buffer_load_dwordx4 v102, s[36:39], s40 offen lds
  s_add_u32 s40, s40, 131072
  s_add_u32 m0, s41, 29696
  s_nop 0
  buffer_load_dwordx4 v102, s[36:39], s40 offen lds
  s_add_u32 s40, s44, 3932160
  s_add_u32 m0, s41, 30720
  s_nop 0
  buffer_load_dwordx4 v102, s[36:39], s40 offen lds
  s_add_u32 s40, s40, 131072
  s_add_u32 m0, s41, 31744
  s_nop 0
  buffer_load_dwordx4 v102, s[36:39], s40 offen lds
  s_waitcnt vmcnt(16)
  ds_read_b64_tr_b16 a[128:129], v100 offset:0
  ds_read_b64_tr_b16 a[130:131], v100 offset:256
  ds_read_b64_tr_b16 a[192:193], v100 offset:8
  ds_read_b64_tr_b16 a[194:195], v100 offset:264
  ds_read_b64_tr_b16 a[132:133], v100 offset:2048
  ds_read_b64_tr_b16 a[134:135], v100 offset:2304
  ds_read_b64_tr_b16 a[196:197], v100 offset:2056
  ds_read_b64_tr_b16 a[198:199], v100 offset:2312
  s_waitcnt lgkmcnt(4)
  ds_read_b64_tr_b16 a[136:137], v100 offset:4096
  ds_read_b64_tr_b16 a[138:139], v100 offset:4352
  ds_read_b64_tr_b16 a[200:201], v100 offset:4104
  ds_read_b64_tr_b16 a[202:203], v100 offset:4360
  ds_read_b64_tr_b16 a[140:141], v100 offset:6144
  ds_read_b64_tr_b16 a[142:143], v100 offset:6400
  ds_read_b64_tr_b16 a[204:205], v100 offset:6152
  ds_read_b64_tr_b16 a[206:207], v100 offset:6408
  s_waitcnt lgkmcnt(4)
  ds_read_b64_tr_b16 a[144:145], v100 offset:8192
  ds_read_b64_tr_b16 a[146:147], v100 offset:8448
  ds_read_b64_tr_b16 a[208:209], v100 offset:8200
  ds_read_b64_tr_b16 a[210:211], v100 offset:8456
  ds_read_b64_tr_b16 a[148:149], v100 offset:10240
  ds_read_b64_tr_b16 a[150:151], v100 offset:10496
  ds_read_b64_tr_b16 a[212:213], v100 offset:10248
  ds_read_b64_tr_b16 a[214:215], v100 offset:10504
  s_waitcnt lgkmcnt(4)
  ds_read_b64_tr_b16 a[152:153], v100 offset:12288
  ds_read_b64_tr_b16 a[154:155], v100 offset:12544
  ds_read_b64_tr_b16 a[216:217], v100 offset:12296
  ds_read_b64_tr_b16 a[218:219], v100 offset:12552
  ds_read_b64_tr_b16 a[156:157], v100 offset:14336
  ds_read_b64_tr_b16 a[158:159], v100 offset:14592
  ds_read_b64_tr_b16 a[220:221], v100 offset:14344
  ds_read_b64_tr_b16 a[222:223], v100 offset:14600
  s_waitcnt lgkmcnt(4)
  s_waitcnt lgkmcnt(0)
  s_load_dwordx2 s[42:43], s[0:1], 32
  s_waitcnt lgkmcnt(0)
  s_mov_b32 s36, s42
  s_and_b32 s37, s43, 0xffff
  s_mov_b32 s38, 4194304
  s_mov_b32 s39, 0x20000
  s_add_u32 s40, s44, 0
  s_add_u32 m0, s41, 0
  s_nop 0
  buffer_load_dwordx4 v102, s[36:39], s40 offen lds
  s_add_u32 s40, s40, 131072
  s_add_u32 m0, s41, 1024
  s_nop 0
  buffer_load_dwordx4 v102, s[36:39], s40 offen lds
  s_add_u32 s40, s44, 262144
  s_add_u32 m0, s41, 2048
  s_nop 0
  buffer_load_dwordx4 v102, s[36:39], s40 offen lds
  s_add_u32 s40, s40, 131072
  s_add_u32 m0, s41, 3072
  s_nop 0
  buffer_load_dwordx4 v102, s[36:39], s40 offen lds
  s_add_u32 s40, s44, 524288
  s_add_u32 m0, s41, 4096
  s_nop 0
  buffer_load_dwordx4 v102, s[36:39], s40 offen lds
  s_add_u32 s40, s40, 131072
  s_add_u32 m0, s41, 5120
  s_nop 0
  buffer_load_dwordx4 v102, s[36:39], s40 offen lds
  s_add_u32 s40, s44, 786432
  s_add_u32 m0, s41, 6144
  s_nop 0
  buffer_load_dwordx4 v102, s[36:39], s40 offen lds
  s_add_u32 s40, s40, 131072
  s_add_u32 m0, s41, 7168
  s_nop 0
  buffer_load_dwordx4 v102, s[36:39], s40 offen lds
  s_add_u32 s40, s44, 1048576
  s_add_u32 m0, s41, 8192
  s_nop 0
  buffer_load_dwordx4 v102, s[36:39], s40 offen lds
  s_add_u32 s40, s40, 131072
  s_add_u32 m0, s41, 9216
  s_nop 0
  buffer_load_dwordx4 v102, s[36:39], s40 offen lds
  s_add_u32 s40, s44, 1310720
  s_add_u32 m0, s41, 10240
  s_nop 0
  buffer_load_dwordx4 v102, s[36:39], s40 offen lds
  s_add_u32 s40, s40, 131072
  s_add_u32 m0, s41, 11264
  s_nop 0
  buffer_load_dwordx4 v102, s[36:39], s40 offen lds
  s_add_u32 s40, s44, 1572864
  s_add_u32 m0, s41, 12288
  s_nop 0
  buffer_load_dwordx4 v102, s[36:39], s40 offen lds
  s_add_u32 s40, s40, 131072
  s_add_u32 m0, s41, 13312
  s_nop 0
  buffer_load_dwordx4 v102, s[36:39], s40 offen lds
  s_add_u32 s40, s44, 1835008
  s_add_u32 m0, s41, 14336
  s_nop 0
  buffer_load_dwordx4 v102, s[36:39], s40 offen lds
  s_add_u32 s40, s40, 131072
  s_add_u32 m0, s41, 15360
  s_nop 0
  buffer_load_dwordx4 v102, s[36:39], s40 offen lds
  s_waitcnt vmcnt(16)
  ds_read_b64_tr_b16 a[160:161], v100 offset:16384
  ds_read_b64_tr_b16 a[162:163], v100 offset:16640
  ds_read_b64_tr_b16 a[224:225], v100 offset:16392
  ds_read_b64_tr_b16 a[226:227], v100 offset:16648
  ds_read_b64_tr_b16 a[164:165], v100 offset:18432
  ds_read_b64_tr_b16 a[166:167], v100 offset:18688
  ds_read_b64_tr_b16 a[228:229], v100 offset:18440
  ds_read_b64_tr_b16 a[230:231], v100 offset:18696
  s_waitcnt lgkmcnt(4)
  ds_read_b64_tr_b16 a[168:169], v100 offset:20480
  ds_read_b64_tr_b16 a[170:171], v100 offset:20736
  ds_read_b64_tr_b16 a[232:233], v100 offset:20488
  ds_read_b64_tr_b16 a[234:235], v100 offset:20744
  ds_read_b64_tr_b16 a[172:173], v100 offset:22528
  ds_read_b64_tr_b16 a[174:175], v100 offset:22784
  ds_read_b64_tr_b16 a[236:237], v100 offset:22536
  ds_read_b64_tr_b16 a[238:239], v100 offset:22792
  s_waitcnt lgkmcnt(4)
  ds_read_b64_tr_b16 a[176:177], v100 offset:24576
  ds_read_b64_tr_b16 a[178:179], v100 offset:24832
  ds_read_b64_tr_b16 a[240:241], v100 offset:24584
  ds_read_b64_tr_b16 a[242:243], v100 offset:24840
  ds_read_b64_tr_b16 a[180:181], v100 offset:26624
  ds_read_b64_tr_b16 a[182:183], v100 offset:26880
  ds_read_b64_tr_b16 a[244:245], v100 offset:26632
  ds_read_b64_tr_b16 a[246:247], v100 offset:26888
  s_waitcnt lgkmcnt(4)
  ds_read_b64_tr_b16 a[184:185], v100 offset:28672
  ds_read_b64_tr_b16 a[186:187], v100 offset:28928
  ds_read_b64_tr_b16 a[248:249], v100 offset:28680
  ds_read_b64_tr_b16 a[250:251], v100 offset:28936
  ds_read_b64_tr_b16 a[188:189], v100 offset:30720
  ds_read_b64_tr_b16 a[190:191], v100 offset:30976
  ds_read_b64_tr_b16 a[252:253], v100 offset:30728
  ds_read_b64_tr_b16 a[254:255], v100 offset:30984
  s_waitcnt lgkmcnt(4)
  s_waitcnt lgkmcnt(0)
  s_add_u32 s40, s44, 2097152
  s_add_u32 m0, s41, 16384
  s_nop 0
  buffer_load_dwordx4 v102, s[36:39], s40 offen lds
  s_add_u32 s40, s40, 131072
  s_add_u32 m0, s41, 17408
  s_nop 0
  buffer_load_dwordx4 v102, s[36:39], s40 offen lds
  s_add_u32 s40, s44, 2359296
  s_add_u32 m0, s41, 18432
  s_nop 0
  buffer_load_dwordx4 v102, s[36:39], s40 offen lds
  s_add_u32 s40, s40, 131072
  s_add_u32 m0, s41, 19456
  s_nop 0
  buffer_load_dwordx4 v102, s[36:39], s40 offen lds
  s_add_u32 s40, s44, 2621440
  s_add_u32 m0, s41, 20480
  s_nop 0
  buffer_load_dwordx4 v102, s[36:39], s40 offen lds
  s_add_u32 s40, s40, 131072
  s_add_u32 m0, s41, 21504
  s_nop 0
  buffer_load_dwordx4 v102, s[36:39], s40 offen lds
  s_add_u32 s40, s44, 2883584
  s_add_u32 m0, s41, 22528
  s_nop 0
  buffer_load_dwordx4 v102, s[36:39], s40 offen lds
  s_add_u32 s40, s40, 131072
  s_add_u32 m0, s41, 23552
  s_nop 0
  buffer_load_dwordx4 v102, s[36:39], s40 offen lds
  s_add_u32 s40, s44, 3145728
  s_add_u32 m0, s41, 24576
  s_nop 0
  buffer_load_dwordx4 v102, s[36:39], s40 offen lds
  s_add_u32 s40, s40, 131072
  s_add_u32 m0, s41, 25600
  s_nop 0
  buffer_load_dwordx4 v102, s[36:39], s40 offen lds
  s_add_u32 s40, s44, 3407872
  s_add_u32 m0, s41, 26624
  s_nop 0
  buffer_load_dwordx4 v102, s[36:39], s40 offen lds
  s_add_u32 s40, s40, 131072
  s_add_u32 m0, s41, 27648
  s_nop 0
  buffer_load_dwordx4 v102, s[36:39], s40 offen lds
  s_add_u32 s40, s44, 3670016
  s_add_u32 m0, s41, 28672
  s_nop 0
  buffer_load_dwordx4 v102, s[36:39], s40 offen lds
  s_add_u32 s40, s40, 131072
  s_add_u32 m0, s41, 29696
  s_nop 0
  buffer_load_dwordx4 v102, s[36:39], s40 offen lds
  s_add_u32 s40, s44, 3932160
  s_add_u32 m0, s41, 30720
  s_nop 0
  buffer_load_dwordx4 v102, s[36:39], s40 offen lds
  s_add_u32 s40, s40, 131072
  s_add_u32 m0, s41, 31744
  s_nop 0
  buffer_load_dwordx4 v102, s[36:39], s40 offen lds
  s_waitcnt vmcnt(16)
  ds_read_b64_tr_b16 v[128:129], v100 offset:0
  ds_read_b64_tr_b16 v[130:131], v100 offset:256
  ds_read_b64_tr_b16 v[192:193], v100 offset:8
  ds_read_b64_tr_b16 v[194:195], v100 offset:264
  ds_read_b64_tr_b16 v[132:133], v100 offset:2048
  ds_read_b64_tr_b16 v[134:135], v100 offset:2304
  ds_read_b64_tr_b16 v[196:197], v100 offset:2056
  ds_read_b64_tr_b16 v[198:199], v100 offset:2312
  s_waitcnt lgkmcnt(4)
  ds_read_b64_tr_b16 v[136:137], v100 offset:4096
  ds_read_b64_tr_b16 v[138:139], v100 offset:4352
  ds_read_b64_tr_b16 v[200:201], v100 offset:4104
  ds_read_b64_tr_b16 v[202:203], v100 offset:4360
  ds_read_b64_tr_b16 v[140:141], v100 offset:6144
  ds_read_b64_tr_b16 v[142:143], v100 offset:6400
  ds_read_b64_tr_b16 v[204:205], v100 offset:6152
  ds_read_b64_tr_b16 v[206:207], v100 offset:6408
  s_waitcnt lgkmcnt(4)
  ds_read_b64_tr_b16 v[144:145], v100 offset:8192
  ds_read_b64_tr_b16 v[146:147], v100 offset:8448
  ds_read_b64_tr_b16 v[208:209], v100 offset:8200
  ds_read_b64_tr_b16 v[210:211], v100 offset:8456
  ds_read_b64_tr_b16 v[148:149], v100 offset:10240
  ds_read_b64_tr_b16 v[150:151], v100 offset:10496
  ds_read_b64_tr_b16 v[212:213], v100 offset:10248
  ds_read_b64_tr_b16 v[214:215], v100 offset:10504
  s_waitcnt lgkmcnt(4)
  ds_read_b64_tr_b16 v[152:153], v100 offset:12288
  ds_read_b64_tr_b16 v[154:155], v100 offset:12544
  ds_read_b64_tr_b16 v[216:217], v100 offset:12296
  ds_read_b64_tr_b16 v[218:219], v100 offset:12552
  ds_read_b64_tr_b16 v[156:157], v100 offset:14336
  ds_read_b64_tr_b16 v[158:159], v100 offset:14592
  ds_read_b64_tr_b16 v[220:221], v100 offset:14344
  ds_read_b64_tr_b16 v[222:223], v100 offset:14600
  s_waitcnt lgkmcnt(4)
  s_waitcnt lgkmcnt(0)
  s_load_dwordx2 s[42:43], s[0:1], 16
  s_waitcnt lgkmcnt(0)
  s_mov_b32 s36, s42
  s_and_b32 s37, s43, 0xffff
  s_mov_b32 s38, 4194304
  s_mov_b32 s39, 0x20000
  s_add_u32 s40, s44, 0
  s_add_u32 m0, s41, 0
  s_nop 0
  buffer_load_dwordx4 v102, s[36:39], s40 offen lds
  s_add_u32 s40, s40, 131072
  s_add_u32 m0, s41, 1024
  s_nop 0
  buffer_load_dwordx4 v102, s[36:39], s40 offen lds
  s_add_u32 s40, s44, 262144
  s_add_u32 m0, s41, 2048
  s_nop 0
  buffer_load_dwordx4 v102, s[36:39], s40 offen lds
  s_add_u32 s40, s40, 131072
  s_add_u32 m0, s41, 3072
  s_nop 0
  buffer_load_dwordx4 v102, s[36:39], s40 offen lds
  s_add_u32 s40, s44, 524288
  s_add_u32 m0, s41, 4096
  s_nop 0
  buffer_load_dwordx4 v102, s[36:39], s40 offen lds
  s_add_u32 s40, s40, 131072
  s_add_u32 m0, s41, 5120
  s_nop 0
  buffer_load_dwordx4 v102, s[36:39], s40 offen lds
  s_add_u32 s40, s44, 786432
  s_add_u32 m0, s41, 6144
  s_nop 0
  buffer_load_dwordx4 v102, s[36:39], s40 offen lds
  s_add_u32 s40, s40, 131072
  s_add_u32 m0, s41, 7168
  s_nop 0
  buffer_load_dwordx4 v102, s[36:39], s40 offen lds
  s_add_u32 s40, s44, 1048576
  s_add_u32 m0, s41, 8192
  s_nop 0
  buffer_load_dwordx4 v102, s[36:39], s40 offen lds
  s_add_u32 s40, s40, 131072
  s_add_u32 m0, s41, 9216
  s_nop 0
  buffer_load_dwordx4 v102, s[36:39], s40 offen lds
  s_add_u32 s40, s44, 1310720
  s_add_u32 m0, s41, 10240
  s_nop 0
  buffer_load_dwordx4 v102, s[36:39], s40 offen lds
  s_add_u32 s40, s40, 131072
  s_add_u32 m0, s41, 11264
  s_nop 0
  buffer_load_dwordx4 v102, s[36:39], s40 offen lds
  s_add_u32 s40, s44, 1572864
  s_add_u32 m0, s41, 12288
  s_nop 0
  buffer_load_dwordx4 v102, s[36:39], s40 offen lds
  s_add_u32 s40, s40, 131072
  s_add_u32 m0, s41, 13312
  s_nop 0
  buffer_load_dwordx4 v102, s[36:39], s40 offen lds
  s_add_u32 s40, s44, 1835008
  s_add_u32 m0, s41, 14336
  s_nop 0
  buffer_load_dwordx4 v102, s[36:39], s40 offen lds
  s_add_u32 s40, s40, 131072
  s_add_u32 m0, s41, 15360
  s_nop 0
  buffer_load_dwordx4 v102, s[36:39], s40 offen lds
  s_waitcnt vmcnt(16)
  ds_read_b64_tr_b16 v[160:161], v100 offset:16384
  ds_read_b64_tr_b16 v[162:163], v100 offset:16640
  ds_read_b64_tr_b16 v[224:225], v100 offset:16392
  ds_read_b64_tr_b16 v[226:227], v100 offset:16648
  ds_read_b64_tr_b16 v[164:165], v100 offset:18432
  ds_read_b64_tr_b16 v[166:167], v100 offset:18688
  ds_read_b64_tr_b16 v[228:229], v100 offset:18440
  ds_read_b64_tr_b16 v[230:231], v100 offset:18696
  s_waitcnt lgkmcnt(4)
  ds_read_b64_tr_b16 v[168:169], v100 offset:20480
  ds_read_b64_tr_b16 v[170:171], v100 offset:20736
  ds_read_b64_tr_b16 v[232:233], v100 offset:20488
  ds_read_b64_tr_b16 v[234:235], v100 offset:20744
  ds_read_b64_tr_b16 v[172:173], v100 offset:22528
  ds_read_b64_tr_b16 v[174:175], v100 offset:22784
  ds_read_b64_tr_b16 v[236:237], v100 offset:22536
  ds_read_b64_tr_b16 v[238:239], v100 offset:22792
  s_waitcnt lgkmcnt(4)
  ds_read_b64_tr_b16 v[176:177], v100 offset:24576
  ds_read_b64_tr_b16 v[178:179], v100 offset:24832
  ds_read_b64_tr_b16 v[240:241], v100 offset:24584
  ds_read_b64_tr_b16 v[242:243], v100 offset:24840
  ds_read_b64_tr_b16 v[180:181], v100 offset:26624
  ds_read_b64_tr_b16 v[182:183], v100 offset:26880
  ds_read_b64_tr_b16 v[244:245], v100 offset:26632
  ds_read_b64_tr_b16 v[246:247], v100 offset:26888
  s_waitcnt lgkmcnt(4)
  ds_read_b64_tr_b16 v[184:185], v100 offset:28672
  ds_read_b64_tr_b16 v[186:187], v100 offset:28928
  ds_read_b64_tr_b16 v[248:249], v100 offset:28680
  ds_read_b64_tr_b16 v[250:251], v100 offset:28936
  ds_read_b64_tr_b16 v[188:189], v100 offset:30720
  ds_read_b64_tr_b16 v[190:191], v100 offset:30976
  ds_read_b64_tr_b16 v[252:253], v100 offset:30728
  ds_read_b64_tr_b16 v[254:255], v100 offset:30984
  s_waitcnt lgkmcnt(4)
  s_waitcnt lgkmcnt(0)
  s_add_u32 s40, s44, 2097152
  s_add_u32 m0, s41, 16384
  s_nop 0
  buffer_load_dwordx4 v102, s[36:39], s40 offen lds
  s_add_u32 s40, s40, 131072
  s_add_u32 m0, s41, 17408
  s_nop 0
  buffer_load_dwordx4 v102, s[36:39], s40 offen lds
  s_add_u32 s40, s44, 2359296
  s_add_u32 m0, s41, 18432
  s_nop 0
  buffer_load_dwordx4 v102, s[36:39], s40 offen lds
  s_add_u32 s40, s40, 131072
  s_add_u32 m0, s41, 19456
  s_nop 0
  buffer_load_dwordx4 v102, s[36:39], s40 offen lds
  s_add_u32 s40, s44, 2621440
  s_add_u32 m0, s41, 20480
  s_nop 0
  buffer_load_dwordx4 v102, s[36:39], s40 offen lds
  s_add_u32 s40, s40, 131072
  s_add_u32 m0, s41, 21504
  s_nop 0
  buffer_load_dwordx4 v102, s[36:39], s40 offen lds
  s_add_u32 s40, s44, 2883584
  s_add_u32 m0, s41, 22528
  s_nop 0
  buffer_load_dwordx4 v102, s[36:39], s40 offen lds
  s_add_u32 s40, s40, 131072
  s_add_u32 m0, s41, 23552
  s_nop 0
  buffer_load_dwordx4 v102, s[36:39], s40 offen lds
  s_add_u32 s40, s44, 3145728
  s_add_u32 m0, s41, 24576
  s_nop 0
  buffer_load_dwordx4 v102, s[36:39], s40 offen lds
  s_add_u32 s40, s40, 131072
  s_add_u32 m0, s41, 25600
  s_nop 0
  buffer_load_dwordx4 v102, s[36:39], s40 offen lds
  s_add_u32 s40, s44, 3407872
  s_add_u32 m0, s41, 26624
  s_nop 0
  buffer_load_dwordx4 v102, s[36:39], s40 offen lds
  s_add_u32 s40, s40, 131072
  s_add_u32 m0, s41, 27648
  s_nop 0
  buffer_load_dwordx4 v102, s[36:39], s40 offen lds
  s_add_u32 s40, s44, 3670016
  s_add_u32 m0, s41, 28672
  s_nop 0
  buffer_load_dwordx4 v102, s[36:39], s40 offen lds
  s_add_u32 s40, s40, 131072
  s_add_u32 m0, s41, 29696
  s_nop 0
  buffer_load_dwordx4 v102, s[36:39], s40 offen lds
  s_add_u32 s40, s44, 3932160
  s_add_u32 m0, s41, 30720
  s_nop 0
  buffer_load_dwordx4 v102, s[36:39], s40 offen lds
  s_add_u32 s40, s40, 131072
  s_add_u32 m0, s41, 31744
  s_nop 0
  buffer_load_dwordx4 v102, s[36:39], s40 offen lds
  s_waitcnt vmcnt(16)
  ds_read_b64_tr_b16 a[0:1], v100 offset:0
  ds_read_b64_tr_b16 a[2:3], v100 offset:256
  ds_read_b64_tr_b16 a[64:65], v100 offset:8
  ds_read_b64_tr_b16 a[66:67], v100 offset:264
  ds_read_b64_tr_b16 a[4:5], v100 offset:2048
  ds_read_b64_tr_b16 a[6:7], v100 offset:2304
  ds_read_b64_tr_b16 a[68:69], v100 offset:2056
  ds_read_b64_tr_b16 a[70:71], v100 offset:2312
  s_waitcnt lgkmcnt(4)
  ds_read_b64_tr_b16 a[8:9], v100 offset:4096
  ds_read_b64_tr_b16 a[10:11], v100 offset:4352
  ds_read_b64_tr_b16 a[72:73], v100 offset:4104
  ds_read_b64_tr_b16 a[74:75], v100 offset:4360
  ds_read_b64_tr_b16 a[12:13], v100 offset:6144
  ds_read_b64_tr_b16 a[14:15], v100 offset:6400
  ds_read_b64_tr_b16 a[76:77], v100 offset:6152
  ds_read_b64_tr_b16 a[78:79], v100 offset:6408
  s_waitcnt lgkmcnt(4)
  ds_read_b64_tr_b16 a[16:17], v100 offset:8192
  ds_read_b64_tr_b16 a[18:19], v100 offset:8448
  ds_read_b64_tr_b16 a[80:81], v100 offset:8200
  ds_read_b64_tr_b16 a[82:83], v100 offset:8456
  ds_read_b64_tr_b16 a[20:21], v100 offset:10240
  ds_read_b64_tr_b16 a[22:23], v100 offset:10496
  ds_read_b64_tr_b16 a[84:85], v100 offset:10248
  ds_read_b64_tr_b16 a[86:87], v100 offset:10504
  s_waitcnt lgkmcnt(4)
  ds_read_b64_tr_b16 a[24:25], v100 offset:12288
  ds_read_b64_tr_b16 a[26:27], v100 offset:12544
  ds_read_b64_tr_b16 a[88:89], v100 offset:12296
  ds_read_b64_tr_b16 a[90:91], v100 offset:12552
  ds_read_b64_tr_b16 a[28:29], v100 offset:14336
  ds_read_b64_tr_b16 a[30:31], v100 offset:14592
  ds_read_b64_tr_b16 a[92:93], v100 offset:14344
  ds_read_b64_tr_b16 a[94:95], v100 offset:14600
  s_waitcnt lgkmcnt(4)
  s_waitcnt lgkmcnt(0)
  s_waitcnt vmcnt(0)
  ds_read_b64_tr_b16 a[32:33], v100 offset:16384
  ds_read_b64_tr_b16 a[34:35], v100 offset:16640
  ds_read_b64_tr_b16 a[96:97], v100 offset:16392
  ds_read_b64_tr_b16 a[98:99], v100 offset:16648
  ds_read_b64_tr_b16 a[36:37], v100 offset:18432
  ds_read_b64_tr_b16 a[38:39], v100 offset:18688
  ds_read_b64_tr_b16 a[100:101], v100 offset:18440
  ds_read_b64_tr_b16 a[102:103], v100 offset:18696
  s_waitcnt lgkmcnt(4)
  ds_read_b64_tr_b16 a[40:41], v100 offset:20480
  ds_read_b64_tr_b16 a[42:43], v100 offset:20736
  ds_read_b64_tr_b16 a[104:105], v100 offset:20488
  ds_read_b64_tr_b16 a[106:107], v100 offset:20744
  ds_read_b64_tr_b16 a[44:45], v100 offset:22528
  ds_read_b64_tr_b16 a[46:47], v100 offset:22784
  ds_read_b64_tr_b16 a[108:109], v100 offset:22536
  ds_read_b64_tr_b16 a[110:111], v100 offset:22792
  s_waitcnt lgkmcnt(4)
  ds_read_b64_tr_b16 a[48:49], v100 offset:24576
  ds_read_b64_tr_b16 a[50:51], v100 offset:24832
  ds_read_b64_tr_b16 a[112:113], v100 offset:24584
  ds_read_b64_tr_b16 a[114:115], v100 offset:24840
  ds_read_b64_tr_b16 a[52:53], v100 offset:26624
  ds_read_b64_tr_b16 a[54:55], v100 offset:26880
  ds_read_b64_tr_b16 a[116:117], v100 offset:26632
  ds_read_b64_tr_b16 a[118:119], v100 offset:26888
  s_waitcnt lgkmcnt(4)
  ds_read_b64_tr_b16 a[56:57], v100 offset:28672
  ds_read_b64_tr_b16 a[58:59], v100 offset:28928
  ds_read_b64_tr_b16 a[120:121], v100 offset:28680
  ds_read_b64_tr_b16 a[122:123], v100 offset:28936
  ds_read_b64_tr_b16 a[60:61], v100 offset:30720
  ds_read_b64_tr_b16 a[62:63], v100 offset:30976
  ds_read_b64_tr_b16 a[124:125], v100 offset:30728
  ds_read_b64_tr_b16 a[126:127], v100 offset:30984
  s_waitcnt lgkmcnt(4)
  s_waitcnt lgkmcnt(0)
  s_call_b64 s[100:101], VERIFY
  s_cbranch_scc1 VER_OK_8
  v_mov_b32 v0, v116
  s_waitcnt vmcnt(0) lgkmcnt(0)
  s_barrier
  s_branch DISPATCH
VER_OK_8:
  s_barrier
  s_lshl_b32 s34, s70, 13
  s_lshl_b32 s35, s16, 10
  s_add_u32 s34, s34, s35
  v_add_u32 v9, s34, v1
  s_mov_b32 s73, 0
  s_mov_b32 s93, 0
  s_mov_b32 s92, 268435456
  s_mov_b32 s86, 0
QA_LOOP:
  s_lshl_b32 s74, s71, 6
  s_add_u32 s74, s74, s73
  s_add_u32 s72, s73, 1
  s_add_u32 s87, s74, 1
  s_lshl_b32 s84, s74, 10
  s_add_u32 s84, s84, 24674304
  s_lshl_b32 s85, s87, 10
  s_add_u32 s85, s85, 24674304
  s_cmp_lt_u32 s72, 64
  s_cselect_b32 s85, s85, 268435456
  s_cmp_eq_u32 s93, 1
  s_cbranch_scc1 QA_HAVE_9
QA_W_SPIN_11:
  buffer_load_dword v8, v3, s[8:11], s84 offen sc1
  s_waitcnt vmcnt(0)
  s_mov_b64 exec, 1
  buffer_store_dword v5, v7, s[8:11], s92 offen sc1
  s_mov_b64 exec, -1
  s_mov_b32 s92, 268435456
  v_cmp_eq_u32 vcc, 0, v8
  s_nop 0
  s_cbranch_vccz QA_W_OK_12
  s_cmp_eq_u32 s19, 0
  s_cbranch_scc1 QA_W_OK_12
  s_sub_u32 s19, s19, 1
  s_sleep 1
  s_branch QA_W_SPIN_11
QA_W_OK_12:
  s_lshl_b32 s34, s74, 15
  s_add_u32 s34, s34, 26247168
  s_xor_b32 s35, s86, 0
  s_lshr_b32 s36, s16, 1
  s_lshl_b32 s36, s36, 14
  s_and_b32 s37, s16, 1
  s_lshl_b32 s37, s37, 9
  s_add_u32 s36, s36, s37
  s_add_u32 s36, s36, s34
  s_lshl_b32 s37, s16, 13
  s_add_u32 s37, s37, s35
  s_add_u32 m0, s37, 0
  s_nop 0
  buffer_load_dwordx4 v2, s[8:11], s36 offen offset:0 sc1 lds
  s_add_u32 m0, s37, 960
  s_nop 0
  buffer_load_dwordx4 v2, s[8:11], s36 offen offset:64 sc1 lds
  s_add_u32 m0, s37, 1920
  s_nop 0
  buffer_load_dwordx4 v2, s[8:11], s36 offen offset:128 sc1 lds
  s_add_u32 m0, s37, 2880
  s_nop 0
  buffer_load_dwordx4 v2, s[8:11], s36 offen offset:192 sc1 lds
  s_add_u32 m0, s37, 3840
  s_nop 0
  buffer_load_dwordx4 v2, s[8:11], s36 offen offset:256 sc1 lds
  s_add_u32 m0, s37, 4800
  s_nop 0
  buffer_load_dwordx4 v2, s[8:11], s36 offen offset:320 sc1 lds
  s_add_u32 m0, s37, 5760
  s_nop 0
  buffer_load_dwordx4 v2, s[8:11], s36 offen offset:384 sc1 lds
  s_add_u32 m0, s37, 6720
  s_nop 0
  buffer_load_dwordx4 v2, s[8:11], s36 offen offset:448 sc1 lds
  s_waitcnt vmcnt(0)
  s_branch QA_GO_10
QA_HAVE_9:
  s_waitcnt vmcnt(6)
QA_GO_10:
  buffer_load_dword v8, v3, s[8:11], s85 offen sc1
  s_waitcnt lgkmcnt(0)
  s_barrier
  v_add_u32 v15, s86, v1
  ds_read_b128 v[16:19], v15 offset:0
  ds_read_b128 v[20:23], v15 offset:1024
  ds_read_b128 v[24:27], v15 offset:2048
  ds_read_b128 v[28:31], v15 offset:3072
  ds_read_b128 v[32:35], v15 offset:4096
  ds_read_b128 v[36:39], v15 offset:5120
  ds_read_b128 v[40:43], v15 offset:6144
  ds_read_b128 v[44:47], v15 offset:7168
  s_waitcnt lgkmcnt(7)
  v_mfma_f32_16x16x32_bf16 v[64:67], a[128:131], v[16:19], 0
  v_mfma_f32_16x16x32_bf16 v[72:75], a[192:195], v[16:19], 0
  v_mfma_f32_16x16x32_bf16 v[80:83], v[16:19], v[128:131], 0
  v_mfma_f32_16x16x32_bf16 v[88:91], v[16:19], v[192:195], 0
  v_mfma_f32_16x16x32_bf16 v[48:51], a[0:3], v[16:19], 0
  v_mfma_f32_16x16x32_bf16 v[56:59], a[64:67], v[16:19], 0
  ds_read_b128 v[16:19], v15 offset:8192
  s_waitcnt lgkmcnt(7)
  v_mfma_f32_16x16x32_bf16 v[64:67], a[132:135], v[20:23], v[64:67]
  v_mfma_f32_16x16x32_bf16 v[72:75], a[196:199], v[20:23], v[72:75]
  v_mfma_f32_16x16x32_bf16 v[80:83], v[20:23], v[132:135], v[80:83]
  v_mfma_f32_16x16x32_bf16 v[88:91], v[20:23], v[196:199], v[88:91]
  v_mfma_f32_16x16x32_bf16 v[48:51], a[4:7], v[20:23], v[48:51]
  v_mfma_f32_16x16x32_bf16 v[56:59], a[68:71], v[20:23], v[56:59]
  ds_read_b128 v[20:23], v15 offset:9216
  s_waitcnt lgkmcnt(7)
  v_mfma_f32_16x16x32_bf16 v[64:67], a[136:139], v[24:27], v[64:67]
  v_mfma_f32_16x16x32_bf16 v[72:75], a[200:203], v[24:27], v[72:75]
  v_mfma_f32_16x16x32_bf16 v[80:83], v[24:27], v[136:139], v[80:83]
  v_mfma_f32_16x16x32_bf16 v[88:91], v[24:27], v[200:203], v[88:91]
  v_mfma_f32_16x16x32_bf16 v[48:51], a[8:11], v[24:27], v[48:51]
  v_mfma_f32_16x16x32_bf16 v[56:59], a[72:75], v[24:27], v[56:59]
  ds_read_b128 v[24:27], v15 offset:10240
  s_waitcnt lgkmcnt(7)
  v_mfma_f32_16x16x32_bf16 v[64:67], a[140:143], v[28:31], v[64:67]
  v_mfma_f32_16x16x32_bf16 v[72:75], a[204:207], v[28:31], v[72:75]
  v_mfma_f32_16x16x32_bf16 v[80:83], v[28:31], v[140:143], v[80:83]
  v_mfma_f32_16x16x32_bf16 v[88:91], v[28:31], v[204:207], v[88:91]
  v_mfma_f32_16x16x32_bf16 v[48:51], a[12:15], v[28:31], v[48:51]
  v_mfma_f32_16x16x32_bf16 v[56:59], a[76:79], v[28:31], v[56:59]
  ds_read_b128 v[28:31], v15 offset:11264
  s_waitcnt lgkmcnt(7)
  v_mfma_f32_16x16x32_bf16 v[64:67], a[144:147], v[32:35], v[64:67]
  v_mfma_f32_16x16x32_bf16 v[72:75], a[208:211], v[32:35], v[72:75]
  v_mfma_f32_16x16x32_bf16 v[80:83], v[32:35], v[144:147], v[80:83]
  v_mfma_f32_16x16x32_bf16 v[88:91], v[32:35], v[208:211], v[88:91]
  v_mfma_f32_16x16x32_bf16 v[48:51], a[16:19], v[32:35], v[48:51]
  v_mfma_f32_16x16x32_bf16 v[56:59], a[80:83], v[32:35], v[56:59]
  ds_read_b128 v[32:35], v15 offset:12288
  s_waitcnt lgkmcnt(7)
  v_mfma_f32_16x16x32_bf16 v[64:67], a[148:151], v[36:39], v[64:67]
  v_mfma_f32_16x16x32_bf16 v[72:75], a[212:215], v[36:39], v[72:75]
  v_mfma_f32_16x16x32_bf16 v[80:83], v[36:39], v[148:151], v[80:83]
  v_mfma_f32_16x16x32_bf16 v[88:91], v[36:39], v[212:215], v[88:91]
  v_mfma_f32_16x16x32_bf16 v[48:51], a[20:23], v[36:39], v[48:51]
  v_mfma_f32_16x16x32_bf16 v[56:59], a[84:87], v[36:39], v[56:59]
  ds_read_b128 v[36:39], v15 offset:13312
  s_waitcnt lgkmcnt(7)
  v_mfma_f32_16x16x32_bf16 v[64:67], a[152:155], v[40:43], v[64:67]
  v_mfma_f32_16x16x32_bf16 v[72:75], a[216:219], v[40:43], v[72:75]
  v_mfma_f32_16x16x32_bf16 v[80:83], v[40:43], v[152:155], v[80:83]
  v_mfma_f32_16x16x32_bf16 v[88:91], v[40:43], v[216:219], v[88:91]
  v_mfma_f32_16x16x32_bf16 v[48:51], a[24:27], v[40:43], v[48:51]
  v_mfma_f32_16x16x32_bf16 v[56:59], a[88:91], v[40:43], v[56:59]
  ds_read_b128 v[40:43], v15 offset:14336
  s_waitcnt lgkmcnt(7)
  v_mfma_f32_16x16x32_bf16 v[64:67], a[156:159], v[44:47], v[64:67]
  v_mfma_f32_16x16x32_bf16 v[72:75], a[220:223], v[44:47], v[72:75]
  v_mfma_f32_16x16x32_bf16 v[80:83], v[44:47], v[156:159], v[80:83]
  v_mfma_f32_16x16x32_bf16 v[88:91], v[44:47], v[220:223], v[88:91]
  v_mfma_f32_16x16x32_bf16 v[48:51], a[28:31], v[44:47], v[48:51]
  v_mfma_f32_16x16x32_bf16 v[56:59], a[92:95], v[44:47], v[56:59]
  ds_read_b128 v[44:47], v15 offset:15360
  s_waitcnt lgkmcnt(7)
  v_mfma_f32_16x16x32_bf16 v[64:67], a[160:163], v[16:19], v[64:67]
  v_mfma_f32_16x16x32_bf16 v[72:75], a[224:227], v[16:19], v[72:75]
  v_mfma_f32_16x16x32_bf16 v[80:83], v[16:19], v[160:163], v[80:83]
  v_mfma_f32_16x16x32_bf16 v[88:91], v[16:19], v[224:227], v[88:91]
  v_mfma_f32_16x16x32_bf16 v[48:51], a[32:35], v[16:19], v[48:51]
  v_mfma_f32_16x16x32_bf16 v[56:59], a[96:99], v[16:19], v[56:59]
  ds_read_b128 v[16:19], v15 offset:16384
  s_waitcnt lgkmcnt(7)
  v_mfma_f32_16x16x32_bf16 v[64:67], a[164:167], v[20:23], v[64:67]
  v_mfma_f32_16x16x32_bf16 v[72:75], a[228:231], v[20:23], v[72:75]
  v_mfma_f32_16x16x32_bf16 v[80:83], v[20:23], v[164:167], v[80:83]
  v_mfma_f32_16x16x32_bf16 v[88:91], v[20:23], v[228:231], v[88:91]
  v_mfma_f32_16x16x32_bf16 v[48:51], a[36:39], v[20:23], v[48:51]
  v_mfma_f32_16x16x32_bf16 v[56:59], a[100:103], v[20:23], v[56:59]
  ds_read_b128 v[20:23], v15 offset:17408
  s_waitcnt lgkmcnt(7)
  v_mfma_f32_16x16x32_bf16 v[64:67], a[168:171], v[24:27], v[64:67]
  v_mfma_f32_16x16x32_bf16 v[72:75], a[232:235], v[24:27], v[72:75]
  v_mfma_f32_16x16x32_bf16 v[80:83], v[24:27], v[168:171], v[80:83]
  v_mfma_f32_16x16x32_bf16 v[88:91], v[24:27], v[232:235], v[88:91]
  v_mfma_f32_16x16x32_bf16 v[48:51], a[40:43], v[24:27], v[48:51]
  v_mfma_f32_16x16x32_bf16 v[56:59], a[104:107], v[24:27], v[56:59]
  ds_read_b128 v[24:27], v15 offset:18432
  s_waitcnt lgkmcnt(7)
  v_mfma_f32_16x16x32_bf16 v[64:67], a[172:175], v[28:31], v[64:67]
  v_mfma_f32_16x16x32_bf16 v[72:75], a[236:239], v[28:31], v[72:75]
  v_mfma_f32_16x16x32_bf16 v[80:83], v[28:31], v[172:175], v[80:83]
  v_mfma_f32_16x16x32_bf16 v[88:91], v[28:31], v[236:239], v[88:91]
  v_mfma_f32_16x16x32_bf16 v[48:51], a[44:47], v[28:31], v[48:51]
  v_mfma_f32_16x16x32_bf16 v[56:59], a[108:111], v[28:31], v[56:59]
  ds_read_b128 v[28:31], v15 offset:19456
  s_waitcnt lgkmcnt(7)
  v_mfma_f32_16x16x32_bf16 v[64:67], a[176:179], v[32:35], v[64:67]
  v_mfma_f32_16x16x32_bf16 v[72:75], a[240:243], v[32:35], v[72:75]
  v_mfma_f32_16x16x32_bf16 v[80:83], v[32:35], v[176:179], v[80:83]
  v_mfma_f32_16x16x32_bf16 v[88:91], v[32:35], v[240:243], v[88:91]
  v_mfma_f32_16x16x32_bf16 v[48:51], a[48:51], v[32:35], v[48:51]
  v_mfma_f32_16x16x32_bf16 v[56:59], a[112:115], v[32:35], v[56:59]
  ds_read_b128 v[32:35], v15 offset:20480
  s_waitcnt lgkmcnt(7)
  v_mfma_f32_16x16x32_bf16 v[64:67], a[180:183], v[36:39], v[64:67]
  v_mfma_f32_16x16x32_bf16 v[72:75], a[244:247], v[36:39], v[72:75]
  v_mfma_f32_16x16x32_bf16 v[80:83], v[36:39], v[180:183], v[80:83]
  v_mfma_f32_16x16x32_bf16 v[88:91], v[36:39], v[244:247], v[88:91]
  v_mfma_f32_16x16x32_bf16 v[48:51], a[52:55], v[36:39], v[48:51]
  v_mfma_f32_16x16x32_bf16 v[56:59], a[116:119], v[36:39], v[56:59]
  ds_read_b128 v[36:39], v15 offset:21504
  s_waitcnt vmcnt(0)
  s_mov_b64 exec, 1
  buffer_store_dword v5, v7, s[8:11], s92 offen sc1
  s_mov_b64 exec, -1
  s_mov_b32 s92, 268435456
  v_cmp_eq_u32 vcc, 0, v8
  s_mov_b32 s93, 0
  s_cbranch_vccnz QA_NOPF_13
  s_mov_b32 s93, 1
  s_lshl_b32 s34, s87, 15
  s_add_u32 s34, s34, 26247168
  s_xor_b32 s35, s86, 32768
  s_lshr_b32 s36, s16, 1
  s_lshl_b32 s36, s36, 14
  s_and_b32 s37, s16, 1
  s_lshl_b32 s37, s37, 9
  s_add_u32 s36, s36, s37
  s_add_u32 s36, s36, s34
  s_lshl_b32 s37, s16, 13
  s_add_u32 s37, s37, s35
  s_add_u32 m0, s37, 0
  s_nop 0
  buffer_load_dwordx4 v2, s[8:11], s36 offen offset:0 sc1 lds
  s_add_u32 m0, s37, 960
  s_nop 0
  buffer_load_dwordx4 v2, s[8:11], s36 offen offset:64 sc1 lds
  s_add_u32 m0, s37, 1920
  s_nop 0
  buffer_load_dwordx4 v2, s[8:11], s36 offen offset:128 sc1 lds
  s_add_u32 m0, s37, 2880
  s_nop 0
  buffer_load_dwordx4 v2, s[8:11], s36 offen offset:192 sc1 lds
  s_add_u32 m0, s37, 3840
  s_nop 0
  buffer_load_dwordx4 v2, s[8:11], s36 offen offset:256 sc1 lds
  s_add_u32 m0, s37, 4800
  s_nop 0
  buffer_load_dwordx4 v2, s[8:11], s36 offen offset:320 sc1 lds
  s_add_u32 m0, s37, 5760
  s_nop 0
  buffer_load_dwordx4 v2, s[8:11], s36 offen offset:384 sc1 lds
  s_add_u32 m0, s37, 6720
  s_nop 0
  buffer_load_dwordx4 v2, s[8:11], s36 offen offset:448 sc1 lds
QA_NOPF_13:
  s_waitcnt lgkmcnt(7)
  v_mfma_f32_16x16x32_bf16 v[64:67], a[184:187], v[40:43], v[64:67]
  s_lshl_b32 s34, s74, 19
  s_add_u32 s34, s34, 43024384
  s_lshl_b32 s35, s74, 18
  v_mfma_f32_16x16x32_bf16 v[72:75], a[248:251], v[40:43], v[72:75]
  s_add_u32 s35, s35, 177242112
  s_add_u32 s36, s35, 4096
  s_lshl_b32 s92, s74, 13
  v_mfma_f32_16x16x32_bf16 v[80:83], v[40:43], v[184:187], v[80:83]
  s_add_u32 s92, s92, 22282240
  v_mfma_f32_16x16x32_bf16 v[88:91], v[40:43], v[248:251], v[88:91]
  v_mfma_f32_16x16x32_bf16 v[48:51], a[56:59], v[40:43], v[48:51]
  v_mfma_f32_16x16x32_bf16 v[56:59], a[120:123], v[40:43], v[56:59]
  ds_read_b128 v[40:43], v15 offset:22528
  s_waitcnt lgkmcnt(7)
  v_mfma_f32_16x16x32_bf16 v[64:67], a[188:191], v[44:47], v[64:67]
  v_mfma_f32_16x16x32_bf16 v[72:75], a[252:255], v[44:47], v[72:75]
  v_mfma_f32_16x16x32_bf16 v[80:83], v[44:47], v[188:191], v[80:83]
  v_mfma_f32_16x16x32_bf16 v[88:91], v[44:47], v[252:255], v[88:91]
  s_nop 4
  v_cvt_pk_bf16_f32 v104, v64, v65
  v_mfma_f32_16x16x32_bf16 v[48:51], a[60:63], v[44:47], v[48:51]
  v_cvt_pk_bf16_f32 v105, v66, v67
  v_mfma_f32_16x16x32_bf16 v[56:59], a[124:127], v[44:47], v[56:59]
  ds_read_b128 v[44:47], v15 offset:23552
  v_cvt_pk_bf16_f32 v106, v72, v73
  s_waitcnt lgkmcnt(7)
  v_mfma_f32_16x16x32_bf16 v[68:71], a[128:131], v[16:19], 0
  v_cvt_pk_bf16_f32 v107, v74, v75
  v_mfma_f32_16x16x32_bf16 v[76:79], a[192:195], v[16:19], 0
  buffer_store_dwordx4 v[104:107], v6, s[8:11], s34 offen offset:0 sc1
  v_cvt_pk_bf16_f32 v96, v48, v49
  v_mfma_f32_16x16x32_bf16 v[84:87], v[16:19], v[128:131], 0
  v_cvt_pk_bf16_f32 v97, v50, v51
  v_mfma_f32_16x16x32_bf16 v[92:95], v[16:19], v[192:195], 0
  v_cvt_pk_bf16_f32 v98, v56, v57
  v_mfma_f32_16x16x32_bf16 v[52:55], a[0:3], v[16:19], 0
  v_cvt_pk_bf16_f32 v99, v58, v59
  v_mfma_f32_16x16x32_bf16 v[60:63], a[64:67], v[16:19], 0
  ds_read_b128 v[16:19], v15 offset:24576
  v_cvt_pk_bf16_f32 v112, v80, v81
  s_waitcnt lgkmcnt(7)
  v_mfma_f32_16x16x32_bf16 v[68:71], a[132:135], v[20:23], v[68:71]
  v_cvt_pk_bf16_f32 v113, v82, v83
  v_mfma_f32_16x16x32_bf16 v[76:79], a[196:199], v[20:23], v[76:79]
  buffer_store_dwordx4 v[96:99], v9, s[8:11], s35 offen sc1
  v_mfma_f32_16x16x32_bf16 v[84:87], v[20:23], v[132:135], v[84:87]
  v_cvt_pk_bf16_f32 v116, v88, v89
  v_mfma_f32_16x16x32_bf16 v[92:95], v[20:23], v[196:199], v[92:95]
  v_cvt_pk_bf16_f32 v117, v90, v91
  v_mfma_f32_16x16x32_bf16 v[52:55], a[4:7], v[20:23], v[52:55]
  v_mfma_f32_16x16x32_bf16 v[60:63], a[68:71], v[20:23], v[60:63]
  ds_read_b128 v[20:23], v15 offset:25600
  s_waitcnt lgkmcnt(7)
  v_mfma_f32_16x16x32_bf16 v[68:71], a[136:139], v[24:27], v[68:71]
  v_mfma_f32_16x16x32_bf16 v[76:79], a[200:203], v[24:27], v[76:79]
  v_mfma_f32_16x16x32_bf16 v[84:87], v[24:27], v[136:139], v[84:87]
  v_mfma_f32_16x16x32_bf16 v[92:95], v[24:27], v[200:203], v[92:95]
  v_mfma_f32_16x16x32_bf16 v[52:55], a[8:11], v[24:27], v[52:55]
  v_mfma_f32_16x16x32_bf16 v[60:63], a[72:75], v[24:27], v[60:63]
  ds_read_b128 v[24:27], v15 offset:26624
  s_waitcnt lgkmcnt(7)
  v_mfma_f32_16x16x32_bf16 v[68:71], a[140:143], v[28:31], v[68:71]
  v_mfma_f32_16x16x32_bf16 v[76:79], a[204:207], v[28:31], v[76:79]
  v_mfma_f32_16x16x32_bf16 v[84:87], v[28:31], v[140:143], v[84:87]
  v_mfma_f32_16x16x32_bf16 v[92:95], v[28:31], v[204:207], v[92:95]
  v_mfma_f32_16x16x32_bf16 v[52:55], a[12:15], v[28:31], v[52:55]
  v_mfma_f32_16x16x32_bf16 v[60:63], a[76:79], v[28:31], v[60:63]
  ds_read_b128 v[28:31], v15 offset:27648
  s_waitcnt lgkmcnt(7)
  v_mfma_f32_16x16x32_bf16 v[68:71], a[144:147], v[32:35], v[68:71]
  v_mfma_f32_16x16x32_bf16 v[76:79], a[208:211], v[32:35], v[76:79]
  v_mfma_f32_16x16x32_bf16 v[84:87], v[32:35], v[144:147], v[84:87]
  v_mfma_f32_16x16x32_bf16 v[92:95], v[32:35], v[208:211], v[92:95]
  v_mfma_f32_16x16x32_bf16 v[52:55], a[16:19], v[32:35], v[52:55]
  v_mfma_f32_16x16x32_bf16 v[60:63], a[80:83], v[32:35], v[60:63]
  ds_read_b128 v[32:35], v15 offset:28672
  s_waitcnt lgkmcnt(7)
  v_mfma_f32_16x16x32_bf16 v[68:71], a[148:151], v[36:39], v[68:71]
  v_mfma_f32_16x16x32_bf16 v[76:79], a[212:215], v[36:39], v[76:79]
  v_mfma_f32_16x16x32_bf16 v[84:87], v[36:39], v[148:151], v[84:87]
  v_mfma_f32_16x16x32_bf16 v[92:95], v[36:39], v[212:215], v[92:95]
  v_mfma_f32_16x16x32_bf16 v[52:55], a[20:23], v[36:39], v[52:55]
  v_mfma_f32_16x16x32_bf16 v[60:63], a[84:87], v[36:39], v[60:63]
  ds_read_b128 v[36:39], v15 offset:29696
  s_waitcnt lgkmcnt(7)
  v_mfma_f32_16x16x32_bf16 v[68:71], a[152:155], v[40:43], v[68:71]
  v_mfma_f32_16x16x32_bf16 v[76:79], a[216:219], v[40:43], v[76:79]
  v_mfma_f32_16x16x32_bf16 v[84:87], v[40:43], v[152:155], v[84:87]
  v_mfma_f32_16x16x32_bf16 v[92:95], v[40:43], v[216:219], v[92:95]
  v_mfma_f32_16x16x32_bf16 v[52:55], a[24:27], v[40:43], v[52:55]
  v_mfma_f32_16x16x32_bf16 v[60:63], a[88:91], v[40:43], v[60:63]
  ds_read_b128 v[40:43], v15 offset:30720
  s_waitcnt lgkmcnt(7)
  v_mfma_f32_16x16x32_bf16 v[68:71], a[156:159], v[44:47], v[68:71]
  v_mfma_f32_16x16x32_bf16 v[76:79], a[220:223], v[44:47], v[76:79]
  v_mfma_f32_16x16x32_bf16 v[84:87], v[44:47], v[156:159], v[84:87]
  v_mfma_f32_16x16x32_bf16 v[92:95], v[44:47], v[220:223], v[92:95]
  v_mfma_f32_16x16x32_bf16 v[52:55], a[28:31], v[44:47], v[52:55]
  v_mfma_f32_16x16x32_bf16 v[60:63], a[92:95], v[44:47], v[60:63]
  ds_read_b128 v[44:47], v15 offset:31744
  s_waitcnt lgkmcnt(7)
  v_mfma_f32_16x16x32_bf16 v[68:71], a[160:163], v[16:19], v[68:71]
  v_mfma_f32_16x16x32_bf16 v[76:79], a[224:227], v[16:19], v[76:79]
  v_mfma_f32_16x16x32_bf16 v[84:87], v[16:19], v[160:163], v[84:87]
  v_mfma_f32_16x16x32_bf16 v[92:95], v[16:19], v[224:227], v[92:95]
  v_mfma_f32_16x16x32_bf16 v[52:55], a[32:35], v[16:19], v[52:55]
  v_mfma_f32_16x16x32_bf16 v[60:63], a[96:99], v[16:19], v[60:63]
  s_waitcnt lgkmcnt(6)
  v_mfma_f32_16x16x32_bf16 v[68:71], a[164:167], v[20:23], v[68:71]
  v_mfma_f32_16x16x32_bf16 v[76:79], a[228:231], v[20:23], v[76:79]
  v_mfma_f32_16x16x32_bf16 v[84:87], v[20:23], v[164:167], v[84:87]
  v_mfma_f32_16x16x32_bf16 v[92:95], v[20:23], v[228:231], v[92:95]
  v_mfma_f32_16x16x32_bf16 v[52:55], a[36:39], v[20:23], v[52:55]
  v_mfma_f32_16x16x32_bf16 v[60:63], a[100:103], v[20:23], v[60:63]
  s_waitcnt lgkmcnt(5)
  v_mfma_f32_16x16x32_bf16 v[68:71], a[168:171], v[24:27], v[68:71]
  v_mfma_f32_16x16x32_bf16 v[76:79], a[232:235], v[24:27], v[76:79]
  v_mfma_f32_16x16x32_bf16 v[84:87], v[24:27], v[168:171], v[84:87]
  v_mfma_f32_16x16x32_bf16 v[92:95], v[24:27], v[232:235], v[92:95]
  v_mfma_f32_16x16x32_bf16 v[52:55], a[40:43], v[24:27], v[52:55]
  v_mfma_f32_16x16x32_bf16 v[60:63], a[104:107], v[24:27], v[60:63]
  s_waitcnt lgkmcnt(4)
  v_mfma_f32_16x16x32_bf16 v[68:71], a[172:175], v[28:31], v[68:71]
  v_mfma_f32_16x16x32_bf16 v[76:79], a[236:239], v[28:31], v[76:79]
  v_mfma_f32_16x16x32_bf16 v[84:87], v[28:31], v[172:175], v[84:87]
  v_mfma_f32_16x16x32_bf16 v[92:95], v[28:31], v[236:239], v[92:95]
  v_mfma_f32_16x16x32_bf16 v[52:55], a[44:47], v[28:31], v[52:55]
  v_mfma_f32_16x16x32_bf16 v[60:63], a[108:111], v[28:31], v[60:63]
  s_waitcnt lgkmcnt(3)
  v_mfma_f32_16x16x32_bf16 v[68:71], a[176:179], v[32:35], v[68:71]
  v_mfma_f32_16x16x32_bf16 v[76:79], a[240:243], v[32:35], v[76:79]
  v_mfma_f32_16x16x32_bf16 v[84:87], v[32:35], v[176:179], v[84:87]
  v_mfma_f32_16x16x32_bf16 v[92:95], v[32:35], v[240:243], v[92:95]
  v_mfma_f32_16x16x32_bf16 v[52:55], a[48:51], v[32:35], v[52:55]
  v_mfma_f32_16x16x32_bf16 v[60:63], a[112:115], v[32:35], v[60:63]
  s_waitcnt lgkmcnt(2)
  v_mfma_f32_16x16x32_bf16 v[68:71], a[180:183], v[36:39], v[68:71]
  v_mfma_f32_16x16x32_bf16 v[76:79], a[244:247], v[36:39], v[76:79]
  v_mfma_f32_16x16x32_bf16 v[84:87], v[36:39], v[180:183], v[84:87]
  v_mfma_f32_16x16x32_bf16 v[92:95], v[36:39], v[244:247], v[92:95]
  v_mfma_f32_16x16x32_bf16 v[52:55], a[52:55], v[36:39], v[52:55]
  v_mfma_f32_16x16x32_bf16 v[60:63], a[116:119], v[36:39], v[60:63]
  s_waitcnt lgkmcnt(1)
  v_mfma_f32_16x16x32_bf16 v[68:71], a[184:187], v[40:43], v[68:71]
  v_mfma_f32_16x16x32_bf16 v[76:79], a[248:251], v[40:43], v[76:79]
  v_mfma_f32_16x16x32_bf16 v[84:87], v[40:43], v[184:187], v[84:87]
  v_mfma_f32_16x16x32_bf16 v[92:95], v[40:43], v[248:251], v[92:95]
  v_mfma_f32_16x16x32_bf16 v[52:55], a[56:59], v[40:43], v[52:55]
  v_mfma_f32_16x16x32_bf16 v[60:63], a[120:123], v[40:43], v[60:63]
  s_waitcnt lgkmcnt(0)
  v_mfma_f32_16x16x32_bf16 v[68:71], a[188:191], v[44:47], v[68:71]
  v_mfma_f32_16x16x32_bf16 v[76:79], a[252:255], v[44:47], v[76:79]
  v_mfma_f32_16x16x32_bf16 v[84:87], v[44:47], v[188:191], v[84:87]
  v_mfma_f32_16x16x32_bf16 v[92:95], v[44:47], v[252:255], v[92:95]
  s_nop 4
  v_cvt_pk_bf16_f32 v108, v68, v69
  v_mfma_f32_16x16x32_bf16 v[52:55], a[60:63], v[44:47], v[52:55]
  v_cvt_pk_bf16_f32 v109, v70, v71
  v_mfma_f32_16x16x32_bf16 v[60:63], a[124:127], v[44:47], v[60:63]
  v_cvt_pk_bf16_f32 v110, v76, v77
  v_cvt_pk_bf16_f32 v111, v78, v79
  v_cvt_pk_bf16_f32 v114, v84, v85
  v_cvt_pk_bf16_f32 v115, v86, v87
  v_cvt_pk_bf16_f32 v118, v92, v93
  s_nop 0
  v_cvt_pk_bf16_f32 v100, v52, v53
  v_cvt_pk_bf16_f32 v101, v54, v55
  v_cvt_pk_bf16_f32 v102, v60, v61
  v_cvt_pk_bf16_f32 v103, v62, v63
  v_cvt_pk_bf16_f32 v119, v94, v95
  buffer_store_dwordx4 v[108:111], v6, s[8:11], s34 offen offset:1024 sc1
  buffer_store_dwordx4 v[100:103], v9, s[8:11], s36 offen sc1
  buffer_store_dwordx4 v[112:115], v6, s[8:11], s34 offen offset:2048 sc1
  buffer_store_dwordx4 v[116:119], v6, s[8:11], s34 offen offset:3072 sc1
  s_xor_b32 s86, s86, 32768
  s_add_u32 s73, s73, 1
  s_cmp_lt_u32 s73, 64
  s_cbranch_scc1 QA_LOOP
  s_waitcnt vmcnt(0)
  s_mov_b64 exec, 1
  buffer_store_dword v5, v7, s[8:11], s92 offen sc1
  s_mov_b64 exec, -1
  s_mov_b32 s92, 268435456
  s_endpgm
ROLE_BL:
  s_call_b64 s[100:101], VERIFY
  s_cbranch_scc1 VER_OK_14
  v_mov_b32 v0, v116
  s_waitcnt vmcnt(0) lgkmcnt(0)
  s_barrier
  s_branch DISPATCH
VER_OK_14:
  s_mov_b32 s70, s17
  s_lshr_b32 s71, s70, 5
  s_and_b32 s72, s70, 31
  v_and_b32 v14, 63, v0
  v_lshlrev_b32 v1, 4, v14
  s_lshl_b32 s34, s72, 13
  v_lshlrev_b32 v2, 3, v14
  v_and_b32 v3, 3, v14
  v_lshlrev_b32 v3, 2, v3
  s_lshl_b32 s34, s72, 4
  v_add_u32 v3, s34, v3
  v_mov_b32 v4, 1
  v_mov_b32 v6, v3
  v_and_b32 v3, 3, v14
  v_lshlrev_b32 v3, 6, v3
  s_lshl_b32 s34, s72, 8
  v_add_u32 v3, s34, v3
  v_and_b32 v15, 15, v14
  v_lshrrev_b32 v13, 4, v14
  v_lshlrev_b32 v13, 2, v13
  v_mov_b32 v5, 0xf149f2ca
  v_add_u32 v7, 0, v13
  v_cmp_le_u32 vcc, v7, v15
  s_nop 1
  v_cndmask_b32 v8, v5, 0, vcc
  v_add_u32 v7, 1, v13
  v_cmp_le_u32 vcc, v7, v15
  s_nop 1
  v_cndmask_b32 v9, v5, 0, vcc
  v_add_u32 v7, 2, v13
  v_cmp_le_u32 vcc, v7, v15
  s_nop 1
  v_cndmask_b32 v10, v5, 0, vcc
  v_add_u32 v7, 3, v13
  v_cmp_le_u32 vcc, v7, v15
  s_nop 1
  v_cndmask_b32 v11, v5, 0, vcc
  v_mov_b32 v12, v8
  v_mov_b32 v13, v9
  v_mov_b32 v14, v10
  v_mov_b32 v15, v11
  s_mov_b32 s34, -1
  s_mov_b32 s35, 0
  v_cndmask_b32 v16, v5, 0, s[34:35]
  v_cndmask_b32 v17, v5, 0, s[34:35]
  v_cndmask_b32 v18, v5, 0, s[34:35]
  v_cndmask_b32 v19, v5, 0, s[34:35]
  s_mov_b32 s60, 1040356334
  s_mov_b32 s73, 0
  s_mov_b32 s93, 0
  s_mov_b32 s92, 268435456
B_LOOPL:
  s_lshl_b32 s74, s71, 6
  s_add_u32 s74, s74, s73
  s_lshl_b32 s76, s74, 13
  s_add_u32 s76, s76, 22282240
  s_lshl_b32 s77, s74, 13
  s_add_u32 s77, s77, 23330816
  s_lshl_b32 s80, s74, 18
  s_lshl_b32 s35, s72, 13
  s_add_u32 s80, s80, s35
  s_add_u32 s80, s80, 110133248
  s_cmp_eq_u32 s93, 1
  s_cbranch_scc1 B_HAVE0L
B_KV0L:
  buffer_load_dword v5, v3, s[8:11], s76 offen sc1
  s_waitcnt vmcnt(0)
  s_mov_b64 exec, 15
  buffer_store_dword v4, v6, s[8:11], s92 offen
  s_mov_b64 exec, -1
  s_mov_b32 s92, 268435456
  v_cmp_eq_u32 vcc, 0, v5
  s_nop 0
  s_cbranch_vccz B_KVO0L
  s_cmp_eq_u32 s19, 0
  s_cbranch_scc1 B_KVO0L
  s_sub_u32 s19, s19, 1
  s_sleep 1
  s_branch B_KV0L
B_KVO0L:
  s_lshl_b32 s34, s74, 18
  s_lshl_b32 s35, s72, 13
  s_add_u32 s34, s34, s35
  s_add_u32 s34, s34, 177242112
  buffer_load_dwordx4 a[0:3], v1, s[8:11], s34 offen offset:0 sc1
  buffer_load_dwordx4 a[4:7], v1, s[8:11], s34 offen offset:1024 sc1
  buffer_load_dwordx4 a[8:11], v1, s[8:11], s34 offen offset:2048 sc1
  buffer_load_dwordx4 a[12:15], v1, s[8:11], s34 offen offset:3072 sc1
  s_add_u32 s34, s34, 4096
  buffer_load_dwordx4 a[16:19], v1, s[8:11], s34 offen offset:0 sc1
  buffer_load_dwordx4 a[20:23], v1, s[8:11], s34 offen offset:1024 sc1
  buffer_load_dwordx4 a[24:27], v1, s[8:11], s34 offen offset:2048 sc1
  buffer_load_dwordx4 a[28:31], v1, s[8:11], s34 offen offset:3072 sc1
  s_lshl_b32 s34, s74, 19
  s_lshl_b32 s35, s72, 14
  s_add_u32 s34, s34, s35
  s_add_u32 s34, s34, 43024384
  buffer_load_dwordx4 a[32:35], v1, s[8:11], s34 offen offset:0 sc1
  buffer_load_dwordx4 a[48:51], v1, s[8:11], s34 offen offset:1024 sc1
  buffer_load_dwordx4 a[64:67], v1, s[8:11], s34 offen offset:2048 sc1
  buffer_load_dwordx4 a[68:71], v1, s[8:11], s34 offen offset:3072 sc1
  s_add_u32 s34, s34, 4096
  buffer_load_dwordx4 a[36:39], v1, s[8:11], s34 offen offset:0 sc1
  buffer_load_dwordx4 a[52:55], v1, s[8:11], s34 offen offset:1024 sc1
  buffer_load_dwordx4 a[72:75], v1, s[8:11], s34 offen offset:2048 sc1
  buffer_load_dwordx4 a[76:79], v1, s[8:11], s34 offen offset:3072 sc1
  s_add_u32 s34, s34, 4096
  buffer_load_dwordx4 a[40:43], v1, s[8:11], s34 offen offset:0 sc1
  buffer_load_dwordx4 a[56:59], v1, s[8:11], s34 offen offset:1024 sc1
  buffer_load_dwordx4 a[80:83], v1, s[8:11], s34 offen offset:2048 sc1
  buffer_load_dwordx4 a[84:87], v1, s[8:11], s34 offen offset:3072 sc1
  s_add_u32 s34, s34, 4096
  buffer_load_dwordx4 a[44:47], v1, s[8:11], s34 offen offset:0 sc1
  buffer_load_dwordx4 a[60:63], v1, s[8:11], s34 offen offset:1024 sc1
  buffer_load_dwordx4 a[88:91], v1, s[8:11], s34 offen offset:2048 sc1
  buffer_load_dwordx4 a[92:95], v1, s[8:11], s34 offen offset:3072 sc1
B_HAVE0L:
  s_add_u32 s36, s76, 8192
  s_cmp_lt_u32 s73, 63
  s_cselect_b32 s36, s36, 268435456
  buffer_load_dword v5, v3, s[8:11], s36 offen sc1
  buffer_load_dword v7, v3, s[8:11], s77 offen sc1
  s_waitcnt vmcnt(0)
  s_mov_b64 exec, 15
  buffer_store_dword v4, v6, s[8:11], s92 offen
  s_mov_b64 exec, -1
  s_mov_b32 s92, 268435456
  v_cmp_eq_u32 vcc, 0, v7
  s_nop 0
  s_cbranch_vccz B0L_KMO
B0L_KMS:
  buffer_load_dword v7, v3, s[8:11], s77 offen sc1
  s_waitcnt vmcnt(0)
  v_cmp_eq_u32 vcc, 0, v7
  s_nop 0
  s_cbranch_vccz B0L_KMO
  s_cmp_eq_u32 s19, 0
  s_cbranch_scc1 B0L_KMO
  s_sub_u32 s19, s19, 1
  s_branch B0L_KMS
B0L_KMO:
  s_add_u32 s34, s80, 4096
  buffer_load_dwordx4 v[20:23], v1, s[8:11], s80 offen offset:0 sc1
  buffer_load_dwordx4 v[24:27], v1, s[8:11], s80 offen offset:2048 sc1
  buffer_load_dwordx4 v[28:31], v1, s[8:11], s34 offen offset:0 sc1
  buffer_load_dwordx4 v[32:35], v1, s[8:11], s34 offen offset:2048 sc1
  buffer_load_dwordx2 v[36:37], v2, s[8:11], s80 offen offset:1024 sc1
  buffer_load_dwordx2 v[38:39], v2, s[8:11], s80 offen offset:1536 sc1
  buffer_load_dwordx2 v[40:41], v2, s[8:11], s80 offen offset:3072 sc1
  buffer_load_dwordx2 v[42:43], v2, s[8:11], s80 offen offset:3584 sc1
  buffer_load_dwordx2 v[44:45], v2, s[8:11], s34 offen offset:1024 sc1
  buffer_load_dwordx2 v[46:47], v2, s[8:11], s34 offen offset:1536 sc1
  buffer_load_dwordx2 v[48:49], v2, s[8:11], s34 offen offset:3072 sc1
  buffer_load_dwordx2 v[50:51], v2, s[8:11], s34 offen offset:3584 sc1
  v_cmp_eq_u32 vcc, 0, v5
  s_nop 0
  s_cmp_eq_u64 vcc, 0
  s_cselect_b32 s93, 1, 0
  s_add_u32 s37, s74, 1
  s_lshl_b32 s82, s37, 18
  s_lshl_b32 s35, s72, 13
  s_add_u32 s82, s82, s35
  s_add_u32 s82, s82, 177242112
  s_lshl_b32 s83, s37, 19
  s_lshl_b32 s35, s72, 14
  s_add_u32 s83, s83, s35
  s_add_u32 s83, s83, 43024384
  s_cmp_eq_u32 s93, 1
  s_cselect_b32 s82, s82, 268435456
  s_cselect_b32 s83, s83, 268435456
  buffer_load_dwordx4 a[96:99], v1, s[8:11], s82 offen offset:0 sc1
  buffer_load_dwordx4 a[100:103], v1, s[8:11], s82 offen offset:1024 sc1
  buffer_load_dwordx4 a[104:107], v1, s[8:11], s82 offen offset:2048 sc1
  buffer_load_dwordx4 a[108:111], v1, s[8:11], s82 offen offset:3072 sc1
  s_add_u32 s82, s82, 4096
  buffer_load_dwordx4 a[112:115], v1, s[8:11], s82 offen offset:0 sc1
  buffer_load_dwordx4 a[116:119], v1, s[8:11], s82 offen offset:1024 sc1
  buffer_load_dwordx4 a[120:123], v1, s[8:11], s82 offen offset:2048 sc1
  buffer_load_dwordx4 a[124:127], v1, s[8:11], s82 offen offset:3072 sc1
  buffer_load_dwordx4 a[128:131], v1, s[8:11], s83 offen offset:0 sc1
  buffer_load_dwordx4 a[144:147], v1, s[8:11], s83 offen offset:1024 sc1
  buffer_load_dwordx4 a[160:163], v1, s[8:11], s83 offen offset:2048 sc1
  buffer_load_dwordx4 a[164:167], v1, s[8:11], s83 offen offset:3072 sc1
  s_add_u32 s83, s83, 4096
  buffer_load_dwordx4 a[132:135], v1, s[8:11], s83 offen offset:0 sc1
  buffer_load_dwordx4 a[148:151], v1, s[8:11], s83 offen offset:1024 sc1
  buffer_load_dwordx4 a[168:171], v1, s[8:11], s83 offen offset:2048 sc1
  buffer_load_dwordx4 a[172:175], v1, s[8:11], s83 offen offset:3072 sc1
  s_add_u32 s83, s83, 4096
  buffer_load_dwordx4 a[136:139], v1, s[8:11], s83 offen offset:0 sc1
  buffer_load_dwordx4 a[152:155], v1, s[8:11], s83 offen offset:1024 sc1
  buffer_load_dwordx4 a[176:179], v1, s[8:11], s83 offen offset:2048 sc1
  buffer_load_dwordx4 a[180:183], v1, s[8:11], s83 offen offset:3072 sc1
  s_add_u32 s83, s83, 4096
  buffer_load_dwordx4 a[140:143], v1, s[8:11], s83 offen offset:0 sc1
  buffer_load_dwordx4 a[156:159], v1, s[8:11], s83 offen offset:1024 sc1
  buffer_load_dwordx4 a[184:187], v1, s[8:11], s83 offen offset:2048 sc1
  buffer_load_dwordx4 a[188:191], v1, s[8:11], s83 offen offset:3072 sc1
  v_mfma_f32_16x16x32_bf16 v[52:55], a[32:35], a[0:3], v[8:11]
  v_mfma_f32_16x16x32_bf16 v[64:67], a[32:35], a[16:19], 0
  v_mfma_f32_16x16x32_bf16 v[68:71], a[48:51], a[16:19], v[12:15]
  v_mfma_f32_16x16x32_bf16 v[52:55], a[36:39], a[4:7], v[52:55]
  v_mfma_f32_16x16x32_bf16 v[64:67], a[36:39], a[20:23], v[64:67]
  v_mfma_f32_16x16x32_bf16 v[68:71], a[52:55], a[20:23], v[68:71]
  v_mfma_f32_16x16x32_bf16 v[52:55], a[40:43], a[8:11], v[52:55]
  v_mfma_f32_16x16x32_bf16 v[64:67], a[40:43], a[24:27], v[64:67]
  v_mfma_f32_16x16x32_bf16 v[68:71], a[56:59], a[24:27], v[68:71]
  v_mfma_f32_16x16x32_bf16 v[52:55], a[44:47], a[12:15], v[52:55]
  v_mfma_f32_16x16x32_bf16 v[64:67], a[44:47], a[28:31], v[64:67]
  v_mfma_f32_16x16x32_bf16 v[68:71], a[60:63], a[28:31], v[68:71]
  s_waitcnt vmcnt(24)
  v_mfma_f32_16x16x32_bf16 v[60:63], v[20:23], a[0:3], v[16:19]
  s_lshl_b32 s78, s74, 18
  s_nop 2
  v_max3_f32 v148, v52, v53, v54
  v_mfma_f32_16x16x32_bf16 v[60:63], v[24:27], a[4:7], v[60:63]
  s_lshl_b32 s35, s72, 13
  v_max3_f32 v150, v64, v65, v66
  v_mfma_f32_16x16x32_bf16 v[60:63], v[28:31], a[8:11], v[60:63]
  s_add_u32 s78, s78, s35
  v_max3_f32 v150, v150, v67, v68
  v_mfma_f32_16x16x32_bf16 v[60:63], v[32:35], a[12:15], v[60:63]
  s_add_u32 s78, s78, 143687680
  v_max3_f32 v150, v150, v69, v70
  v_mfma_f32_16x16x32_bf16 v[72:75], v[20:23], a[16:19], v[16:19]
  s_add_u32 s36, s78, 4096
  v_mov_b32 v88, 0x3f803f80
  v_mfma_f32_16x16x32_bf16 v[72:75], v[24:27], a[20:23], v[72:75]
  s_lshl_b32 s92, s74, 9
  v_mov_b32 v89, 0x3f803f80
  v_mfma_f32_16x16x32_bf16 v[72:75], v[28:31], a[24:27], v[72:75]
  s_add_u32 s92, s92, 24379392
  v_max3_f32 v148, v148, v55, v60
  v_mfma_f32_16x16x32_bf16 v[72:75], v[32:35], a[28:31], v[72:75]
  v_max3_f32 v148, v148, v61, v62
  v_max_f32 v148, v148, v63
  v_mov_b32 v149, v148
  v_mov_b32 v90, 0x3f803f80
  s_nop 0
  v_permlane16_swap_b32 v148, v149
  v_max_f32 v148, v148, v149
  v_mov_b32 v149, v148
  v_mov_b32 v91, 0x3f803f80
  s_nop 0
  v_permlane32_swap_b32 v148, v149
  v_max_f32 v148, v148, v149
  v_mul_f32 v148, s60, v148
  v_fma_f32 v52, v52, s60, -v148
  v_fma_f32 v53, v53, s60, -v148
  v_fma_f32 v54, v54, s60, -v148
  v_fma_f32 v55, v55, s60, -v148
  v_exp_f32 v52, v52
  v_exp_f32 v53, v53
  v_exp_f32 v54, v54
  v_exp_f32 v55, v55
  v_cvt_pk_bf16_f32 v76, v52, v53
  v_cvt_pk_bf16_f32 v77, v54, v55
  v_mov_b32 v78, 0
  v_mov_b32 v79, 0
  v_max3_f32 v150, v150, v71, v72
  s_nop 0
  v_mfma_f32_16x16x32_bf16 v[92:95], v[88:91], v[76:79], 0
  v_max3_f32 v150, v150, v73, v74
  v_max_f32 v150, v150, v75
  v_mov_b32 v151, v150
  v_fma_f32 v60, v60, s60, -v148
  v_fma_f32 v61, v61, s60, -v148
  v_fma_f32 v62, v62, s60, -v148
  v_fma_f32 v63, v63, s60, -v148
  v_exp_f32 v60, v60
  v_exp_f32 v61, v61
  v_exp_f32 v62, v62
  v_exp_f32 v63, v63
  v_permlane16_swap_b32 v150, v151
  v_max_f32 v150, v150, v151
  v_cvt_pk_bf16_f32 v84, v60, v61
  v_cvt_pk_bf16_f32 v85, v62, v63
  v_mov_b32 v151, v150
  v_mov_b32 v78, 0
  v_mfma_f32_16x16x16_bf16 v[92:95], v[88:89], v[84:85], v[92:95]
  v_permlane32_swap_b32 v150, v151
  v_max_f32 v150, v150, v151
  v_mul_f32 v150, s60, v150
  v_fma_f32 v64, v64, s60, -v150
  v_fma_f32 v65, v65, s60, -v150
  v_fma_f32 v66, v66, s60, -v150
  v_fma_f32 v67, v67, s60, -v150
  v_fma_f32 v68, v68, s60, -v150
  v_fma_f32 v69, v69, s60, -v150
  v_fma_f32 v70, v70, s60, -v150
  v_fma_f32 v71, v71, s60, -v150
  v_exp_f32 v64, v64
  v_exp_f32 v65, v65
  v_exp_f32 v66, v66
  v_exp_f32 v67, v67
  v_exp_f32 v68, v68
  v_exp_f32 v69, v69
  v_exp_f32 v70, v70
  v_exp_f32 v71, v71
  v_cvt_pk_bf16_f32 v80, v64, v65
  v_cvt_pk_bf16_f32 v81, v66, v67
  v_cvt_pk_bf16_f32 v82, v68, v69
  v_cvt_pk_bf16_f32 v83, v70, v71
  v_rcp_f32 v149, v92
  s_nop 0
  v_mfma_f32_16x16x32_bf16 v[96:99], v[88:91], v[80:83], 0
  v_fma_f32 v72, v72, s60, -v150
  v_fma_f32 v73, v73, s60, -v150
  v_fma_f32 v74, v74, s60, -v150
  v_fma_f32 v75, v75, s60, -v150
  v_mul_f32 v52, v52, v149
  v_mul_f32 v53, v53, v149
  v_mul_f32 v54, v54, v149
  v_mul_f32 v55, v55, v149
  v_cvt_pk_bf16_f32 v76, v52, v53
  v_cvt_pk_bf16_f32 v77, v54, v55
  v_exp_f32 v72, v72
  v_exp_f32 v73, v73
  v_exp_f32 v74, v74
  v_exp_f32 v75, v75
  v_mov_b32 v79, 0
  v_cvt_pk_bf16_f32 v86, v72, v73
  s_nop 0
  v_mfma_f32_16x16x32_bf16 v[100:103], a[64:67], v[76:79], 0
  v_cvt_pk_bf16_f32 v87, v74, v75
  v_mfma_f32_16x16x32_bf16 v[104:107], a[68:71], v[76:79], 0
  v_mul_f32 v60, v60, v149
  v_mul_f32 v61, v61, v149
  v_mfma_f32_16x16x32_bf16 v[108:111], a[72:75], v[76:79], 0
  v_mul_f32 v62, v62, v149
  v_mul_f32 v63, v63, v149
  v_mfma_f32_16x16x32_bf16 v[112:115], a[76:79], v[76:79], 0
  v_cvt_pk_bf16_f32 v84, v60, v61
  v_mfma_f32_16x16x32_bf16 v[116:119], a[80:83], v[76:79], 0
  v_cvt_pk_bf16_f32 v85, v62, v63
  v_mfma_f32_16x16x32_bf16 v[120:123], a[84:87], v[76:79], 0
  v_mfma_f32_16x16x32_bf16 v[124:127], a[88:91], v[76:79], 0
  v_mfma_f32_16x16x32_bf16 v[128:131], a[92:95], v[76:79], 0
  v_mfma_f32_16x16x16_bf16 v[96:99], v[88:89], v[86:87], v[96:99]
  v_mfma_f32_16x16x16_bf16 v[100:103], v[36:37], v[84:85], v[100:103]
  v_mfma_f32_16x16x16_bf16 v[104:107], v[38:39], v[84:85], v[104:107]
  v_mfma_f32_16x16x16_bf16 v[108:111], v[40:41], v[84:85], v[108:111]
  s_nop 4
  v_rcp_f32 v151, v96
  v_mfma_f32_16x16x16_bf16 v[112:115], v[42:43], v[84:85], v[112:115]
  v_mul_f32 v64, v64, v151
  v_mul_f32 v65, v65, v151
  v_mfma_f32_16x16x16_bf16 v[116:119], v[44:45], v[84:85], v[116:119]
  v_mul_f32 v66, v66, v151
  v_mul_f32 v67, v67, v151
  v_mfma_f32_16x16x16_bf16 v[120:123], v[46:47], v[84:85], v[120:123]
  v_mul_f32 v68, v68, v151
  v_mul_f32 v69, v69, v151
  v_mfma_f32_16x16x16_bf16 v[124:127], v[48:49], v[84:85], v[124:127]
  v_mul_f32 v70, v70, v151
  v_mul_f32 v71, v71, v151
  v_mfma_f32_16x16x16_bf16 v[128:131], v[50:51], v[84:85], v[128:131]
  v_cvt_pk_bf16_f32 v80, v64, v65
  v_cvt_pk_bf16_f32 v81, v66, v67
  v_cvt_pk_bf16_f32 v82, v68, v69
  v_cvt_pk_bf16_f32 v83, v70, v71
  v_cvt_pk_bf16_f32 v132, v100, v101
  v_cvt_pk_bf16_f32 v133, v102, v103
  v_mfma_f32_16x16x32_bf16 v[100:103], a[64:67], v[80:83], 0
  v_cvt_pk_bf16_f32 v134, v104, v105
  v_cvt_pk_bf16_f32 v135, v106, v107
  v_mfma_f32_16x16x32_bf16 v[104:107], a[68:71], v[80:83], 0
  buffer_store_dwordx4 v[132:135], v1, s[8:11], s78 offen offset:0
  v_cvt_pk_bf16_f32 v136, v108, v109
  v_cvt_pk_bf16_f32 v137, v110, v111
  v_mfma_f32_16x16x32_bf16 v[108:111], a[72:75], v[80:83], 0
  v_cvt_pk_bf16_f32 v138, v112, v113
  v_cvt_pk_bf16_f32 v139, v114, v115
  v_mfma_f32_16x16x32_bf16 v[112:115], a[76:79], v[80:83], 0
  v_cvt_pk_bf16_f32 v140, v116, v117
  v_cvt_pk_bf16_f32 v141, v118, v119
  v_mfma_f32_16x16x32_bf16 v[116:119], a[80:83], v[80:83], 0
  v_cvt_pk_bf16_f32 v142, v120, v121
  v_cvt_pk_bf16_f32 v143, v122, v123
  v_mfma_f32_16x16x32_bf16 v[120:123], a[84:87], v[80:83], 0
  v_cvt_pk_bf16_f32 v144, v124, v125
  v_cvt_pk_bf16_f32 v145, v126, v127
  v_mfma_f32_16x16x32_bf16 v[124:127], a[88:91], v[80:83], 0
  buffer_store_dwordx4 v[136:139], v1, s[8:11], s78 offen offset:1024
  v_cvt_pk_bf16_f32 v146, v128, v129
  v_cvt_pk_bf16_f32 v147, v130, v131
  v_mfma_f32_16x16x32_bf16 v[128:131], a[92:95], v[80:83], 0
  v_mul_f32 v72, v72, v151
  v_mul_f32 v73, v73, v151
  v_mul_f32 v74, v74, v151
  v_mul_f32 v75, v75, v151
  v_cvt_pk_bf16_f32 v86, v72, v73
  v_cvt_pk_bf16_f32 v87, v74, v75
  s_nop 1
  v_mfma_f32_16x16x16_bf16 v[100:103], v[36:37], v[86:87], v[100:103]
  v_mfma_f32_16x16x16_bf16 v[104:107], v[38:39], v[86:87], v[104:107]
  v_mfma_f32_16x16x16_bf16 v[108:111], v[40:41], v[86:87], v[108:111]
  buffer_store_dwordx4 v[140:143], v1, s[8:11], s78 offen offset:2048
  v_mfma_f32_16x16x16_bf16 v[112:115], v[42:43], v[86:87], v[112:115]
  s_nop 3
  v_cvt_pk_bf16_f32 v132, v100, v101
  v_mfma_f32_16x16x16_bf16 v[116:119], v[44:45], v[86:87], v[116:119]
  v_cvt_pk_bf16_f32 v133, v102, v103
  v_mfma_f32_16x16x16_bf16 v[120:123], v[46:47], v[86:87], v[120:123]
  v_cvt_pk_bf16_f32 v134, v104, v105
  v_mfma_f32_16x16x16_bf16 v[124:127], v[48:49], v[86:87], v[124:127]
  v_cvt_pk_bf16_f32 v135, v106, v107
  v_mfma_f32_16x16x16_bf16 v[128:131], v[50:51], v[86:87], v[128:131]
  v_cvt_pk_bf16_f32 v136, v108, v109
  v_cvt_pk_bf16_f32 v137, v110, v111
  v_cvt_pk_bf16_f32 v138, v112, v113
  buffer_store_dwordx4 v[144:147], v1, s[8:11], s78 offen offset:3072
  v_cvt_pk_bf16_f32 v139, v114, v115
  v_cvt_pk_bf16_f32 v140, v116, v117
  v_cvt_pk_bf16_f32 v141, v118, v119
  v_cvt_pk_bf16_f32 v142, v120, v121
  v_cvt_pk_bf16_f32 v143, v122, v123
  v_cvt_pk_bf16_f32 v144, v124, v125
  v_cvt_pk_bf16_f32 v145, v126, v127
  v_cvt_pk_bf16_f32 v146, v128, v129
  v_cvt_pk_bf16_f32 v147, v130, v131
  buffer_store_dwordx4 v[132:135], v1, s[8:11], s36 offen offset:0
  buffer_store_dwordx4 v[136:139], v1, s[8:11], s36 offen offset:1024
  buffer_store_dwordx4 v[140:143], v1, s[8:11], s36 offen offset:2048
  buffer_store_dwordx4 v[144:147], v1, s[8:11], s36 offen offset:3072
  s_waitcnt vmcnt(0)
  s_mov_b64 exec, 15
  buffer_store_dword v4, v6, s[8:11], s92 offen
  s_mov_b64 exec, -1
  s_mov_b32 s92, 268435456
  s_add_u32 s73, s73, 1
  s_lshl_b32 s74, s71, 6
  s_add_u32 s74, s74, s73
  s_lshl_b32 s76, s74, 13
  s_add_u32 s76, s76, 22282240
  s_lshl_b32 s77, s74, 13
  s_add_u32 s77, s77, 23330816
  s_lshl_b32 s80, s74, 18
  s_lshl_b32 s35, s72, 13
  s_add_u32 s80, s80, s35
  s_add_u32 s80, s80, 110133248
  s_cmp_eq_u32 s93, 1
  s_cbranch_scc1 B_HAVE1L
B_KV1L:
  buffer_load_dword v5, v3, s[8:11], s76 offen sc1
  s_waitcnt vmcnt(0)
  s_mov_b64 exec, 15
  buffer_store_dword v4, v6, s[8:11], s92 offen
  s_mov_b64 exec, -1
  s_mov_b32 s92, 268435456
  v_cmp_eq_u32 vcc, 0, v5
  s_nop 0
  s_cbranch_vccz B_KVO1L
  s_cmp_eq_u32 s19, 0
  s_cbranch_scc1 B_KVO1L
  s_sub_u32 s19, s19, 1
  s_sleep 1
  s_branch B_KV1L
B_KVO1L:
  s_lshl_b32 s34, s74, 18
  s_lshl_b32 s35, s72, 13
  s_add_u32 s34, s34, s35
  s_add_u32 s34, s34, 177242112
  buffer_load_dwordx4 a[96:99], v1, s[8:11], s34 offen offset:0 sc1
  buffer_load_dwordx4 a[100:103], v1, s[8:11], s34 offen offset:1024 sc1
  buffer_load_dwordx4 a[104:107], v1, s[8:11], s34 offen offset:2048 sc1
  buffer_load_dwordx4 a[108:111], v1, s[8:11], s34 offen offset:3072 sc1
  s_add_u32 s34, s34, 4096
  buffer_load_dwordx4 a[112:115], v1, s[8:11], s34 offen offset:0 sc1
  buffer_load_dwordx4 a[116:119], v1, s[8:11], s34 offen offset:1024 sc1
  buffer_load_dwordx4 a[120:123], v1, s[8:11], s34 offen offset:2048 sc1
  buffer_load_dwordx4 a[124:127], v1, s[8:11], s34 offen offset:3072 sc1
  s_lshl_b32 s34, s74, 19
  s_lshl_b32 s35, s72, 14
  s_add_u32 s34, s34, s35
  s_add_u32 s34, s34, 43024384
  buffer_load_dwordx4 a[128:131], v1, s[8:11], s34 offen offset:0 sc1
  buffer_load_dwordx4 a[144:147], v1, s[8:11], s34 offen offset:1024 sc1
  buffer_load_dwordx4 a[160:163], v1, s[8:11], s34 offen offset:2048 sc1
  buffer_load_dwordx4 a[164:167], v1, s[8:11], s34 offen offset:3072 sc1
  s_add_u32 s34, s34, 4096
  buffer_load_dwordx4 a[132:135], v1, s[8:11], s34 offen offset:0 sc1
  buffer_load_dwordx4 a[148:151], v1, s[8:11], s34 offen offset:1024 sc1
  buffer_load_dwordx4 a[168:171], v1, s[8:11], s34 offen offset:2048 sc1
  buffer_load_dwordx4 a[172:175], v1, s[8:11], s34 offen offset:3072 sc1
  s_add_u32 s34, s34, 4096
  buffer_load_dwordx4 a[136:139], v1, s[8:11], s34 offen offset:0 sc1
  buffer_load_dwordx4 a[152:155], v1, s[8:11], s34 offen offset:1024 sc1
  buffer_load_dwordx4 a[176:179], v1, s[8:11], s34 offen offset:2048 sc1
  buffer_load_dwordx4 a[180:183], v1, s[8:11], s34 offen offset:3072 sc1
  s_add_u32 s34, s34, 4096
  buffer_load_dwordx4 a[140:143], v1, s[8:11], s34 offen offset:0 sc1
  buffer_load_dwordx4 a[156:159], v1, s[8:11], s34 offen offset:1024 sc1
  buffer_load_dwordx4 a[184:187], v1, s[8:11], s34 offen offset:2048 sc1
  buffer_load_dwordx4 a[188:191], v1, s[8:11], s34 offen offset:3072 sc1
B_HAVE1L:
  s_add_u32 s36, s76, 8192
  s_cmp_lt_u32 s73, 63
  s_cselect_b32 s36, s36, 268435456
  buffer_load_dword v5, v3, s[8:11], s36 offen sc1
  buffer_load_dword v7, v3, s[8:11], s77 offen sc1
  s_waitcnt vmcnt(0)
  s_mov_b64 exec, 15
  buffer_store_dword v4, v6, s[8:11], s92 offen
  s_mov_b64 exec, -1
  s_mov_b32 s92, 268435456
  v_cmp_eq_u32 vcc, 0, v7
  s_nop 0
  s_cbranch_vccz B1L_KMO
B1L_KMS:
  buffer_load_dword v7, v3, s[8:11], s77 offen sc1
  s_waitcnt vmcnt(0)
  v_cmp_eq_u32 vcc, 0, v7
  s_nop 0
  s_cbranch_vccz B1L_KMO
  s_cmp_eq_u32 s19, 0
  s_cbranch_scc1 B1L_KMO
  s_sub_u32 s19, s19, 1
  s_branch B1L_KMS
B1L_KMO:
  s_add_u32 s34, s80, 4096
  buffer_load_dwordx4 v[20:23], v1, s[8:11], s80 offen offset:0 sc1
  buffer_load_dwordx4 v[24:27], v1, s[8:11], s80 offen offset:2048 sc1
  buffer_load_dwordx4 v[28:31], v1, s[8:11], s34 offen offset:0 sc1
  buffer_load_dwordx4 v[32:35], v1, s[8:11], s34 offen offset:2048 sc1
  buffer_load_dwordx2 v[36:37], v2, s[8:11], s80 offen offset:1024 sc1
  buffer_load_dwordx2 v[38:39], v2, s[8:11], s80 offen offset:1536 sc1
  buffer_load_dwordx2 v[40:41], v2, s[8:11], s80 offen offset:3072 sc1
  buffer_load_dwordx2 v[42:43], v2, s[8:11], s80 offen offset:3584 sc1
  buffer_load_dwordx2 v[44:45], v2, s[8:11], s34 offen offset:1024 sc1
  buffer_load_dwordx2 v[46:47], v2, s[8:11], s34 offen offset:1536 sc1
  buffer_load_dwordx2 v[48:49], v2, s[8:11], s34 offen offset:3072 sc1
  buffer_load_dwordx2 v[50:51], v2, s[8:11], s34 offen offset:3584 sc1
  v_cmp_eq_u32 vcc, 0, v5
  s_nop 0
  s_cmp_eq_u64 vcc, 0
  s_cselect_b32 s93, 1, 0
  s_add_u32 s37, s74, 1
  s_lshl_b32 s82, s37, 18
  s_lshl_b32 s35, s72, 13
  s_add_u32 s82, s82, s35
  s_add_u32 s82, s82, 177242112
  s_lshl_b32 s83, s37, 19
  s_lshl_b32 s35, s72, 14
  s_add_u32 s83, s83, s35
  s_add_u32 s83, s83, 43024384
  s_cmp_eq_u32 s93, 1
  s_cselect_b32 s82, s82, 268435456
  s_cselect_b32 s83, s83, 268435456
  buffer_load_dwordx4 a[0:3], v1, s[8:11], s82 offen offset:0 sc1
  buffer_load_dwordx4 a[4:7], v1, s[8:11], s82 offen offset:1024 sc1
  buffer_load_dwordx4 a[8:11], v1, s[8:11], s82 offen offset:2048 sc1
  buffer_load_dwordx4 a[12:15], v1, s[8:11], s82 offen offset:3072 sc1
  s_add_u32 s82, s82, 4096
  buffer_load_dwordx4 a[16:19], v1, s[8:11], s82 offen offset:0 sc1
  buffer_load_dwordx4 a[20:23], v1, s[8:11], s82 offen offset:1024 sc1
  buffer_load_dwordx4 a[24:27], v1, s[8:11], s82 offen offset:2048 sc1
  buffer_load_dwordx4 a[28:31], v1, s[8:11], s82 offen offset:3072 sc1
  buffer_load_dwordx4 a[32:35], v1, s[8:11], s83 offen offset:0 sc1
  buffer_load_dwordx4 a[48:51], v1, s[8:11], s83 offen offset:1024 sc1
  buffer_load_dwordx4 a[64:67], v1, s[8:11], s83 offen offset:2048 sc1
  buffer_load_dwordx4 a[68:71], v1, s[8:11], s83 offen offset:3072 sc1
  s_add_u32 s83, s83, 4096
  buffer_load_dwordx4 a[36:39], v1, s[8:11], s83 offen offset:0 sc1
  buffer_load_dwordx4 a[52:55], v1, s[8:11], s83 offen offset:1024 sc1
  buffer_load_dwordx4 a[72:75], v1, s[8:11], s83 offen offset:2048 sc1
  buffer_load_dwordx4 a[76:79], v1, s[8:11], s83 offen offset:3072 sc1
  s_add_u32 s83, s83, 4096
  buffer_load_dwordx4 a[40:43], v1, s[8:11], s83 offen offset:0 sc1
  buffer_load_dwordx4 a[56:59], v1, s[8:11], s83 offen offset:1024 sc1
  buffer_load_dwordx4 a[80:83], v1, s[8:11], s83 offen offset:2048 sc1
  buffer_load_dwordx4 a[84:87], v1, s[8:11], s83 offen offset:3072 sc1
  s_add_u32 s83, s83, 4096
  buffer_load_dwordx4 a[44:47], v1, s[8:11], s83 offen offset:0 sc1
  buffer_load_dwordx4 a[60:63], v1, s[8:11], s83 offen offset:1024 sc1
  buffer_load_dwordx4 a[88:91], v1, s[8:11], s83 offen offset:2048 sc1
  buffer_load_dwordx4 a[92:95], v1, s[8:11], s83 offen offset:3072 sc1
  v_mfma_f32_16x16x32_bf16 v[52:55], a[128:131], a[96:99], v[8:11]
  v_mfma_f32_16x16x32_bf16 v[64:67], a[128:131], a[112:115], 0
  v_mfma_f32_16x16x32_bf16 v[68:71], a[144:147], a[112:115], v[12:15]
  v_mfma_f32_16x16x32_bf16 v[52:55], a[132:135], a[100:103], v[52:55]
  v_mfma_f32_16x16x32_bf16 v[64:67], a[132:135], a[116:119], v[64:67]
  v_mfma_f32_16x16x32_bf16 v[68:71], a[148:151], a[116:119], v[68:71]
  v_mfma_f32_16x16x32_bf16 v[52:55], a[136:139], a[104:107], v[52:55]
  v_mfma_f32_16x16x32_bf16 v[64:67], a[136:139], a[120:123], v[64:67]
  v_mfma_f32_16x16x32_bf16 v[68:71], a[152:155], a[120:123], v[68:71]
  v_mfma_f32_16x16x32_bf16 v[52:55], a[140:143], a[108:111], v[52:55]
  v_mfma_f32_16x16x32_bf16 v[64:67], a[140:143], a[124:127], v[64:67]
  v_mfma_f32_16x16x32_bf16 v[68:71], a[156:159], a[124:127], v[68:71]
  s_waitcnt vmcnt(24)
  v_mfma_f32_16x16x32_bf16 v[60:63], v[20:23], a[96:99], v[16:19]
  s_lshl_b32 s78, s74, 18
  s_nop 2
  v_max3_f32 v148, v52, v53, v54
  v_mfma_f32_16x16x32_bf16 v[60:63], v[24:27], a[100:103], v[60:63]
  s_lshl_b32 s35, s72, 13
  v_max3_f32 v150, v64, v65, v66
  v_mfma_f32_16x16x32_bf16 v[60:63], v[28:31], a[104:107], v[60:63]
  s_add_u32 s78, s78, s35
  v_max3_f32 v150, v150, v67, v68
  v_mfma_f32_16x16x32_bf16 v[60:63], v[32:35], a[108:111], v[60:63]
  s_add_u32 s78, s78, 143687680
  v_max3_f32 v150, v150, v69, v70
  v_mfma_f32_16x16x32_bf16 v[72:75], v[20:23], a[112:115], v[16:19]
  s_add_u32 s36, s78, 4096
  v_mov_b32 v88, 0x3f803f80
  v_mfma_f32_16x16x32_bf16 v[72:75], v[24:27], a[116:119], v[72:75]
  s_lshl_b32 s92, s74, 9
  v_mov_b32 v89, 0x3f803f80
  v_mfma_f32_16x16x32_bf16 v[72:75], v[28:31], a[120:123], v[72:75]
  s_add_u32 s92, s92, 24379392
  v_max3_f32 v148, v148, v55, v60
  v_mfma_f32_16x16x32_bf16 v[72:75], v[32:35], a[124:127], v[72:75]
  v_max3_f32 v148, v148, v61, v62
  v_max_f32 v148, v148, v63
  v_mov_b32 v149, v148
  v_mov_b32 v90, 0x3f803f80
  s_nop 0
  v_permlane16_swap_b32 v148, v149
  v_max_f32 v148, v148, v149
  v_mov_b32 v149, v148
  v_mov_b32 v91, 0x3f803f80
  s_nop 0
  v_permlane32_swap_b32 v148, v149
  v_max_f32 v148, v148, v149
  v_mul_f32 v148, s60, v148
  v_fma_f32 v52, v52, s60, -v148
  v_fma_f32 v53, v53, s60, -v148
  v_fma_f32 v54, v54, s60, -v148
  v_fma_f32 v55, v55, s60, -v148
  v_exp_f32 v52, v52
  v_exp_f32 v53, v53
  v_exp_f32 v54, v54
  v_exp_f32 v55, v55
  v_cvt_pk_bf16_f32 v76, v52, v53
  v_cvt_pk_bf16_f32 v77, v54, v55
  v_mov_b32 v78, 0
  v_mov_b32 v79, 0
  v_max3_f32 v150, v150, v71, v72
  s_nop 0
  v_mfma_f32_16x16x32_bf16 v[92:95], v[88:91], v[76:79], 0
  v_max3_f32 v150, v150, v73, v74
  v_max_f32 v150, v150, v75
  v_mov_b32 v151, v150
  v_fma_f32 v60, v60, s60, -v148
  v_fma_f32 v61, v61, s60, -v148
  v_fma_f32 v62, v62, s60, -v148
  v_fma_f32 v63, v63, s60, -v148
  v_exp_f32 v60, v60
  v_exp_f32 v61, v61
  v_exp_f32 v62, v62
  v_exp_f32 v63, v63
  v_permlane16_swap_b32 v150, v151
  v_max_f32 v150, v150, v151
  v_cvt_pk_bf16_f32 v84, v60, v61
  v_cvt_pk_bf16_f32 v85, v62, v63
  v_mov_b32 v151, v150
  v_mov_b32 v78, 0
  v_mfma_f32_16x16x16_bf16 v[92:95], v[88:89], v[84:85], v[92:95]
  v_permlane32_swap_b32 v150, v151
  v_max_f32 v150, v150, v151
  v_mul_f32 v150, s60, v150
  v_fma_f32 v64, v64, s60, -v150
  v_fma_f32 v65, v65, s60, -v150
  v_fma_f32 v66, v66, s60, -v150
  v_fma_f32 v67, v67, s60, -v150
  v_fma_f32 v68, v68, s60, -v150
  v_fma_f32 v69, v69, s60, -v150
  v_fma_f32 v70, v70, s60, -v150
  v_fma_f32 v71, v71, s60, -v150
  v_exp_f32 v64, v64
  v_exp_f32 v65, v65
  v_exp_f32 v66, v66
  v_exp_f32 v67, v67
  v_exp_f32 v68, v68
  v_exp_f32 v69, v69
  v_exp_f32 v70, v70
  v_exp_f32 v71, v71
  v_cvt_pk_bf16_f32 v80, v64, v65
  v_cvt_pk_bf16_f32 v81, v66, v67
  v_cvt_pk_bf16_f32 v82, v68, v69
  v_cvt_pk_bf16_f32 v83, v70, v71
  v_rcp_f32 v149, v92
  s_nop 0
  v_mfma_f32_16x16x32_bf16 v[96:99], v[88:91], v[80:83], 0
  v_fma_f32 v72, v72, s60, -v150
  v_fma_f32 v73, v73, s60, -v150
  v_fma_f32 v74, v74, s60, -v150
  v_fma_f32 v75, v75, s60, -v150
  v_mul_f32 v52, v52, v149
  v_mul_f32 v53, v53, v149
  v_mul_f32 v54, v54, v149
  v_mul_f32 v55, v55, v149
  v_cvt_pk_bf16_f32 v76, v52, v53
  v_cvt_pk_bf16_f32 v77, v54, v55
  v_exp_f32 v72, v72
  v_exp_f32 v73, v73
  v_exp_f32 v74, v74
  v_exp_f32 v75, v75
  v_mov_b32 v79, 0
  v_cvt_pk_bf16_f32 v86, v72, v73
  s_nop 0
  v_mfma_f32_16x16x32_bf16 v[100:103], a[160:163], v[76:79], 0
  v_cvt_pk_bf16_f32 v87, v74, v75
  v_mfma_f32_16x16x32_bf16 v[104:107], a[164:167], v[76:79], 0
  v_mul_f32 v60, v60, v149
  v_mul_f32 v61, v61, v149
  v_mfma_f32_16x16x32_bf16 v[108:111], a[168:171], v[76:79], 0
  v_mul_f32 v62, v62, v149
  v_mul_f32 v63, v63, v149
  v_mfma_f32_16x16x32_bf16 v[112:115], a[172:175], v[76:79], 0
  v_cvt_pk_bf16_f32 v84, v60, v61
  v_mfma_f32_16x16x32_bf16 v[116:119], a[176:179], v[76:79], 0
  v_cvt_pk_bf16_f32 v85, v62, v63
  v_mfma_f32_16x16x32_bf16 v[120:123], a[180:183], v[76:79], 0
  v_mfma_f32_16x16x32_bf16 v[124:127], a[184:187], v[76:79], 0
  v_mfma_f32_16x16x32_bf16 v[128:131], a[188:191], v[76:79], 0
  v_mfma_f32_16x16x16_bf16 v[96:99], v[88:89], v[86:87], v[96:99]
  v_mfma_f32_16x16x16_bf16 v[100:103], v[36:37], v[84:85], v[100:103]
  v_mfma_f32_16x16x16_bf16 v[104:107], v[38:39], v[84:85], v[104:107]
  v_mfma_f32_16x16x16_bf16 v[108:111], v[40:41], v[84:85], v[108:111]
  s_nop 4
  v_rcp_f32 v151, v96
  v_mfma_f32_16x16x16_bf16 v[112:115], v[42:43], v[84:85], v[112:115]
  v_mul_f32 v64, v64, v151
  v_mul_f32 v65, v65, v151
  v_mfma_f32_16x16x16_bf16 v[116:119], v[44:45], v[84:85], v[116:119]
  v_mul_f32 v66, v66, v151
  v_mul_f32 v67, v67, v151
  v_mfma_f32_16x16x16_bf16 v[120:123], v[46:47], v[84:85], v[120:123]
  v_mul_f32 v68, v68, v151
  v_mul_f32 v69, v69, v151
  v_mfma_f32_16x16x16_bf16 v[124:127], v[48:49], v[84:85], v[124:127]
  v_mul_f32 v70, v70, v151
  v_mul_f32 v71, v71, v151
  v_mfma_f32_16x16x16_bf16 v[128:131], v[50:51], v[84:85], v[128:131]
  v_cvt_pk_bf16_f32 v80, v64, v65
  v_cvt_pk_bf16_f32 v81, v66, v67
  v_cvt_pk_bf16_f32 v82, v68, v69
  v_cvt_pk_bf16_f32 v83, v70, v71
  v_cvt_pk_bf16_f32 v132, v100, v101
  v_cvt_pk_bf16_f32 v133, v102, v103
  v_mfma_f32_16x16x32_bf16 v[100:103], a[160:163], v[80:83], 0
  v_cvt_pk_bf16_f32 v134, v104, v105
  v_cvt_pk_bf16_f32 v135, v106, v107
  v_mfma_f32_16x16x32_bf16 v[104:107], a[164:167], v[80:83], 0
  buffer_store_dwordx4 v[132:135], v1, s[8:11], s78 offen offset:0
  v_cvt_pk_bf16_f32 v136, v108, v109
  v_cvt_pk_bf16_f32 v137, v110, v111
  v_mfma_f32_16x16x32_bf16 v[108:111], a[168:171], v[80:83], 0
  v_cvt_pk_bf16_f32 v138, v112, v113
  v_cvt_pk_bf16_f32 v139, v114, v115
  v_mfma_f32_16x16x32_bf16 v[112:115], a[172:175], v[80:83], 0
  v_cvt_pk_bf16_f32 v140, v116, v117
  v_cvt_pk_bf16_f32 v141, v118, v119
  v_mfma_f32_16x16x32_bf16 v[116:119], a[176:179], v[80:83], 0
  v_cvt_pk_bf16_f32 v142, v120, v121
  v_cvt_pk_bf16_f32 v143, v122, v123
  v_mfma_f32_16x16x32_bf16 v[120:123], a[180:183], v[80:83], 0
  v_cvt_pk_bf16_f32 v144, v124, v125
  v_cvt_pk_bf16_f32 v145, v126, v127
  v_mfma_f32_16x16x32_bf16 v[124:127], a[184:187], v[80:83], 0
  buffer_store_dwordx4 v[136:139], v1, s[8:11], s78 offen offset:1024
  v_cvt_pk_bf16_f32 v146, v128, v129
  v_cvt_pk_bf16_f32 v147, v130, v131
  v_mfma_f32_16x16x32_bf16 v[128:131], a[188:191], v[80:83], 0
  v_mul_f32 v72, v72, v151
  v_mul_f32 v73, v73, v151
  v_mul_f32 v74, v74, v151
  v_mul_f32 v75, v75, v151
  v_cvt_pk_bf16_f32 v86, v72, v73
  v_cvt_pk_bf16_f32 v87, v74, v75
  s_nop 1
  v_mfma_f32_16x16x16_bf16 v[100:103], v[36:37], v[86:87], v[100:103]
  v_mfma_f32_16x16x16_bf16 v[104:107], v[38:39], v[86:87], v[104:107]
  v_mfma_f32_16x16x16_bf16 v[108:111], v[40:41], v[86:87], v[108:111]
  buffer_store_dwordx4 v[140:143], v1, s[8:11], s78 offen offset:2048
  v_mfma_f32_16x16x16_bf16 v[112:115], v[42:43], v[86:87], v[112:115]
  s_nop 3
  v_cvt_pk_bf16_f32 v132, v100, v101
  v_mfma_f32_16x16x16_bf16 v[116:119], v[44:45], v[86:87], v[116:119]
  v_cvt_pk_bf16_f32 v133, v102, v103
  v_mfma_f32_16x16x16_bf16 v[120:123], v[46:47], v[86:87], v[120:123]
  v_cvt_pk_bf16_f32 v134, v104, v105
  v_mfma_f32_16x16x16_bf16 v[124:127], v[48:49], v[86:87], v[124:127]
  v_cvt_pk_bf16_f32 v135, v106, v107
  v_mfma_f32_16x16x16_bf16 v[128:131], v[50:51], v[86:87], v[128:131]
  v_cvt_pk_bf16_f32 v136, v108, v109
  v_cvt_pk_bf16_f32 v137, v110, v111
  v_cvt_pk_bf16_f32 v138, v112, v113
  buffer_store_dwordx4 v[144:147], v1, s[8:11], s78 offen offset:3072
  v_cvt_pk_bf16_f32 v139, v114, v115
  v_cvt_pk_bf16_f32 v140, v116, v117
  v_cvt_pk_bf16_f32 v141, v118, v119
  v_cvt_pk_bf16_f32 v142, v120, v121
  v_cvt_pk_bf16_f32 v143, v122, v123
  v_cvt_pk_bf16_f32 v144, v124, v125
  v_cvt_pk_bf16_f32 v145, v126, v127
  v_cvt_pk_bf16_f32 v146, v128, v129
  v_cvt_pk_bf16_f32 v147, v130, v131
  buffer_store_dwordx4 v[132:135], v1, s[8:11], s36 offen offset:0
  buffer_store_dwordx4 v[136:139], v1, s[8:11], s36 offen offset:1024
  buffer_store_dwordx4 v[140:143], v1, s[8:11], s36 offen offset:2048
  buffer_store_dwordx4 v[144:147], v1, s[8:11], s36 offen offset:3072
  s_waitcnt vmcnt(0)
  s_mov_b64 exec, 15
  buffer_store_dword v4, v6, s[8:11], s92 offen
  s_mov_b64 exec, -1
  s_mov_b32 s92, 268435456
  s_add_u32 s73, s73, 1
  s_cmp_lt_u32 s73, 64
  s_cbranch_scc1 B_LOOPL
  s_waitcnt vmcnt(0)
  s_mov_b64 exec, 15
  buffer_store_dword v4, v6, s[8:11], s92 offen
  s_mov_b64 exec, -1
  s_mov_b32 s92, 268435456
  s_endpgm
ROLE_CL:
  s_lshr_b32 s70, s17, 4
  s_lshr_b32 s71, s17, 1
  s_and_b32 s71, s71, 7
  s_and_b32 s72, s17, 1
  v_and_b32 v14, 63, v0
  v_lshlrev_b32 v1, 4, v14
  v_and_b32 v2, 15, v14
  v_lshlrev_b32 v2, 2, v2
  s_lshl_b32 s76, s71, 6
  v_add_u32 v2, s76, v2
  v_mov_b32 v3, 1
  v_and_b32 v15, 15, v14
  v_lshrrev_b32 v13, 4, v14
  v_lshlrev_b32 v5, 10, v15
  v_lshl_add_u32 v5, v13, 4, v5
  s_lshl_b32 s76, s72, 3
  s_lshl_b32 s77, s16, 1
  s_add_u32 s76, s76, s77
  s_lshl_b32 s77, s76, 6
  s_lshl_b32 s78, s71, 15
  s_add_u32 s77, s77, s78
  v_add_u32 v5, s77, v5
  s_and_b32 s77, s17, 15
  s_lshl_b32 s77, s77, 2
  s_add_u32 s77, s77, s16
  s_lshl_b32 s77, s77, 2
  v_mov_b32 v6, s77
  s_cmp_eq_u32 s70, 0
  s_cbranch_scc1 CL_NOSTAGE_15
  s_call_b64 s[100:101], VERIFY
  s_cbranch_scc1 VER_OK_17
  v_mov_b32 v0, v116
  s_waitcnt vmcnt(0) lgkmcnt(0)
  s_barrier
  s_branch DISPATCH
VER_OK_17:
  v_mbcnt_lo_u32_b32 v116, -1, 0
  v_mbcnt_hi_u32_b32 v116, -1, v116
  v_and_b32 v116, 31, v116
  v_lshlrev_b32 v116, 6, v116
  s_mov_b32 s44, 24805376
CL_GOSPIN_16:
  buffer_load_dword v117, v116, s[8:11], s44 offen sc1
  s_waitcnt vmcnt(0)
  v_cmp_eq_u32 vcc, 0, v117
  s_nop 0
  s_cbranch_vccz CL_NOSTAGE_15
  s_cmp_eq_u32 s19, 0
  s_cbranch_scc1 CL_NOSTAGE_15
  s_sub_u32 s19, s19, 1
  s_sleep 8
  s_branch CL_GOSPIN_16
CL_NOSTAGE_15:
  s_lshl_b32 s41, s16, 15
  v_lshrrev_b32 v100, 4, v14
  v_lshlrev_b32 v100, 3, v100
  v_lshrrev_b32 v102, 2, v14
  v_and_b32 v102, 3, v102
  v_add_u32 v100, v100, v102
  v_lshlrev_b32 v100, 6, v100
  v_and_b32 v102, 3, v14
  v_lshl_add_u32 v100, v102, 4, v100
  v_add_u32 v100, s41, v100
  v_lshrrev_b32 v102, 2, v14
  s_mov_b32 s40, 1024
  v_mul_lo_u32 v102, v102, s40
  v_and_b32 v101, 3, v14
  v_lshl_add_u32 v102, v101, 4, v102
  s_lshl_b32 s44, s71, 19
  s_lshl_b32 s45, s76, 6
  s_add_u32 s44, s44, s45
  s_load_dwordx2 s[42:43], s[0:1], 40
  s_waitcnt lgkmcnt(0)
  s_mov_b32 s36, s42
  s_and_b32 s37, s43, 0xffff
  s_mov_b32 s38, 4194304
  s_mov_b32 s39, 0x20000
  s_add_u32 s40, s44, 0
  s_add_u32 m0, s41, 0
  s_nop 0
  buffer_load_dwordx4 v102, s[36:39], s40 offen lds
  s_add_u32 s40, s40, 16384
  s_add_u32 m0, s41, 1024
  s_nop 0
  buffer_load_dwordx4 v102, s[36:39], s40 offen lds
  s_add_u32 s40, s44, 64
  s_add_u32 m0, s41, 2048
  s_nop 0
  buffer_load_dwordx4 v102, s[36:39], s40 offen lds
  s_add_u32 s40, s40, 16384
  s_add_u32 m0, s41, 3072
  s_nop 0
  buffer_load_dwordx4 v102, s[36:39], s40 offen lds
  s_add_u32 s40, s44, 32768
  s_add_u32 m0, s41, 4096
  s_nop 0
  buffer_load_dwordx4 v102, s[36:39], s40 offen lds
  s_add_u32 s40, s40, 16384
  s_add_u32 m0, s41, 5120
  s_nop 0
  buffer_load_dwordx4 v102, s[36:39], s40 offen lds
  s_add_u32 s40, s44, 32832
  s_add_u32 m0, s41, 6144
  s_nop 0
  buffer_load_dwordx4 v102, s[36:39], s40 offen lds
  s_add_u32 s40, s40, 16384
  s_add_u32 m0, s41, 7168
  s_nop 0
  buffer_load_dwordx4 v102, s[36:39], s40 offen lds
  s_add_u32 s40, s44, 65536
  s_add_u32 m0, s41, 8192
  s_nop 0
  buffer_load_dwordx4 v102, s[36:39], s40 offen lds
  s_add_u32 s40, s40, 16384
  s_add_u32 m0, s41, 9216
  s_nop 0
  buffer_load_dwordx4 v102, s[36:39], s40 offen lds
  s_add_u32 s40, s44, 65600
  s_add_u32 m0, s41, 10240
  s_nop 0
  buffer_load_dwordx4 v102, s[36:39], s40 offen lds
  s_add_u32 s40, s40, 16384
  s_add_u32 m0, s41, 11264
  s_nop 0
  buffer_load_dwordx4 v102, s[36:39], s40 offen lds
  s_add_u32 s40, s44, 98304
  s_add_u32 m0, s41, 12288
  s_nop 0
  buffer_load_dwordx4 v102, s[36:39], s40 offen lds
  s_add_u32 s40, s40, 16384
  s_add_u32 m0, s41, 13312
  s_nop 0
  buffer_load_dwordx4 v102, s[36:39], s40 offen lds
  s_add_u32 s40, s44, 98368
  s_add_u32 m0, s41, 14336
  s_nop 0
  buffer_load_dwordx4 v102, s[36:39], s40 offen lds
  s_add_u32 s40, s40, 16384
  s_add_u32 m0, s41, 15360
  s_nop 0
  buffer_load_dwordx4 v102, s[36:39], s40 offen lds
  s_add_u32 s40, s44, 131072
  s_add_u32 m0, s41, 16384
  s_nop 0
  buffer_load_dwordx4 v102, s[36:39], s40 offen lds
  s_add_u32 s40, s40, 16384
  s_add_u32 m0, s41, 17408
  s_nop 0
  buffer_load_dwordx4 v102, s[36:39], s40 offen lds
  s_add_u32 s40, s44, 131136
  s_add_u32 m0, s41, 18432
  s_nop 0
  buffer_load_dwordx4 v102, s[36:39], s40 offen lds
  s_add_u32 s40, s40, 16384
  s_add_u32 m0, s41, 19456
  s_nop 0
  buffer_load_dwordx4 v102, s[36:39], s40 offen lds
  s_add_u32 s40, s44, 163840
  s_add_u32 m0, s41, 20480
  s_nop 0
  buffer_load_dwordx4 v102, s[36:39], s40 offen lds
  s_add_u32 s40, s40, 16384
  s_add_u32 m0, s41, 21504
  s_nop 0
  buffer_load_dwordx4 v102, s[36:39], s40 offen lds
  s_add_u32 s40, s44, 163904
  s_add_u32 m0, s41, 22528
  s_nop 0
  buffer_load_dwordx4 v102, s[36:39], s40 offen lds
  s_add_u32 s40, s40, 16384
  s_add_u32 m0, s41, 23552
  s_nop 0
  buffer_load_dwordx4 v102, s[36:39], s40 offen lds
  s_add_u32 s40, s44, 196608
  s_add_u32 m0, s41, 24576
  s_nop 0
  buffer_load_dwordx4 v102, s[36:39], s40 offen lds
  s_add_u32 s40, s40, 16384
  s_add_u32 m0, s41, 25600
  s_nop 0
  buffer_load_dwordx4 v102, s[36:39], s40 offen lds
  s_add_u32 s40, s44, 196672
  s_add_u32 m0, s41, 26624
  s_nop 0
  buffer_load_dwordx4 v102, s[36:39], s40 offen lds
  s_add_u32 s40, s40, 16384
  s_add_u32 m0, s41, 27648
  s_nop 0
  buffer_load_dwordx4 v102, s[36:39], s40 offen lds
  s_add_u32 s40, s44, 229376
  s_add_u32 m0, s41, 28672
  s_nop 0
  buffer_load_dwordx4 v102, s[36:39], s40 offen lds
  s_add_u32 s40, s40, 16384
  s_add_u32 m0, s41, 29696
  s_nop 0
  buffer_load_dwordx4 v102, s[36:39], s40 offen lds
  s_add_u32 s40, s44, 229440
  s_add_u32 m0, s41, 30720
  s_nop 0
  buffer_load_dwordx4 v102, s[36:39], s40 offen lds
  s_add_u32 s40, s40, 16384
  s_add_u32 m0, s41, 31744
  s_nop 0
  buffer_load_dwordx4 v102, s[36:39], s40 offen lds
  s_waitcnt vmcnt(16)
  ds_read_b64_tr_b16 a[0:1], v100 offset:0
  ds_read_b64_tr_b16 a[2:3], v100 offset:256
  ds_read_b64_tr_b16 a[64:65], v100 offset:8
  ds_read_b64_tr_b16 a[66:67], v100 offset:264
  ds_read_b64_tr_b16 a[128:129], v100 offset:2048
  ds_read_b64_tr_b16 a[130:131], v100 offset:2304
  ds_read_b64_tr_b16 a[192:193], v100 offset:2056
  ds_read_b64_tr_b16 a[194:195], v100 offset:2312
  s_waitcnt lgkmcnt(4)
  ds_read_b64_tr_b16 a[4:5], v100 offset:4096
  ds_read_b64_tr_b16 a[6:7], v100 offset:4352
  ds_read_b64_tr_b16 a[68:69], v100 offset:4104
  ds_read_b64_tr_b16 a[70:71], v100 offset:4360
  ds_read_b64_tr_b16 a[132:133], v100 offset:6144
  ds_read_b64_tr_b16 a[134:135], v100 offset:6400
  ds_read_b64_tr_b16 a[196:197], v100 offset:6152
  ds_read_b64_tr_b16 a[198:199], v100 offset:6408
  s_waitcnt lgkmcnt(4)
  ds_read_b64_tr_b16 a[8:9], v100 offset:8192
  ds_read_b64_tr_b16 a[10:11], v100 offset:8448
  ds_read_b64_tr_b16 a[72:73], v100 offset:8200
  ds_read_b64_tr_b16 a[74:75], v100 offset:8456
  ds_read_b64_tr_b16 a[136:137], v100 offset:10240
  ds_read_b64_tr_b16 a[138:139], v100 offset:10496
  ds_read_b64_tr_b16 a[200:201], v100 offset:10248
  ds_read_b64_tr_b16 a[202:203], v100 offset:10504
  s_waitcnt lgkmcnt(4)
  ds_read_b64_tr_b16 a[12:13], v100 offset:12288
  ds_read_b64_tr_b16 a[14:15], v100 offset:12544
  ds_read_b64_tr_b16 a[76:77], v100 offset:12296
  ds_read_b64_tr_b16 a[78:79], v100 offset:12552
  ds_read_b64_tr_b16 a[140:141], v100 offset:14336
  ds_read_b64_tr_b16 a[142:143], v100 offset:14592
  ds_read_b64_tr_b16 a[204:205], v100 offset:14344
  ds_read_b64_tr_b16 a[206:207], v100 offset:14600
  s_waitcnt lgkmcnt(4)
  s_waitcnt lgkmcnt(0)
  s_add_u32 s40, s44, 262144
  s_add_u32 m0, s41, 0
  s_nop 0
  buffer_load_dwordx4 v102, s[36:39], s40 offen lds
  s_add_u32 s40, s40, 16384
  s_add_u32 m0, s41, 1024
  s_nop 0
  buffer_load_dwordx4 v102, s[36:39], s40 offen lds
  s_add_u32 s40, s44, 262208
  s_add_u32 m0, s41, 2048
  s_nop 0
  buffer_load_dwordx4 v102, s[36:39], s40 offen lds
  s_add_u32 s40, s40, 16384
  s_add_u32 m0, s41, 3072
  s_nop 0
  buffer_load_dwordx4 v102, s[36:39], s40 offen lds
  s_add_u32 s40, s44, 294912
  s_add_u32 m0, s41, 4096
  s_nop 0
  buffer_load_dwordx4 v102, s[36:39], s40 offen lds
  s_add_u32 s40, s40, 16384
  s_add_u32 m0, s41, 5120
  s_nop 0
  buffer_load_dwordx4 v102, s[36:39], s40 offen lds
  s_add_u32 s40, s44, 294976
  s_add_u32 m0, s41, 6144
  s_nop 0
  buffer_load_dwordx4 v102, s[36:39], s40 offen lds
  s_add_u32 s40, s40, 16384
  s_add_u32 m0, s41, 7168
  s_nop 0
  buffer_load_dwordx4 v102, s[36:39], s40 offen lds
  s_add_u32 s40, s44, 327680
  s_add_u32 m0, s41, 8192
  s_nop 0
  buffer_load_dwordx4 v102, s[36:39], s40 offen lds
  s_add_u32 s40, s40, 16384
  s_add_u32 m0, s41, 9216
  s_nop 0
  buffer_load_dwordx4 v102, s[36:39], s40 offen lds
  s_add_u32 s40, s44, 327744
  s_add_u32 m0, s41, 10240
  s_nop 0
  buffer_load_dwordx4 v102, s[36:39], s40 offen lds
  s_add_u32 s40, s40, 16384
  s_add_u32 m0, s41, 11264
  s_nop 0
  buffer_load_dwordx4 v102, s[36:39], s40 offen lds
  s_add_u32 s40, s44, 360448
  s_add_u32 m0, s41, 12288
  s_nop 0
  buffer_load_dwordx4 v102, s[36:39], s40 offen lds
  s_add_u32 s40, s40, 16384
  s_add_u32 m0, s41, 13312
  s_nop 0
  buffer_load_dwordx4 v102, s[36:39], s40 offen lds
  s_add_u32 s40, s44, 360512
  s_add_u32 m0, s41, 14336
  s_nop 0
  buffer_load_dwordx4 v102, s[36:39], s40 offen lds
  s_add_u32 s40, s40, 16384
  s_add_u32 m0, s41, 15360
  s_nop 0
  buffer_load_dwordx4 v102, s[36:39], s40 offen lds
  s_waitcnt vmcnt(16)
  ds_read_b64_tr_b16 a[16:17], v100 offset:16384
  ds_read_b64_tr_b16 a[18:19], v100 offset:16640
  ds_read_b64_tr_b16 a[80:81], v100 offset:16392
  ds_read_b64_tr_b16 a[82:83], v100 offset:16648
  ds_read_b64_tr_b16 a[144:145], v100 offset:18432
  ds_read_b64_tr_b16 a[146:147], v100 offset:18688
  ds_read_b64_tr_b16 a[208:209], v100 offset:18440
  ds_read_b64_tr_b16 a[210:211], v100 offset:18696
  s_waitcnt lgkmcnt(4)
  ds_read_b64_tr_b16 a[20:21], v100 offset:20480
  ds_read_b64_tr_b16 a[22:23], v100 offset:20736
  ds_read_b64_tr_b16 a[84:85], v100 offset:20488
  ds_read_b64_tr_b16 a[86:87], v100 offset:20744
  ds_read_b64_tr_b16 a[148:149], v100 offset:22528
  ds_read_b64_tr_b16 a[150:151], v100 offset:22784
  ds_read_b64_tr_b16 a[212:213], v100 offset:22536
  ds_read_b64_tr_b16 a[214:215], v100 offset:22792
  s_waitcnt lgkmcnt(4)
  ds_read_b64_tr_b16 a[24:25], v100 offset:24576
  ds_read_b64_tr_b16 a[26:27], v100 offset:24832
  ds_read_b64_tr_b16 a[88:89], v100 offset:24584
  ds_read_b64_tr_b16 a[90:91], v100 offset:24840
  ds_read_b64_tr_b16 a[152:153], v100 offset:26624
  ds_read_b64_tr_b16 a[154:155], v100 offset:26880
  ds_read_b64_tr_b16 a[216:217], v100 offset:26632
  ds_read_b64_tr_b16 a[218:219], v100 offset:26888
  s_waitcnt lgkmcnt(4)
  ds_read_b64_tr_b16 a[28:29], v100 offset:28672
  ds_read_b64_tr_b16 a[30:31], v100 offset:28928
  ds_read_b64_tr_b16 a[92:93], v100 offset:28680
  ds_read_b64_tr_b16 a[94:95], v100 offset:28936
  ds_read_b64_tr_b16 a[156:157], v100 offset:30720
  ds_read_b64_tr_b16 a[158:159], v100 offset:30976
  ds_read_b64_tr_b16 a[220:221], v100 offset:30728
  ds_read_b64_tr_b16 a[222:223], v100 offset:30984
  s_waitcnt lgkmcnt(4)
  s_waitcnt lgkmcnt(0)
  s_add_u32 s40, s44, 393216
  s_add_u32 m0, s41, 16384
  s_nop 0
  buffer_load_dwordx4 v102, s[36:39], s40 offen lds
  s_add_u32 s40, s40, 16384
  s_add_u32 m0, s41, 17408
  s_nop 0
  buffer_load_dwordx4 v102, s[36:39], s40 offen lds
  s_add_u32 s40, s44, 393280
  s_add_u32 m0, s41, 18432
  s_nop 0
  buffer_load_dwordx4 v102, s[36:39], s40 offen lds
  s_add_u32 s40, s40, 16384
  s_add_u32 m0, s41, 19456
  s_nop 0
  buffer_load_dwordx4 v102, s[36:39], s40 offen lds
  s_add_u32 s40, s44, 425984
  s_add_u32 m0, s41, 20480
  s_nop 0
  buffer_load_dwordx4 v102, s[36:39], s40 offen lds
  s_add_u32 s40, s40, 16384
  s_add_u32 m0, s41, 21504
  s_nop 0
  buffer_load_dwordx4 v102, s[36:39], s40 offen lds
  s_add_u32 s40, s44, 426048
  s_add_u32 m0, s41, 22528
  s_nop 0
  buffer_load_dwordx4 v102, s[36:39], s40 offen lds
  s_add_u32 s40, s40, 16384
  s_add_u32 m0, s41, 23552
  s_nop 0
  buffer_load_dwordx4 v102, s[36:39], s40 offen lds
  s_add_u32 s40, s44, 458752
  s_add_u32 m0, s41, 24576
  s_nop 0
  buffer_load_dwordx4 v102, s[36:39], s40 offen lds
  s_add_u32 s40, s40, 16384
  s_add_u32 m0, s41, 25600
  s_nop 0
  buffer_load_dwordx4 v102, s[36:39], s40 offen lds
  s_add_u32 s40, s44, 458816
  s_add_u32 m0, s41, 26624
  s_nop 0
  buffer_load_dwordx4 v102, s[36:39], s40 offen lds
  s_add_u32 s40, s40, 16384
  s_add_u32 m0, s41, 27648
  s_nop 0
  buffer_load_dwordx4 v102, s[36:39], s40 offen lds
  s_add_u32 s40, s44, 491520
  s_add_u32 m0, s41, 28672
  s_nop 0
  buffer_load_dwordx4 v102, s[36:39], s40 offen lds
  s_add_u32 s40, s40, 16384
  s_add_u32 m0, s41, 29696
  s_nop 0
  buffer_load_dwordx4 v102, s[36:39], s40 offen lds
  s_add_u32 s40, s44, 491584
  s_add_u32 m0, s41, 30720
  s_nop 0
  buffer_load_dwordx4 v102, s[36:39], s40 offen lds
  s_add_u32 s40, s40, 16384
  s_add_u32 m0, s41, 31744
  s_nop 0
  buffer_load_dwordx4 v102, s[36:39], s40 offen lds
  s_waitcnt vmcnt(16)
  ds_read_b64_tr_b16 a[32:33], v100 offset:0
  ds_read_b64_tr_b16 a[34:35], v100 offset:256
  ds_read_b64_tr_b16 a[96:97], v100 offset:8
  ds_read_b64_tr_b16 a[98:99], v100 offset:264
  ds_read_b64_tr_b16 a[160:161], v100 offset:2048
  ds_read_b64_tr_b16 a[162:163], v100 offset:2304
  ds_read_b64_tr_b16 a[224:225], v100 offset:2056
  ds_read_b64_tr_b16 a[226:227], v100 offset:2312
  s_waitcnt lgkmcnt(4)
  ds_read_b64_tr_b16 a[36:37], v100 offset:4096
  ds_read_b64_tr_b16 a[38:39], v100 offset:4352
  ds_read_b64_tr_b16 a[100:101], v100 offset:4104
  ds_read_b64_tr_b16 a[102:103], v100 offset:4360
  ds_read_b64_tr_b16 a[164:165], v100 offset:6144
  ds_read_b64_tr_b16 a[166:167], v100 offset:6400
  ds_read_b64_tr_b16 a[228:229], v100 offset:6152
  ds_read_b64_tr_b16 a[230:231], v100 offset:6408
  s_waitcnt lgkmcnt(4)
  ds_read_b64_tr_b16 a[40:41], v100 offset:8192
  ds_read_b64_tr_b16 a[42:43], v100 offset:8448
  ds_read_b64_tr_b16 a[104:105], v100 offset:8200
  ds_read_b64_tr_b16 a[106:107], v100 offset:8456
  ds_read_b64_tr_b16 a[168:169], v100 offset:10240
  ds_read_b64_tr_b16 a[170:171], v100 offset:10496
  ds_read_b64_tr_b16 a[232:233], v100 offset:10248
  ds_read_b64_tr_b16 a[234:235], v100 offset:10504
  s_waitcnt lgkmcnt(4)
  ds_read_b64_tr_b16 a[44:45], v100 offset:12288
  ds_read_b64_tr_b16 a[46:47], v100 offset:12544
  ds_read_b64_tr_b16 a[108:109], v100 offset:12296
  ds_read_b64_tr_b16 a[110:111], v100 offset:12552
  ds_read_b64_tr_b16 a[172:173], v100 offset:14336
  ds_read_b64_tr_b16 a[174:175], v100 offset:14592
  ds_read_b64_tr_b16 a[236:237], v100 offset:14344
  ds_read_b64_tr_b16 a[238:239], v100 offset:14600
  s_waitcnt lgkmcnt(4)
  s_waitcnt lgkmcnt(0)
  s_waitcnt vmcnt(0)
  ds_read_b64_tr_b16 a[48:49], v100 offset:16384
  ds_read_b64_tr_b16 a[50:51], v100 offset:16640
  ds_read_b64_tr_b16 a[112:113], v100 offset:16392
  ds_read_b64_tr_b16 a[114:115], v100 offset:16648
  ds_read_b64_tr_b16 a[176:177], v100 offset:18432
  ds_read_b64_tr_b16 a[178:179], v100 offset:18688
  ds_read_b64_tr_b16 a[240:241], v100 offset:18440
  ds_read_b64_tr_b16 a[242:243], v100 offset:18696
  s_waitcnt lgkmcnt(4)
  ds_read_b64_tr_b16 a[52:53], v100 offset:20480
  ds_read_b64_tr_b16 a[54:55], v100 offset:20736
  ds_read_b64_tr_b16 a[116:117], v100 offset:20488
  ds_read_b64_tr_b16 a[118:119], v100 offset:20744
  ds_read_b64_tr_b16 a[180:181], v100 offset:22528
  ds_read_b64_tr_b16 a[182:183], v100 offset:22784
  ds_read_b64_tr_b16 a[244:245], v100 offset:22536
  ds_read_b64_tr_b16 a[246:247], v100 offset:22792
  s_waitcnt lgkmcnt(4)
  ds_read_b64_tr_b16 a[56:57], v100 offset:24576
  ds_read_b64_tr_b16 a[58:59], v100 offset:24832
  ds_read_b64_tr_b16 a[120:121], v100 offset:24584
  ds_read_b64_tr_b16 a[122:123], v100 offset:24840
  ds_read_b64_tr_b16 a[184:185], v100 offset:26624
  ds_read_b64_tr_b16 a[186:187], v100 offset:26880
  ds_read_b64_tr_b16 a[248:249], v100 offset:26632
  ds_read_b64_tr_b16 a[250:251], v100 offset:26888
  s_waitcnt lgkmcnt(4)
  ds_read_b64_tr_b16 a[60:61], v100 offset:28672
  ds_read_b64_tr_b16 a[62:63], v100 offset:28928
  ds_read_b64_tr_b16 a[124:125], v100 offset:28680
  ds_read_b64_tr_b16 a[126:127], v100 offset:28936
  ds_read_b64_tr_b16 a[188:189], v100 offset:30720
  ds_read_b64_tr_b16 a[190:191], v100 offset:30976
  ds_read_b64_tr_b16 a[252:253], v100 offset:30728
  ds_read_b64_tr_b16 a[254:255], v100 offset:30984
  s_waitcnt lgkmcnt(4)
  s_waitcnt lgkmcnt(0)
  s_call_b64 s[100:101], VERIFY
  s_cbranch_scc1 VER_OK_18
  v_mov_b32 v0, v116
  s_waitcnt vmcnt(0) lgkmcnt(0)
  s_barrier
  s_branch DISPATCH
VER_OK_18:
  s_barrier
  s_mov_b32 s73, 0
  s_mov_b32 s93, 0
  s_mov_b32 s92, 268435456
  s_mov_b32 s86, 0
C_LOOPL:
  s_lshl_b32 s74, s70, 6
  s_add_u32 s74, s74, s73
  s_lshl_b32 s84, s74, 9
  s_add_u32 s84, s84, 24379392
  s_add_u32 s85, s84, 512
  s_cmp_lt_u32 s73, 63
  s_cselect_b32 s85, s85, 268435456
  s_cmp_eq_u32 s93, 1
  s_cbranch_scc1 CL_HAVE_19
CL_W_SPIN_21:
  buffer_load_dword v4, v2, s[8:11], s84 offen sc1
  s_waitcnt vmcnt(0)
  s_mov_b64 exec, 1
  buffer_store_dword v3, v6, s[8:11], s92 offen
  s_mov_b64 exec, -1
  s_mov_b32 s92, 268435456
  v_cmp_eq_u32 vcc, 0, v4
  s_nop 0
  s_cbranch_vccz CL_W_OK_22
  s_cmp_eq_u32 s19, 0
  s_cbranch_scc1 CL_W_OK_22
  s_sub_u32 s19, s19, 1
  s_sleep 1
  s_branch CL_W_SPIN_21
CL_W_OK_22:
  s_add_u32 s76, s74, 0
  s_lshl_b32 s76, s76, 18
  s_lshl_b32 s77, s71, 15
  s_add_u32 s76, s76, s77
  s_add_u32 s76, s76, 143687680
  s_lshl_b32 s77, s16, 13
  s_add_u32 s76, s76, s77
  s_xor_b32 s78, s86, 0
  s_add_u32 s77, s77, s78
  s_add_u32 m0, s77, 0
  s_nop 0
  buffer_load_dwordx4 v1, s[8:11], s76 offen offset:0 sc1 lds
  s_add_u32 m0, s77, 0
  s_nop 0
  buffer_load_dwordx4 v1, s[8:11], s76 offen offset:1024 sc1 lds
  s_add_u32 m0, s77, 0
  s_nop 0
  buffer_load_dwordx4 v1, s[8:11], s76 offen offset:2048 sc1 lds
  s_add_u32 m0, s77, 0
  s_nop 0
  buffer_load_dwordx4 v1, s[8:11], s76 offen offset:3072 sc1 lds
  s_add_u32 m0, s77, 4096
  s_add_u32 s76, s76, 4096
  buffer_load_dwordx4 v1, s[8:11], s76 offen offset:0 sc1 lds
  s_add_u32 m0, s77, 4096
  s_nop 0
  buffer_load_dwordx4 v1, s[8:11], s76 offen offset:1024 sc1 lds
  s_add_u32 m0, s77, 4096
  s_nop 0
  buffer_load_dwordx4 v1, s[8:11], s76 offen offset:2048 sc1 lds
  s_add_u32 m0, s77, 4096
  s_nop 0
  buffer_load_dwordx4 v1, s[8:11], s76 offen offset:3072 sc1 lds
  s_waitcnt vmcnt(0)
  s_branch CL_GO_20
CL_HAVE_19:
  s_waitcnt vmcnt(4)
CL_GO_20:
  buffer_load_dword v4, v2, s[8:11], s85 offen sc1
  s_waitcnt lgkmcnt(0)
  s_barrier
  v_add_u32 v7, s86, v1
  ds_read_b128 v[48:51], v7 offset:0
  ds_read_b128 v[52:55], v7 offset:1024
  ds_read_b128 v[56:59], v7 offset:2048
  ds_read_b128 v[60:63], v7 offset:3072
  ds_read_b128 v[64:67], v7 offset:8192
  ds_read_b128 v[68:71], v7 offset:9216
  ds_read_b128 v[72:75], v7 offset:10240
  ds_read_b128 v[76:79], v7 offset:11264
  s_waitcnt lgkmcnt(7)
  v_mfma_f32_16x16x32_bf16 v[16:19], a[0:3], v[48:51], 0
  v_mfma_f32_16x16x32_bf16 v[20:23], a[64:67], v[48:51], 0
  v_mfma_f32_16x16x32_bf16 v[24:27], a[128:131], v[48:51], 0
  v_mfma_f32_16x16x32_bf16 v[28:31], a[192:195], v[48:51], 0
  ds_read_b128 v[48:51], v7 offset:16384
  s_waitcnt lgkmcnt(7)
  v_mfma_f32_16x16x32_bf16 v[16:19], a[4:7], v[52:55], v[16:19]
  v_mfma_f32_16x16x32_bf16 v[20:23], a[68:71], v[52:55], v[20:23]
  v_mfma_f32_16x16x32_bf16 v[24:27], a[132:135], v[52:55], v[24:27]
  v_mfma_f32_16x16x32_bf16 v[28:31], a[196:199], v[52:55], v[28:31]
  ds_read_b128 v[52:55], v7 offset:17408
  s_waitcnt lgkmcnt(7)
  v_mfma_f32_16x16x32_bf16 v[16:19], a[8:11], v[56:59], v[16:19]
  v_mfma_f32_16x16x32_bf16 v[20:23], a[72:75], v[56:59], v[20:23]
  v_mfma_f32_16x16x32_bf16 v[24:27], a[136:139], v[56:59], v[24:27]
  v_mfma_f32_16x16x32_bf16 v[28:31], a[200:203], v[56:59], v[28:31]
  ds_read_b128 v[56:59], v7 offset:18432
  s_waitcnt lgkmcnt(7)
  v_mfma_f32_16x16x32_bf16 v[16:19], a[12:15], v[60:63], v[16:19]
  v_mfma_f32_16x16x32_bf16 v[20:23], a[76:79], v[60:63], v[20:23]
  v_mfma_f32_16x16x32_bf16 v[24:27], a[140:143], v[60:63], v[24:27]
  v_mfma_f32_16x16x32_bf16 v[28:31], a[204:207], v[60:63], v[28:31]
  ds_read_b128 v[60:63], v7 offset:19456
  s_waitcnt lgkmcnt(7)
  v_mfma_f32_16x16x32_bf16 v[16:19], a[16:19], v[64:67], v[16:19]
  v_mfma_f32_16x16x32_bf16 v[20:23], a[80:83], v[64:67], v[20:23]
  v_mfma_f32_16x16x32_bf16 v[24:27], a[144:147], v[64:67], v[24:27]
  v_mfma_f32_16x16x32_bf16 v[28:31], a[208:211], v[64:67], v[28:31]
  ds_read_b128 v[64:67], v7 offset:24576
  s_waitcnt lgkmcnt(7)
  v_mfma_f32_16x16x32_bf16 v[16:19], a[20:23], v[68:71], v[16:19]
  v_mfma_f32_16x16x32_bf16 v[20:23], a[84:87], v[68:71], v[20:23]
  v_mfma_f32_16x16x32_bf16 v[24:27], a[148:151], v[68:71], v[24:27]
  v_mfma_f32_16x16x32_bf16 v[28:31], a[212:215], v[68:71], v[28:31]
  ds_read_b128 v[68:71], v7 offset:25600
  s_waitcnt lgkmcnt(7)
  v_mfma_f32_16x16x32_bf16 v[16:19], a[24:27], v[72:75], v[16:19]
  v_mfma_f32_16x16x32_bf16 v[20:23], a[88:91], v[72:75], v[20:23]
  v_mfma_f32_16x16x32_bf16 v[24:27], a[152:155], v[72:75], v[24:27]
  v_mfma_f32_16x16x32_bf16 v[28:31], a[216:219], v[72:75], v[28:31]
  ds_read_b128 v[72:75], v7 offset:26624
  s_waitcnt lgkmcnt(7)
  v_mfma_f32_16x16x32_bf16 v[16:19], a[28:31], v[76:79], v[16:19]
  v_mfma_f32_16x16x32_bf16 v[20:23], a[92:95], v[76:79], v[20:23]
  v_mfma_f32_16x16x32_bf16 v[24:27], a[156:159], v[76:79], v[24:27]
  v_mfma_f32_16x16x32_bf16 v[28:31], a[220:223], v[76:79], v[28:31]
  ds_read_b128 v[76:79], v7 offset:27648
  s_waitcnt lgkmcnt(7)
  v_mfma_f32_16x16x32_bf16 v[16:19], a[32:35], v[48:51], v[16:19]
  v_mfma_f32_16x16x32_bf16 v[20:23], a[96:99], v[48:51], v[20:23]
  v_mfma_f32_16x16x32_bf16 v[24:27], a[160:163], v[48:51], v[24:27]
  v_mfma_f32_16x16x32_bf16 v[28:31], a[224:227], v[48:51], v[28:31]
  ds_read_b128 v[48:51], v7 offset:4096
  s_waitcnt lgkmcnt(7)
  v_mfma_f32_16x16x32_bf16 v[16:19], a[36:39], v[52:55], v[16:19]
  v_mfma_f32_16x16x32_bf16 v[20:23], a[100:103], v[52:55], v[20:23]
  v_mfma_f32_16x16x32_bf16 v[24:27], a[164:167], v[52:55], v[24:27]
  v_mfma_f32_16x16x32_bf16 v[28:31], a[228:231], v[52:55], v[28:31]
  ds_read_b128 v[52:55], v7 offset:5120
  s_waitcnt lgkmcnt(7)
  v_mfma_f32_16x16x32_bf16 v[16:19], a[40:43], v[56:59], v[16:19]
  v_mfma_f32_16x16x32_bf16 v[20:23], a[104:107], v[56:59], v[20:23]
  v_mfma_f32_16x16x32_bf16 v[24:27], a[168:171], v[56:59], v[24:27]
  v_mfma_f32_16x16x32_bf16 v[28:31], a[232:235], v[56:59], v[28:31]
  ds_read_b128 v[56:59], v7 offset:6144
  s_waitcnt lgkmcnt(7)
  v_mfma_f32_16x16x32_bf16 v[16:19], a[44:47], v[60:63], v[16:19]
  v_mfma_f32_16x16x32_bf16 v[20:23], a[108:111], v[60:63], v[20:23]
  v_mfma_f32_16x16x32_bf16 v[24:27], a[172:175], v[60:63], v[24:27]
  v_mfma_f32_16x16x32_bf16 v[28:31], a[236:239], v[60:63], v[28:31]
  ds_read_b128 v[60:63], v7 offset:7168
  s_waitcnt lgkmcnt(7)
  v_mfma_f32_16x16x32_bf16 v[16:19], a[48:51], v[64:67], v[16:19]
  v_mfma_f32_16x16x32_bf16 v[20:23], a[112:115], v[64:67], v[20:23]
  v_mfma_f32_16x16x32_bf16 v[24:27], a[176:179], v[64:67], v[24:27]
  v_mfma_f32_16x16x32_bf16 v[28:31], a[240:243], v[64:67], v[28:31]
  ds_read_b128 v[64:67], v7 offset:12288
  s_waitcnt lgkmcnt(7)
  v_mfma_f32_16x16x32_bf16 v[16:19], a[52:55], v[68:71], v[16:19]
  v_mfma_f32_16x16x32_bf16 v[20:23], a[116:119], v[68:71], v[20:23]
  v_mfma_f32_16x16x32_bf16 v[24:27], a[180:183], v[68:71], v[24:27]
  v_mfma_f32_16x16x32_bf16 v[28:31], a[244:247], v[68:71], v[28:31]
  ds_read_b128 v[68:71], v7 offset:13312
  s_waitcnt vmcnt(0)
  s_mov_b64 exec, 1
  buffer_store_dword v3, v6, s[8:11], s92 offen
  s_mov_b64 exec, -1
  s_mov_b32 s92, 268435456
  v_cmp_eq_u32 vcc, 0, v4
  s_mov_b32 s93, 0
  s_cbranch_vccnz CL_NOPF_23
  s_mov_b32 s93, 1
  s_add_u32 s76, s74, 1
  s_lshl_b32 s76, s76, 18
  s_lshl_b32 s77, s71, 15
  s_add_u32 s76, s76, s77
  s_add_u32 s76, s76, 143687680
  s_lshl_b32 s77, s16, 13
  s_add_u32 s76, s76, s77
  s_xor_b32 s78, s86, 32768
  s_add_u32 s77, s77, s78
  s_add_u32 m0, s77, 0
  s_nop 0
  buffer_load_dwordx4 v1, s[8:11], s76 offen offset:0 sc1 lds
  s_add_u32 m0, s77, 0
  s_nop 0
  buffer_load_dwordx4 v1, s[8:11], s76 offen offset:1024 sc1 lds
  s_add_u32 m0, s77, 0
  s_nop 0
  buffer_load_dwordx4 v1, s[8:11], s76 offen offset:2048 sc1 lds
  s_add_u32 m0, s77, 0
  s_nop 0
  buffer_load_dwordx4 v1, s[8:11], s76 offen offset:3072 sc1 lds
  s_add_u32 m0, s77, 4096
  s_add_u32 s76, s76, 4096
  buffer_load_dwordx4 v1, s[8:11], s76 offen offset:0 sc1 lds
  s_add_u32 m0, s77, 4096
  s_nop 0
  buffer_load_dwordx4 v1, s[8:11], s76 offen offset:1024 sc1 lds
  s_add_u32 m0, s77, 4096
  s_nop 0
  buffer_load_dwordx4 v1, s[8:11], s76 offen offset:2048 sc1 lds
  s_add_u32 m0, s77, 4096
  s_nop 0
  buffer_load_dwordx4 v1, s[8:11], s76 offen offset:3072 sc1 lds
CL_NOPF_23:
  s_waitcnt lgkmcnt(7)
  v_mfma_f32_16x16x32_bf16 v[16:19], a[56:59], v[72:75], v[16:19]
  s_lshl_b32 s76, s74, 18
  s_add_u32 s76, s76, 177242112
  s_add_u32 s77, s76, 16384
  v_mfma_f32_16x16x32_bf16 v[20:23], a[120:123], v[72:75], v[20:23]
  s_lshl_b32 s92, s74, 8
  s_add_u32 s92, s92, 24444928
  v_mfma_f32_16x16x32_bf16 v[24:27], a[184:187], v[72:75], v[24:27]
  v_mfma_f32_16x16x32_bf16 v[28:31], a[248:251], v[72:75], v[28:31]
  ds_read_b128 v[72:75], v7 offset:14336
  s_waitcnt lgkmcnt(7)
  v_mfma_f32_16x16x32_bf16 v[16:19], a[60:63], v[76:79], v[16:19]
  v_mfma_f32_16x16x32_bf16 v[20:23], a[124:127], v[76:79], v[20:23]
  v_mfma_f32_16x16x32_bf16 v[24:27], a[188:191], v[76:79], v[24:27]
  v_mfma_f32_16x16x32_bf16 v[28:31], a[252:255], v[76:79], v[28:31]
  ds_read_b128 v[76:79], v7 offset:15360
  s_nop 3
  v_cvt_pk_bf16_f32 v96, v16, v17
  s_waitcnt lgkmcnt(7)
  v_mfma_f32_16x16x32_bf16 v[32:35], a[0:3], v[48:51], 0
  v_cvt_pk_bf16_f32 v97, v18, v19
  v_mfma_f32_16x16x32_bf16 v[36:39], a[64:67], v[48:51], 0
  v_cvt_pk_bf16_f32 v98, v20, v21
  v_mfma_f32_16x16x32_bf16 v[40:43], a[128:131], v[48:51], 0
  v_cvt_pk_bf16_f32 v99, v22, v23
  v_mfma_f32_16x16x32_bf16 v[44:47], a[192:195], v[48:51], 0
  ds_read_b128 v[48:51], v7 offset:20480
  v_cvt_pk_bf16_f32 v100, v24, v25
  s_waitcnt lgkmcnt(7)
  v_mfma_f32_16x16x32_bf16 v[32:35], a[4:7], v[52:55], v[32:35]
  buffer_store_dwordx4 v[96:99], v5, s[8:11], s76 offen offset:0
  v_cvt_pk_bf16_f32 v101, v26, v27
  v_mfma_f32_16x16x32_bf16 v[36:39], a[68:71], v[52:55], v[36:39]
  v_cvt_pk_bf16_f32 v102, v28, v29
  v_mfma_f32_16x16x32_bf16 v[40:43], a[132:135], v[52:55], v[40:43]
  v_cvt_pk_bf16_f32 v103, v30, v31
  v_mfma_f32_16x16x32_bf16 v[44:47], a[196:199], v[52:55], v[44:47]
  ds_read_b128 v[52:55], v7 offset:21504
  s_waitcnt lgkmcnt(7)
  v_mfma_f32_16x16x32_bf16 v[32:35], a[8:11], v[56:59], v[32:35]
  v_mfma_f32_16x16x32_bf16 v[36:39], a[72:75], v[56:59], v[36:39]
  v_mfma_f32_16x16x32_bf16 v[40:43], a[136:139], v[56:59], v[40:43]
  buffer_store_dwordx4 v[100:103], v5, s[8:11], s76 offen offset:64
  v_mfma_f32_16x16x32_bf16 v[44:47], a[200:203], v[56:59], v[44:47]
  ds_read_b128 v[56:59], v7 offset:22528
  s_waitcnt lgkmcnt(7)
  v_mfma_f32_16x16x32_bf16 v[32:35], a[12:15], v[60:63], v[32:35]
  v_mfma_f32_16x16x32_bf16 v[36:39], a[76:79], v[60:63], v[36:39]
  v_mfma_f32_16x16x32_bf16 v[40:43], a[140:143], v[60:63], v[40:43]
  v_mfma_f32_16x16x32_bf16 v[44:47], a[204:207], v[60:63], v[44:47]
  ds_read_b128 v[60:63], v7 offset:23552
  s_waitcnt lgkmcnt(7)
  v_mfma_f32_16x16x32_bf16 v[32:35], a[16:19], v[64:67], v[32:35]
  v_mfma_f32_16x16x32_bf16 v[36:39], a[80:83], v[64:67], v[36:39]
  v_mfma_f32_16x16x32_bf16 v[40:43], a[144:147], v[64:67], v[40:43]
  v_mfma_f32_16x16x32_bf16 v[44:47], a[208:211], v[64:67], v[44:47]
  ds_read_b128 v[64:67], v7 offset:28672
  s_waitcnt lgkmcnt(7)
  v_mfma_f32_16x16x32_bf16 v[32:35], a[20:23], v[68:71], v[32:35]
  v_mfma_f32_16x16x32_bf16 v[36:39], a[84:87], v[68:71], v[36:39]
  v_mfma_f32_16x16x32_bf16 v[40:43], a[148:151], v[68:71], v[40:43]
  v_mfma_f32_16x16x32_bf16 v[44:47], a[212:215], v[68:71], v[44:47]
  ds_read_b128 v[68:71], v7 offset:29696
  s_waitcnt lgkmcnt(7)
  v_mfma_f32_16x16x32_bf16 v[32:35], a[24:27], v[72:75], v[32:35]
  v_mfma_f32_16x16x32_bf16 v[36:39], a[88:91], v[72:75], v[36:39]
  v_mfma_f32_16x16x32_bf16 v[40:43], a[152:155], v[72:75], v[40:43]
  v_mfma_f32_16x16x32_bf16 v[44:47], a[216:219], v[72:75], v[44:47]
  ds_read_b128 v[72:75], v7 offset:30720
  s_waitcnt lgkmcnt(7)
  v_mfma_f32_16x16x32_bf16 v[32:35], a[28:31], v[76:79], v[32:35]
  v_mfma_f32_16x16x32_bf16 v[36:39], a[92:95], v[76:79], v[36:39]
  v_mfma_f32_16x16x32_bf16 v[40:43], a[156:159], v[76:79], v[40:43]
  v_mfma_f32_16x16x32_bf16 v[44:47], a[220:223], v[76:79], v[44:47]
  ds_read_b128 v[76:79], v7 offset:31744
  s_waitcnt lgkmcnt(7)
  v_mfma_f32_16x16x32_bf16 v[32:35], a[32:35], v[48:51], v[32:35]
  v_mfma_f32_16x16x32_bf16 v[36:39], a[96:99], v[48:51], v[36:39]
  v_mfma_f32_16x16x32_bf16 v[40:43], a[160:163], v[48:51], v[40:43]
  v_mfma_f32_16x16x32_bf16 v[44:47], a[224:227], v[48:51], v[44:47]
  s_waitcnt lgkmcnt(6)
  v_mfma_f32_16x16x32_bf16 v[32:35], a[36:39], v[52:55], v[32:35]
  v_mfma_f32_16x16x32_bf16 v[36:39], a[100:103], v[52:55], v[36:39]
  v_mfma_f32_16x16x32_bf16 v[40:43], a[164:167], v[52:55], v[40:43]
  v_mfma_f32_16x16x32_bf16 v[44:47], a[228:231], v[52:55], v[44:47]
  s_waitcnt lgkmcnt(5)
  v_mfma_f32_16x16x32_bf16 v[32:35], a[40:43], v[56:59], v[32:35]
  v_mfma_f32_16x16x32_bf16 v[36:39], a[104:107], v[56:59], v[36:39]
  v_mfma_f32_16x16x32_bf16 v[40:43], a[168:171], v[56:59], v[40:43]
  v_mfma_f32_16x16x32_bf16 v[44:47], a[232:235], v[56:59], v[44:47]
  s_waitcnt lgkmcnt(4)
  v_mfma_f32_16x16x32_bf16 v[32:35], a[44:47], v[60:63], v[32:35]
  v_mfma_f32_16x16x32_bf16 v[36:39], a[108:111], v[60:63], v[36:39]
  v_mfma_f32_16x16x32_bf16 v[40:43], a[172:175], v[60:63], v[40:43]
  v_mfma_f32_16x16x32_bf16 v[44:47], a[236:239], v[60:63], v[44:47]
  s_waitcnt lgkmcnt(3)
  v_mfma_f32_16x16x32_bf16 v[32:35], a[48:51], v[64:67], v[32:35]
  v_mfma_f32_16x16x32_bf16 v[36:39], a[112:115], v[64:67], v[36:39]
  v_mfma_f32_16x16x32_bf16 v[40:43], a[176:179], v[64:67], v[40:43]
  v_mfma_f32_16x16x32_bf16 v[44:47], a[240:243], v[64:67], v[44:47]
  s_waitcnt lgkmcnt(2)
  v_mfma_f32_16x16x32_bf16 v[32:35], a[52:55], v[68:71], v[32:35]
  v_mfma_f32_16x16x32_bf16 v[36:39], a[116:119], v[68:71], v[36:39]
  v_mfma_f32_16x16x32_bf16 v[40:43], a[180:183], v[68:71], v[40:43]
  v_mfma_f32_16x16x32_bf16 v[44:47], a[244:247], v[68:71], v[44:47]
  s_waitcnt lgkmcnt(1)
  v_mfma_f32_16x16x32_bf16 v[32:35], a[56:59], v[72:75], v[32:35]
  v_mfma_f32_16x16x32_bf16 v[36:39], a[120:123], v[72:75], v[36:39]
  v_mfma_f32_16x16x32_bf16 v[40:43], a[184:187], v[72:75], v[40:43]
  v_mfma_f32_16x16x32_bf16 v[44:47], a[248:251], v[72:75], v[44:47]
  s_waitcnt lgkmcnt(0)
  v_mfma_f32_16x16x32_bf16 v[32:35], a[60:63], v[76:79], v[32:35]
  v_mfma_f32_16x16x32_bf16 v[36:39], a[124:127], v[76:79], v[36:39]
  v_mfma_f32_16x16x32_bf16 v[40:43], a[188:191], v[76:79], v[40:43]
  v_mfma_f32_16x16x32_bf16 v[44:47], a[252:255], v[76:79], v[44:47]
  s_nop 4
  v_cvt_pk_bf16_f32 v104, v32, v33
  v_cvt_pk_bf16_f32 v105, v34, v35
  v_cvt_pk_bf16_f32 v106, v36, v37
  v_cvt_pk_bf16_f32 v107, v38, v39
  buffer_store_dwordx4 v[104:107], v5, s[8:11], s77 offen offset:0
  v_cvt_pk_bf16_f32 v108, v40, v41
  v_cvt_pk_bf16_f32 v109, v42, v43
  v_cvt_pk_bf16_f32 v110, v44, v45
  v_cvt_pk_bf16_f32 v111, v46, v47
  buffer_store_dwordx4 v[108:111], v5, s[8:11], s77 offen offset:64
  s_waitcnt vmcnt(0)
  s_mov_b64 exec, 1
  buffer_store_dword v3, v6, s[8:11], s92 offen
  s_mov_b64 exec, -1
  s_mov_b32 s92, 268435456
  s_xor_b32 s86, s86, 32768
  s_add_u32 s73, s73, 1
  s_cmp_lt_u32 s73, 64
  s_cbranch_scc1 C_LOOPL
  s_waitcnt vmcnt(0)
  s_mov_b64 exec, 1
  buffer_store_dword v3, v6, s[8:11], s92 offen
  s_mov_b64 exec, -1
  s_mov_b32 s92, 268435456
  s_endpgm
ROLE_FL:
  s_mul_i32 s71, s17, 4682
  s_lshr_b32 s71, s71, 16
  s_mul_i32 s76, s71, 14
  s_sub_u32 s70, s17, s76
  v_and_b32 v14, 63, v0
  v_lshlrev_b32 v1, 4, v14
  v_and_b32 v15, 15, v14
  v_lshrrev_b32 v13, 4, v14
  v_lshlrev_b32 v2, 10, v15
  v_lshl_add_u32 v2, v13, 4, v2
  v_and_b32 v3, 15, v14
  v_lshlrev_b32 v3, 6, v3
  v_mov_b32 v4, 1
  s_lshl_b32 s76, s70, 15
  s_lshl_b32 s77, s16, 8
  s_add_u32 s76, s76, s77
  v_add_u32 v6, s76, v2
  s_lshl_b32 s76, s70, 2
  s_add_u32 s76, s76, s16
  s_lshl_b32 s77, s76, 2
  v_mov_b32 v7, s77
  s_lshl_b32 s77, s16, 10
  s_add_u32 s77, s77, 65536
  v_add_u32 v8, s77, v1
  v_add_u32 v10, 65536, v1
  s_lshr_b32 s74, s71, 1
  s_cmp_eq_u32 s74, 0
  s_cbranch_scc1 FL_NOSTAGE_24
  s_call_b64 s[100:101], VERIFY
  s_cbranch_scc1 VER_OK_26
  v_mov_b32 v0, v116
  s_waitcnt vmcnt(0) lgkmcnt(0)
  s_barrier
  s_branch DISPATCH
VER_OK_26:
  v_mbcnt_lo_u32_b32 v116, -1, 0
  v_mbcnt_hi_u32_b32 v116, -1, v116
  v_and_b32 v116, 31, v116
  v_lshlrev_b32 v116, 6, v116
  s_mov_b32 s44, 24805376
FL_GOSPIN_25:
  buffer_load_dword v117, v116, s[8:11], s44 offen sc1
  s_waitcnt vmcnt(0)
  v_cmp_eq_u32 vcc, 0, v117
  s_nop 0
  s_cbranch_vccz FL_NOSTAGE_24
  s_cmp_eq_u32 s19, 0
  s_cbranch_scc1 FL_NOSTAGE_24
  s_sub_u32 s19, s19, 1
  s_sleep 8
  s_branch FL_GOSPIN_25
FL_NOSTAGE_24:
  s_lshl_b32 s41, s16, 15
  v_lshrrev_b32 v100, 4, v14
  v_lshlrev_b32 v100, 3, v100
  v_lshrrev_b32 v102, 2, v14
  v_and_b32 v102, 3, v102
  v_add_u32 v100, v100, v102
  v_lshlrev_b32 v100, 6, v100
  v_and_b32 v102, 3, v14
  v_lshl_add_u32 v100, v102, 4, v100
  v_add_u32 v100, s41, v100
  v_lshrrev_b32 v102, 2, v14
  s_mov_b32 s40, 3584
  v_mul_lo_u32 v102, v102, s40
  v_and_b32 v101, 3, v14
  v_lshl_add_u32 v102, v101, 4, v102
  v_lshrrev_b32 v103, 2, v14
  s_mov_b32 s40, 1024
  v_mul_lo_u32 v103, v103, s40
  v_and_b32 v101, 3, v14
  v_lshl_add_u32 v103, v101, 4, v103
  s_lshl_b32 s44, s76, 6
  s_lshl_b32 s45, s70, 17
  s_lshl_b32 s46, s16, 8
  s_add_u32 s45, s45, s46
  s_load_dwordx2 s[42:43], s[0:1], 64
  s_waitcnt lgkmcnt(0)
  s_mov_b32 s36, s42
  s_and_b32 s37, s43, 0xffff
  s_mov_b32 s38, 1835008
  s_mov_b32 s39, 0x20000
  s_add_u32 s40, s44, 0
  s_add_u32 m0, s41, 0
  s_nop 0
  buffer_load_dwordx4 v102, s[36:39], s40 offen lds
  s_add_u32 s40, s40, 57344
  s_add_u32 m0, s41, 1024
  s_nop 0
  buffer_load_dwordx4 v102, s[36:39], s40 offen lds
  s_add_u32 s40, s44, 114688
  s_add_u32 m0, s41, 2048
  s_nop 0
  buffer_load_dwordx4 v102, s[36:39], s40 offen lds
  s_add_u32 s40, s40, 57344
  s_add_u32 m0, s41, 3072
  s_nop 0
  buffer_load_dwordx4 v102, s[36:39], s40 offen lds
  s_add_u32 s40, s44, 229376
  s_add_u32 m0, s41, 4096
  s_nop 0
  buffer_load_dwordx4 v102, s[36:39], s40 offen lds
  s_add_u32 s40, s40, 57344
  s_add_u32 m0, s41, 5120
  s_nop 0
  buffer_load_dwordx4 v102, s[36:39], s40 offen lds
  s_add_u32 s40, s44, 344064
  s_add_u32 m0, s41, 6144
  s_nop 0
  buffer_load_dwordx4 v102, s[36:39], s40 offen lds
  s_add_u32 s40, s40, 57344
  s_add_u32 m0, s41, 7168
  s_nop 0
  buffer_load_dwordx4 v102, s[36:39], s40 offen lds
  s_add_u32 s40, s44, 458752
  s_add_u32 m0, s41, 8192
  s_nop 0
  buffer_load_dwordx4 v102, s[36:39], s40 offen lds
  s_add_u32 s40, s40, 57344
  s_add_u32 m0, s41, 9216
  s_nop 0
  buffer_load_dwordx4 v102, s[36:39], s40 offen lds
  s_add_u32 s40, s44, 573440
  s_add_u32 m0, s41, 10240
  s_nop 0
  buffer_load_dwordx4 v102, s[36:39], s40 offen lds
  s_add_u32 s40, s40, 57344
  s_add_u32 m0, s41, 11264
  s_nop 0
  buffer_load_dwordx4 v102, s[36:39], s40 offen lds
  s_add_u32 s40, s44, 688128
  s_add_u32 m0, s41, 12288
  s_nop 0
  buffer_load_dwordx4 v102, s[36:39], s40 offen lds
  s_add_u32 s40, s40, 57344
  s_add_u32 m0, s41, 13312
  s_nop 0
  buffer_load_dwordx4 v102, s[36:39], s40 offen lds
  s_add_u32 s40, s44, 802816
  s_add_u32 m0, s41, 14336
  s_nop 0
  buffer_load_dwordx4 v102, s[36:39], s40 offen lds
  s_add_u32 s40, s40, 57344
  s_add_u32 m0, s41, 15360
  s_nop 0
  buffer_load_dwordx4 v102, s[36:39], s40 offen lds
  s_add_u32 s40, s44, 917504
  s_add_u32 m0, s41, 16384
  s_nop 0
  buffer_load_dwordx4 v102, s[36:39], s40 offen lds
  s_add_u32 s40, s40, 57344
  s_add_u32 m0, s41, 17408
  s_nop 0
  buffer_load_dwordx4 v102, s[36:39], s40 offen lds
  s_add_u32 s40, s44, 1032192
  s_add_u32 m0, s41, 18432
  s_nop 0
  buffer_load_dwordx4 v102, s[36:39], s40 offen lds
  s_add_u32 s40, s40, 57344
  s_add_u32 m0, s41, 19456
  s_nop 0
  buffer_load_dwordx4 v102, s[36:39], s40 offen lds
  s_add_u32 s40, s44, 1146880
  s_add_u32 m0, s41, 20480
  s_nop 0
  buffer_load_dwordx4 v102, s[36:39], s40 offen lds
  s_add_u32 s40, s40, 57344
  s_add_u32 m0, s41, 21504
  s_nop 0
  buffer_load_dwordx4 v102, s[36:39], s40 offen lds
  s_add_u32 s40, s44, 1261568
  s_add_u32 m0, s41, 22528
  s_nop 0
  buffer_load_dwordx4 v102, s[36:39], s40 offen lds
  s_add_u32 s40, s40, 57344
  s_add_u32 m0, s41, 23552
  s_nop 0
  buffer_load_dwordx4 v102, s[36:39], s40 offen lds
  s_add_u32 s40, s44, 1376256
  s_add_u32 m0, s41, 24576
  s_nop 0
  buffer_load_dwordx4 v102, s[36:39], s40 offen lds
  s_add_u32 s40, s40, 57344
  s_add_u32 m0, s41, 25600
  s_nop 0
  buffer_load_dwordx4 v102, s[36:39], s40 offen lds
  s_add_u32 s40, s44, 1490944
  s_add_u32 m0, s41, 26624
  s_nop 0
  buffer_load_dwordx4 v102, s[36:39], s40 offen lds
  s_add_u32 s40, s40, 57344
  s_add_u32 m0, s41, 27648
  s_nop 0
  buffer_load_dwordx4 v102, s[36:39], s40 offen lds
  s_add_u32 s40, s44, 1605632
  s_add_u32 m0, s41, 28672
  s_nop 0
  buffer_load_dwordx4 v102, s[36:39], s40 offen lds
  s_add_u32 s40, s40, 57344
  s_add_u32 m0, s41, 29696
  s_nop 0
  buffer_load_dwordx4 v102, s[36:39], s40 offen lds
  s_add_u32 s40, s44, 1720320
  s_add_u32 m0, s41, 30720
  s_nop 0
  buffer_load_dwordx4 v102, s[36:39], s40 offen lds
  s_add_u32 s40, s40, 57344
  s_add_u32 m0, s41, 31744
  s_nop 0
  buffer_load_dwordx4 v102, s[36:39], s40 offen lds
  s_waitcnt vmcnt(16)
  ds_read_b64_tr_b16 a[0:1], v100 offset:0
  ds_read_b64_tr_b16 a[2:3], v100 offset:256
  ds_read_b64_tr_b16 a[64:65], v100 offset:8
  ds_read_b64_tr_b16 a[66:67], v100 offset:264
  ds_read_b64_tr_b16 a[4:5], v100 offset:2048
  ds_read_b64_tr_b16 a[6:7], v100 offset:2304
  ds_read_b64_tr_b16 a[68:69], v100 offset:2056
  ds_read_b64_tr_b16 a[70:71], v100 offset:2312
  s_waitcnt lgkmcnt(4)
  ds_read_b64_tr_b16 a[8:9], v100 offset:4096
  ds_read_b64_tr_b16 a[10:11], v100 offset:4352
  ds_read_b64_tr_b16 a[72:73], v100 offset:4104
  ds_read_b64_tr_b16 a[74:75], v100 offset:4360
  ds_read_b64_tr_b16 a[12:13], v100 offset:6144
  ds_read_b64_tr_b16 a[14:15], v100 offset:6400
  ds_read_b64_tr_b16 a[76:77], v100 offset:6152
  ds_read_b64_tr_b16 a[78:79], v100 offset:6408
  s_waitcnt lgkmcnt(4)
  ds_read_b64_tr_b16 a[16:17], v100 offset:8192
  ds_read_b64_tr_b16 a[18:19], v100 offset:8448
  ds_read_b64_tr_b16 a[80:81], v100 offset:8200
  ds_read_b64_tr_b16 a[82:83], v100 offset:8456
  ds_read_b64_tr_b16 a[20:21], v100 offset:10240
  ds_read_b64_tr_b16 a[22:23], v100 offset:10496
  ds_read_b64_tr_b16 a[84:85], v100 offset:10248
  ds_read_b64_tr_b16 a[86:87], v100 offset:10504
  s_waitcnt lgkmcnt(4)
  ds_read_b64_tr_b16 a[24:25], v100 offset:12288
  ds_read_b64_tr_b16 a[26:27], v100 offset:12544
  ds_read_b64_tr_b16 a[88:89], v100 offset:12296
  ds_read_b64_tr_b16 a[90:91], v100 offset:12552
  ds_read_b64_tr_b16 a[28:29], v100 offset:14336
  ds_read_b64_tr_b16 a[30:31], v100 offset:14592
  ds_read_b64_tr_b16 a[92:93], v100 offset:14344
  ds_read_b64_tr_b16 a[94:95], v100 offset:14600
  s_waitcnt lgkmcnt(4)
  s_waitcnt lgkmcnt(0)
  s_load_dwordx2 s[42:43], s[0:1], 72
  s_waitcnt lgkmcnt(0)
  s_mov_b32 s36, s42
  s_and_b32 s37, s43, 0xffff
  s_mov_b32 s38, 1835008
  s_mov_b32 s39, 0x20000
  s_add_u32 s40, s44, 0
  s_add_u32 m0, s41, 0
  s_nop 0
  buffer_load_dwordx4 v102, s[36:39], s40 offen lds
  s_add_u32 s40, s40, 57344
  s_add_u32 m0, s41, 1024
  s_nop 0
  buffer_load_dwordx4 v102, s[36:39], s40 offen lds
  s_add_u32 s40, s44, 114688
  s_add_u32 m0, s41, 2048
  s_nop 0
  buffer_load_dwordx4 v102, s[36:39], s40 offen lds
  s_add_u32 s40, s40, 57344
  s_add_u32 m0, s41, 3072
  s_nop 0
  buffer_load_dwordx4 v102, s[36:39], s40 offen lds
  s_add_u32 s40, s44, 229376
  s_add_u32 m0, s41, 4096
  s_nop 0
  buffer_load_dwordx4 v102, s[36:39], s40 offen lds
  s_add_u32 s40, s40, 57344
  s_add_u32 m0, s41, 5120
  s_nop 0
  buffer_load_dwordx4 v102, s[36:39], s40 offen lds
  s_add_u32 s40, s44, 344064
  s_add_u32 m0, s41, 6144
  s_nop 0
  buffer_load_dwordx4 v102, s[36:39], s40 offen lds
  s_add_u32 s40, s40, 57344
  s_add_u32 m0, s41, 7168
  s_nop 0
  buffer_load_dwordx4 v102, s[36:39], s40 offen lds
  s_add_u32 s40, s44, 458752
  s_add_u32 m0, s41, 8192
  s_nop 0
  buffer_load_dwordx4 v102, s[36:39], s40 offen lds
  s_add_u32 s40, s40, 57344
  s_add_u32 m0, s41, 9216
  s_nop 0
  buffer_load_dwordx4 v102, s[36:39], s40 offen lds
  s_add_u32 s40, s44, 573440
  s_add_u32 m0, s41, 10240
  s_nop 0
  buffer_load_dwordx4 v102, s[36:39], s40 offen lds
  s_add_u32 s40, s40, 57344
  s_add_u32 m0, s41, 11264
  s_nop 0
  buffer_load_dwordx4 v102, s[36:39], s40 offen lds
  s_add_u32 s40, s44, 688128
  s_add_u32 m0, s41, 12288
  s_nop 0
  buffer_load_dwordx4 v102, s[36:39], s40 offen lds
  s_add_u32 s40, s40, 57344
  s_add_u32 m0, s41, 13312
  s_nop 0
  buffer_load_dwordx4 v102, s[36:39], s40 offen lds
  s_add_u32 s40, s44, 802816
  s_add_u32 m0, s41, 14336
  s_nop 0
  buffer_load_dwordx4 v102, s[36:39], s40 offen lds
  s_add_u32 s40, s40, 57344
  s_add_u32 m0, s41, 15360
  s_nop 0
  buffer_load_dwordx4 v102, s[36:39], s40 offen lds
  s_waitcnt vmcnt(16)
  ds_read_b64_tr_b16 a[32:33], v100 offset:16384
  ds_read_b64_tr_b16 a[34:35], v100 offset:16640
  ds_read_b64_tr_b16 a[96:97], v100 offset:16392
  ds_read_b64_tr_b16 a[98:99], v100 offset:16648
  ds_read_b64_tr_b16 a[36:37], v100 offset:18432
  ds_read_b64_tr_b16 a[38:39], v100 offset:18688
  ds_read_b64_tr_b16 a[100:101], v100 offset:18440
  ds_read_b64_tr_b16 a[102:103], v100 offset:18696
  s_waitcnt lgkmcnt(4)
  ds_read_b64_tr_b16 a[40:41], v100 offset:20480
  ds_read_b64_tr_b16 a[42:43], v100 offset:20736
  ds_read_b64_tr_b16 a[104:105], v100 offset:20488
  ds_read_b64_tr_b16 a[106:107], v100 offset:20744
  ds_read_b64_tr_b16 a[44:45], v100 offset:22528
  ds_read_b64_tr_b16 a[46:47], v100 offset:22784
  ds_read_b64_tr_b16 a[108:109], v100 offset:22536
  ds_read_b64_tr_b16 a[110:111], v100 offset:22792
  s_waitcnt lgkmcnt(4)
  ds_read_b64_tr_b16 a[48:49], v100 offset:24576
  ds_read_b64_tr_b16 a[50:51], v100 offset:24832
  ds_read_b64_tr_b16 a[112:113], v100 offset:24584
  ds_read_b64_tr_b16 a[114:115], v100 offset:24840
  ds_read_b64_tr_b16 a[52:53], v100 offset:26624
  ds_read_b64_tr_b16 a[54:55], v100 offset:26880
  ds_read_b64_tr_b16 a[116:117], v100 offset:26632
  ds_read_b64_tr_b16 a[118:119], v100 offset:26888
  s_waitcnt lgkmcnt(4)
  ds_read_b64_tr_b16 a[56:57], v100 offset:28672
  ds_read_b64_tr_b16 a[58:59], v100 offset:28928
  ds_read_b64_tr_b16 a[120:121], v100 offset:28680
  ds_read_b64_tr_b16 a[122:123], v100 offset:28936
  ds_read_b64_tr_b16 a[60:61], v100 offset:30720
  ds_read_b64_tr_b16 a[62:63], v100 offset:30976
  ds_read_b64_tr_b16 a[124:125], v100 offset:30728
  ds_read_b64_tr_b16 a[126:127], v100 offset:30984
  s_waitcnt lgkmcnt(4)
  s_waitcnt lgkmcnt(0)
  s_add_u32 s40, s44, 917504
  s_add_u32 m0, s41, 16384
  s_nop 0
  buffer_load_dwordx4 v102, s[36:39], s40 offen lds
  s_add_u32 s40, s40, 57344
  s_add_u32 m0, s41, 17408
  s_nop 0
  buffer_load_dwordx4 v102, s[36:39], s40 offen lds
  s_add_u32 s40, s44, 1032192
  s_add_u32 m0, s41, 18432
  s_nop 0
  buffer_load_dwordx4 v102, s[36:39], s40 offen lds
  s_add_u32 s40, s40, 57344
  s_add_u32 m0, s41, 19456
  s_nop 0
  buffer_load_dwordx4 v102, s[36:39], s40 offen lds
  s_add_u32 s40, s44, 1146880
  s_add_u32 m0, s41, 20480
  s_nop 0
  buffer_load_dwordx4 v102, s[36:39], s40 offen lds
  s_add_u32 s40, s40, 57344
  s_add_u32 m0, s41, 21504
  s_nop 0
  buffer_load_dwordx4 v102, s[36:39], s40 offen lds
  s_add_u32 s40, s44, 1261568
  s_add_u32 m0, s41, 22528
  s_nop 0
  buffer_load_dwordx4 v102, s[36:39], s40 offen lds
  s_add_u32 s40, s40, 57344
  s_add_u32 m0, s41, 23552
  s_nop 0
  buffer_load_dwordx4 v102, s[36:39], s40 offen lds
  s_add_u32 s40, s44, 1376256
  s_add_u32 m0, s41, 24576
  s_nop 0
  buffer_load_dwordx4 v102, s[36:39], s40 offen lds
  s_add_u32 s40, s40, 57344
  s_add_u32 m0, s41, 25600
  s_nop 0
  buffer_load_dwordx4 v102, s[36:39], s40 offen lds
  s_add_u32 s40, s44, 1490944
  s_add_u32 m0, s41, 26624
  s_nop 0
  buffer_load_dwordx4 v102, s[36:39], s40 offen lds
  s_add_u32 s40, s40, 57344
  s_add_u32 m0, s41, 27648
  s_nop 0
  buffer_load_dwordx4 v102, s[36:39], s40 offen lds
  s_add_u32 s40, s44, 1605632
  s_add_u32 m0, s41, 28672
  s_nop 0
  buffer_load_dwordx4 v102, s[36:39], s40 offen lds
  s_add_u32 s40, s40, 57344
  s_add_u32 m0, s41, 29696
  s_nop 0
  buffer_load_dwordx4 v102, s[36:39], s40 offen lds
  s_add_u32 s40, s44, 1720320
  s_add_u32 m0, s41, 30720
  s_nop 0
  buffer_load_dwordx4 v102, s[36:39], s40 offen lds
  s_add_u32 s40, s40, 57344
  s_add_u32 m0, s41, 31744
  s_nop 0
  buffer_load_dwordx4 v102, s[36:39], s40 offen lds
  s_waitcnt vmcnt(16)
  ds_read_b64_tr_b16 a[128:129], v100 offset:0
  ds_read_b64_tr_b16 a[130:131], v100 offset:256
  ds_read_b64_tr_b16 a[192:193], v100 offset:8
  ds_read_b64_tr_b16 a[194:195], v100 offset:264
  ds_read_b64_tr_b16 a[132:133], v100 offset:2048
  ds_read_b64_tr_b16 a[134:135], v100 offset:2304
  ds_read_b64_tr_b16 a[196:197], v100 offset:2056
  ds_read_b64_tr_b16 a[198:199], v100 offset:2312
  s_waitcnt lgkmcnt(4)
  ds_read_b64_tr_b16 a[136:137], v100 offset:4096
  ds_read_b64_tr_b16 a[138:139], v100 offset:4352
  ds_read_b64_tr_b16 a[200:201], v100 offset:4104
  ds_read_b64_tr_b16 a[202:203], v100 offset:4360
  ds_read_b64_tr_b16 a[140:141], v100 offset:6144
  ds_read_b64_tr_b16 a[142:143], v100 offset:6400
  ds_read_b64_tr_b16 a[204:205], v100 offset:6152
  ds_read_b64_tr_b16 a[206:207], v100 offset:6408
  s_waitcnt lgkmcnt(4)
  ds_read_b64_tr_b16 a[144:145], v100 offset:8192
  ds_read_b64_tr_b16 a[146:147], v100 offset:8448
  ds_read_b64_tr_b16 a[208:209], v100 offset:8200
  ds_read_b64_tr_b16 a[210:211], v100 offset:8456
  ds_read_b64_tr_b16 a[148:149], v100 offset:10240
  ds_read_b64_tr_b16 a[150:151], v100 offset:10496
  ds_read_b64_tr_b16 a[212:213], v100 offset:10248
  ds_read_b64_tr_b16 a[214:215], v100 offset:10504
  s_waitcnt lgkmcnt(4)
  ds_read_b64_tr_b16 a[152:153], v100 offset:12288
  ds_read_b64_tr_b16 a[154:155], v100 offset:12544
  ds_read_b64_tr_b16 a[216:217], v100 offset:12296
  ds_read_b64_tr_b16 a[218:219], v100 offset:12552
  ds_read_b64_tr_b16 a[156:157], v100 offset:14336
  ds_read_b64_tr_b16 a[158:159], v100 offset:14592
  ds_read_b64_tr_b16 a[220:221], v100 offset:14344
  ds_read_b64_tr_b16 a[222:223], v100 offset:14600
  s_waitcnt lgkmcnt(4)
  s_waitcnt lgkmcnt(0)
  s_load_dwordx2 s[42:43], s[0:1], 80
  s_waitcnt lgkmcnt(0)
  s_mov_b32 s36, s42
  s_and_b32 s37, s43, 0xffff
  s_mov_b32 s38, 1835008
  s_mov_b32 s39, 0x20000
  s_add_u32 s40, s45, 0
  s_add_u32 m0, s41, 0
  s_nop 0
  buffer_load_dwordx4 v103, s[36:39], s40 offen lds
  s_add_u32 s40, s40, 16384
  s_add_u32 m0, s41, 1024
  s_nop 0
  buffer_load_dwordx4 v103, s[36:39], s40 offen lds
  s_add_u32 s40, s45, 32768
  s_add_u32 m0, s41, 2048
  s_nop 0
  buffer_load_dwordx4 v103, s[36:39], s40 offen lds
  s_add_u32 s40, s40, 16384
  s_add_u32 m0, s41, 3072
  s_nop 0
  buffer_load_dwordx4 v103, s[36:39], s40 offen lds
  s_add_u32 s40, s45, 65536
  s_add_u32 m0, s41, 4096
  s_nop 0
  buffer_load_dwordx4 v103, s[36:39], s40 offen lds
  s_add_u32 s40, s40, 16384
  s_add_u32 m0, s41, 5120
  s_nop 0
  buffer_load_dwordx4 v103, s[36:39], s40 offen lds
  s_add_u32 s40, s45, 98304
  s_add_u32 m0, s41, 6144
  s_nop 0
  buffer_load_dwordx4 v103, s[36:39], s40 offen lds
  s_add_u32 s40, s40, 16384
  s_add_u32 m0, s41, 7168
  s_nop 0
  buffer_load_dwordx4 v103, s[36:39], s40 offen lds
  s_add_u32 s40, s45, 64
  s_add_u32 m0, s41, 8192
  s_nop 0
  buffer_load_dwordx4 v103, s[36:39], s40 offen lds
  s_add_u32 s40, s40, 16384
  s_add_u32 m0, s41, 9216
  s_nop 0
  buffer_load_dwordx4 v103, s[36:39], s40 offen lds
  s_add_u32 s40, s45, 32832
  s_add_u32 m0, s41, 10240
  s_nop 0
  buffer_load_dwordx4 v103, s[36:39], s40 offen lds
  s_add_u32 s40, s40, 16384
  s_add_u32 m0, s41, 11264
  s_nop 0
  buffer_load_dwordx4 v103, s[36:39], s40 offen lds
  s_add_u32 s40, s45, 65600
  s_add_u32 m0, s41, 12288
  s_nop 0
  buffer_load_dwordx4 v103, s[36:39], s40 offen lds
  s_add_u32 s40, s40, 16384
  s_add_u32 m0, s41, 13312
  s_nop 0
  buffer_load_dwordx4 v103, s[36:39], s40 offen lds
  s_add_u32 s40, s45, 98368
  s_add_u32 m0, s41, 14336
  s_nop 0
  buffer_load_dwordx4 v103, s[36:39], s40 offen lds
  s_add_u32 s40, s40, 16384
  s_add_u32 m0, s41, 15360
  s_nop 0
  buffer_load_dwordx4 v103, s[36:39], s40 offen lds
  s_waitcnt vmcnt(16)
  ds_read_b64_tr_b16 a[160:161], v100 offset:16384
  ds_read_b64_tr_b16 a[162:163], v100 offset:16640
  ds_read_b64_tr_b16 a[224:225], v100 offset:16392
  ds_read_b64_tr_b16 a[226:227], v100 offset:16648
  ds_read_b64_tr_b16 a[164:165], v100 offset:18432
  ds_read_b64_tr_b16 a[166:167], v100 offset:18688
  ds_read_b64_tr_b16 a[228:229], v100 offset:18440
  ds_read_b64_tr_b16 a[230:231], v100 offset:18696
  s_waitcnt lgkmcnt(4)
  ds_read_b64_tr_b16 a[168:169], v100 offset:20480
  ds_read_b64_tr_b16 a[170:171], v100 offset:20736
  ds_read_b64_tr_b16 a[232:233], v100 offset:20488
  ds_read_b64_tr_b16 a[234:235], v100 offset:20744
  ds_read_b64_tr_b16 a[172:173], v100 offset:22528
  ds_read_b64_tr_b16 a[174:175], v100 offset:22784
  ds_read_b64_tr_b16 a[236:237], v100 offset:22536
  ds_read_b64_tr_b16 a[238:239], v100 offset:22792
  s_waitcnt lgkmcnt(4)
  ds_read_b64_tr_b16 a[176:177], v100 offset:24576
  ds_read_b64_tr_b16 a[178:179], v100 offset:24832
  ds_read_b64_tr_b16 a[240:241], v100 offset:24584
  ds_read_b64_tr_b16 a[242:243], v100 offset:24840
  ds_read_b64_tr_b16 a[180:181], v100 offset:26624
  ds_read_b64_tr_b16 a[182:183], v100 offset:26880
  ds_read_b64_tr_b16 a[244:245], v100 offset:26632
  ds_read_b64_tr_b16 a[246:247], v100 offset:26888
  s_waitcnt lgkmcnt(4)
  ds_read_b64_tr_b16 a[184:185], v100 offset:28672
  ds_read_b64_tr_b16 a[186:187], v100 offset:28928
  ds_read_b64_tr_b16 a[248:249], v100 offset:28680
  ds_read_b64_tr_b16 a[250:251], v100 offset:28936
  ds_read_b64_tr_b16 a[188:189], v100 offset:30720
  ds_read_b64_tr_b16 a[190:191], v100 offset:30976
  ds_read_b64_tr_b16 a[252:253], v100 offset:30728
  ds_read_b64_tr_b16 a[254:255], v100 offset:30984
  s_waitcnt lgkmcnt(4)
  s_waitcnt lgkmcnt(0)
  s_add_u32 s40, s45, 128
  s_add_u32 m0, s41, 16384
  s_nop 0
  buffer_load_dwordx4 v103, s[36:39], s40 offen lds
  s_add_u32 s40, s40, 16384
  s_add_u32 m0, s41, 17408
  s_nop 0
  buffer_load_dwordx4 v103, s[36:39], s40 offen lds
  s_add_u32 s40, s45, 32896
  s_add_u32 m0, s41, 18432
  s_nop 0
  buffer_load_dwordx4 v103, s[36:39], s40 offen lds
  s_add_u32 s40, s40, 16384
  s_add_u32 m0, s41, 19456
  s_nop 0
  buffer_load_dwordx4 v103, s[36:39], s40 offen lds
  s_add_u32 s40, s45, 65664
  s_add_u32 m0, s41, 20480
  s_nop 0
  buffer_load_dwordx4 v103, s[36:39], s40 offen lds
  s_add_u32 s40, s40, 16384
  s_add_u32 m0, s41, 21504
  s_nop 0
  buffer_load_dwordx4 v103, s[36:39], s40 offen lds
  s_add_u32 s40, s45, 98432
  s_add_u32 m0, s41, 22528
  s_nop 0
  buffer_load_dwordx4 v103, s[36:39], s40 offen lds
  s_add_u32 s40, s40, 16384
  s_add_u32 m0, s41, 23552
  s_nop 0
  buffer_load_dwordx4 v103, s[36:39], s40 offen lds
  s_add_u32 s40, s45, 192
  s_add_u32 m0, s41, 24576
  s_nop 0
  buffer_load_dwordx4 v103, s[36:39], s40 offen lds
  s_add_u32 s40, s40, 16384
  s_add_u32 m0, s41, 25600
  s_nop 0
  buffer_load_dwordx4 v103, s[36:39], s40 offen lds
  s_add_u32 s40, s45, 32960
  s_add_u32 m0, s41, 26624
  s_nop 0
  buffer_load_dwordx4 v103, s[36:39], s40 offen lds
  s_add_u32 s40, s40, 16384
  s_add_u32 m0, s41, 27648
  s_nop 0
  buffer_load_dwordx4 v103, s[36:39], s40 offen lds
  s_add_u32 s40, s45, 65728
  s_add_u32 m0, s41, 28672
  s_nop 0
  buffer_load_dwordx4 v103, s[36:39], s40 offen lds
  s_add_u32 s40, s40, 16384
  s_add_u32 m0, s41, 29696
  s_nop 0
  buffer_load_dwordx4 v103, s[36:39], s40 offen lds
  s_add_u32 s40, s45, 98496
  s_add_u32 m0, s41, 30720
  s_nop 0
  buffer_load_dwordx4 v103, s[36:39], s40 offen lds
  s_add_u32 s40, s40, 16384
  s_add_u32 m0, s41, 31744
  s_nop 0
  buffer_load_dwordx4 v103, s[36:39], s40 offen lds
  s_waitcnt vmcnt(16)
  ds_read_b64_tr_b16 v[128:129], v100 offset:0
  ds_read_b64_tr_b16 v[130:131], v100 offset:256
  ds_read_b64_tr_b16 v[144:145], v100 offset:8
  ds_read_b64_tr_b16 v[146:147], v100 offset:264
  ds_read_b64_tr_b16 v[132:133], v100 offset:2048
  ds_read_b64_tr_b16 v[134:135], v100 offset:2304
  ds_read_b64_tr_b16 v[148:149], v100 offset:2056
  ds_read_b64_tr_b16 v[150:151], v100 offset:2312
  s_waitcnt lgkmcnt(4)
  ds_read_b64_tr_b16 v[136:137], v100 offset:4096
  ds_read_b64_tr_b16 v[138:139], v100 offset:4352
  ds_read_b64_tr_b16 v[152:153], v100 offset:4104
  ds_read_b64_tr_b16 v[154:155], v100 offset:4360
  ds_read_b64_tr_b16 v[140:141], v100 offset:6144
  ds_read_b64_tr_b16 v[142:143], v100 offset:6400
  ds_read_b64_tr_b16 v[156:157], v100 offset:6152
  ds_read_b64_tr_b16 v[158:159], v100 offset:6408
  s_waitcnt lgkmcnt(4)
  ds_read_b64_tr_b16 v[160:161], v100 offset:8192
  ds_read_b64_tr_b16 v[162:163], v100 offset:8448
  ds_read_b64_tr_b16 v[176:177], v100 offset:8200
  ds_read_b64_tr_b16 v[178:179], v100 offset:8456
  ds_read_b64_tr_b16 v[164:165], v100 offset:10240
  ds_read_b64_tr_b16 v[166:167], v100 offset:10496
  ds_read_b64_tr_b16 v[180:181], v100 offset:10248
  ds_read_b64_tr_b16 v[182:183], v100 offset:10504
  s_waitcnt lgkmcnt(4)
  ds_read_b64_tr_b16 v[168:169], v100 offset:12288
  ds_read_b64_tr_b16 v[170:171], v100 offset:12544
  ds_read_b64_tr_b16 v[184:185], v100 offset:12296
  ds_read_b64_tr_b16 v[186:187], v100 offset:12552
  ds_read_b64_tr_b16 v[172:173], v100 offset:14336
  ds_read_b64_tr_b16 v[174:175], v100 offset:14592
  ds_read_b64_tr_b16 v[188:189], v100 offset:14344
  ds_read_b64_tr_b16 v[190:191], v100 offset:14600
  s_waitcnt lgkmcnt(4)
  s_waitcnt lgkmcnt(0)
  s_waitcnt vmcnt(0)
  ds_read_b64_tr_b16 v[192:193], v100 offset:16384
  ds_read_b64_tr_b16 v[194:195], v100 offset:16640
  ds_read_b64_tr_b16 v[208:209], v100 offset:16392
  ds_read_b64_tr_b16 v[210:211], v100 offset:16648
  ds_read_b64_tr_b16 v[196:197], v100 offset:18432
  ds_read_b64_tr_b16 v[198:199], v100 offset:18688
  ds_read_b64_tr_b16 v[212:213], v100 offset:18440
  ds_read_b64_tr_b16 v[214:215], v100 offset:18696
  s_waitcnt lgkmcnt(4)
  ds_read_b64_tr_b16 v[200:201], v100 offset:20480
  ds_read_b64_tr_b16 v[202:203], v100 offset:20736
  ds_read_b64_tr_b16 v[216:217], v100 offset:20488
  ds_read_b64_tr_b16 v[218:219], v100 offset:20744
  ds_read_b64_tr_b16 v[204:205], v100 offset:22528
  ds_read_b64_tr_b16 v[206:207], v100 offset:22784
  ds_read_b64_tr_b16 v[220:221], v100 offset:22536
  ds_read_b64_tr_b16 v[222:223], v100 offset:22792
  s_waitcnt lgkmcnt(4)
  ds_read_b64_tr_b16 v[224:225], v100 offset:24576
  ds_read_b64_tr_b16 v[226:227], v100 offset:24832
  ds_read_b64_tr_b16 v[240:241], v100 offset:24584
  ds_read_b64_tr_b16 v[242:243], v100 offset:24840
  ds_read_b64_tr_b16 v[228:229], v100 offset:26624
  ds_read_b64_tr_b16 v[230:231], v100 offset:26880
  ds_read_b64_tr_b16 v[244:245], v100 offset:26632
  ds_read_b64_tr_b16 v[246:247], v100 offset:26888
  s_waitcnt lgkmcnt(4)
  ds_read_b64_tr_b16 v[232:233], v100 offset:28672
  ds_read_b64_tr_b16 v[234:235], v100 offset:28928
  ds_read_b64_tr_b16 v[248:249], v100 offset:28680
  ds_read_b64_tr_b16 v[250:251], v100 offset:28936
  ds_read_b64_tr_b16 v[236:237], v100 offset:30720
  ds_read_b64_tr_b16 v[238:239], v100 offset:30976
  ds_read_b64_tr_b16 v[252:253], v100 offset:30728
  ds_read_b64_tr_b16 v[254:255], v100 offset:30984
  s_waitcnt lgkmcnt(4)
  s_waitcnt lgkmcnt(0)
  s_call_b64 s[100:101], VERIFY
  s_cbranch_scc1 VER_OK_27
  v_mov_b32 v0, v116
  s_waitcnt vmcnt(0) lgkmcnt(0)
  s_barrier
  s_branch DISPATCH
VER_OK_27:
  s_barrier
  s_and_b32 s91, s71, 1
  s_lshr_b32 s74, s71, 1
  s_mov_b32 s72, 0
  v_and_b32 v14, 63, v0
  v_and_b32 v3, 7, v14
  v_lshlrev_b32 v3, 6, v3
  s_lshl_b32 s76, s91, 9
  v_add_u32 v3, s76, v3
  s_lshl_b32 s76, s91, 14
  v_add_u32 v6, s76, v6
  s_lshl_b32 s76, s91, 8
  v_add_u32 v7, s76, v7
  s_mov_b32 s93, 0
  s_mov_b32 s92, 268435456
  s_mov_b32 s86, 0
F_LOOPL:
  s_lshl_b32 s73, s74, 6
  s_add_u32 s73, s73, s72
  s_add_u32 s90, s72, 1
  s_add_u32 s87, s73, 1
  s_lshl_b32 s84, s73, 10
  s_add_u32 s84, s84, 24477696
  s_lshl_b32 s85, s87, 10
  s_add_u32 s85, s85, 24477696
  s_cmp_lt_u32 s90, 64
  s_cselect_b32 s85, s85, 268435456
  s_cmp_eq_u32 s93, 1
  s_cbranch_scc1 FL_HAVE_28
FL_W_SPIN_30:
  buffer_load_dword v5, v3, s[8:11], s84 offen sc1
  s_waitcnt vmcnt(0)
  s_mov_b64 exec, 1
  buffer_store_dword v4, v7, s[8:11], s92 offen
  s_mov_b64 exec, -1
  s_mov_b32 s92, 268435456
  v_cmp_eq_u32 vcc, 0, v5
  s_nop 0
  s_cbranch_vccz FL_W_OK_31
  s_cmp_eq_u32 s19, 0
  s_cbranch_scc1 FL_W_OK_31
  s_sub_u32 s19, s19, 1
  s_sleep 1
  s_branch FL_W_SPIN_30
FL_W_OK_31:
  s_lshl_b32 s76, s73, 15
  s_add_u32 s76, s76, 38830080
  s_lshl_b32 s77, s91, 14
  s_add_u32 s76, s76, s77
  s_lshl_b32 s77, s16, 8
  s_add_u32 s76, s76, s77
  s_xor_b32 s77, s86, 0
  s_lshl_b32 s78, s16, 12
  s_add_u32 s77, s77, s78
  s_add_u32 m0, s77, 0
  s_nop 0
  buffer_load_dwordx4 v2, s[8:11], s76 offen offset:0 sc1 lds
  s_add_u32 m0, s77, 960
  s_nop 0
  buffer_load_dwordx4 v2, s[8:11], s76 offen offset:64 sc1 lds
  s_add_u32 m0, s77, 1920
  s_nop 0
  buffer_load_dwordx4 v2, s[8:11], s76 offen offset:128 sc1 lds
  s_add_u32 m0, s77, 2880
  s_nop 0
  buffer_load_dwordx4 v2, s[8:11], s76 offen offset:192 sc1 lds
  s_waitcnt vmcnt(0)
  s_branch FL_GO_29
FL_HAVE_28:
  s_waitcnt vmcnt(4)
FL_GO_29:
  buffer_load_dword v5, v3, s[8:11], s85 offen sc1
  s_waitcnt lgkmcnt(0)
  s_barrier
  v_add_u32 v9, s86, v1
  ds_read_b128 v[48:51], v9 offset:0
  ds_read_b128 v[52:55], v9 offset:1024
  ds_read_b128 v[56:59], v9 offset:2048
  ds_read_b128 v[60:63], v9 offset:3072
  ds_read_b128 v[64:67], v9 offset:4096
  ds_read_b128 v[68:71], v9 offset:5120
  ds_read_b128 v[72:75], v9 offset:6144
  ds_read_b128 v[76:79], v9 offset:7168
  s_waitcnt lgkmcnt(7)
  v_mfma_f32_16x16x32_bf16 v[16:19], a[0:3], v[48:51], 0
  v_mfma_f32_16x16x32_bf16 v[20:23], a[64:67], v[48:51], 0
  v_mfma_f32_16x16x32_bf16 v[24:27], a[128:131], v[48:51], 0
  v_mfma_f32_16x16x32_bf16 v[28:31], a[192:195], v[48:51], 0
  ds_read_b128 v[48:51], v9 offset:8192
  s_waitcnt lgkmcnt(7)
  v_mfma_f32_16x16x32_bf16 v[16:19], a[4:7], v[52:55], v[16:19]
  v_mfma_f32_16x16x32_bf16 v[20:23], a[68:71], v[52:55], v[20:23]
  v_mfma_f32_16x16x32_bf16 v[24:27], a[132:135], v[52:55], v[24:27]
  v_mfma_f32_16x16x32_bf16 v[28:31], a[196:199], v[52:55], v[28:31]
  ds_read_b128 v[52:55], v9 offset:9216
  s_waitcnt lgkmcnt(7)
  v_mfma_f32_16x16x32_bf16 v[16:19], a[8:11], v[56:59], v[16:19]
  v_mfma_f32_16x16x32_bf16 v[20:23], a[72:75], v[56:59], v[20:23]
  v_mfma_f32_16x16x32_bf16 v[24:27], a[136:139], v[56:59], v[24:27]
  v_mfma_f32_16x16x32_bf16 v[28:31], a[200:203], v[56:59], v[28:31]
  ds_read_b128 v[56:59], v9 offset:10240
  s_waitcnt lgkmcnt(7)
  v_mfma_f32_16x16x32_bf16 v[16:19], a[12:15], v[60:63], v[16:19]
  v_mfma_f32_16x16x32_bf16 v[20:23], a[76:79], v[60:63], v[20:23]
  v_mfma_f32_16x16x32_bf16 v[24:27], a[140:143], v[60:63], v[24:27]
  v_mfma_f32_16x16x32_bf16 v[28:31], a[204:207], v[60:63], v[28:31]
  ds_read_b128 v[60:63], v9 offset:11264
  s_waitcnt lgkmcnt(7)
  v_mfma_f32_16x16x32_bf16 v[16:19], a[16:19], v[64:67], v[16:19]
  v_mfma_f32_16x16x32_bf16 v[20:23], a[80:83], v[64:67], v[20:23]
  v_mfma_f32_16x16x32_bf16 v[24:27], a[144:147], v[64:67], v[24:27]
  v_mfma_f32_16x16x32_bf16 v[28:31], a[208:211], v[64:67], v[28:31]
  ds_read_b128 v[64:67], v9 offset:12288
  s_waitcnt lgkmcnt(7)
  v_mfma_f32_16x16x32_bf16 v[16:19], a[20:23], v[68:71], v[16:19]
  v_mfma_f32_16x16x32_bf16 v[20:23], a[84:87], v[68:71], v[20:23]
  v_mfma_f32_16x16x32_bf16 v[24:27], a[148:151], v[68:71], v[24:27]
  v_mfma_f32_16x16x32_bf16 v[28:31], a[212:215], v[68:71], v[28:31]
  ds_read_b128 v[68:71], v9 offset:13312
  s_waitcnt lgkmcnt(7)
  v_mfma_f32_16x16x32_bf16 v[16:19], a[24:27], v[72:75], v[16:19]
  v_mfma_f32_16x16x32_bf16 v[20:23], a[88:91], v[72:75], v[20:23]
  v_mfma_f32_16x16x32_bf16 v[24:27], a[152:155], v[72:75], v[24:27]
  v_mfma_f32_16x16x32_bf16 v[28:31], a[216:219], v[72:75], v[28:31]
  ds_read_b128 v[72:75], v9 offset:14336
  s_waitcnt lgkmcnt(7)
  v_mfma_f32_16x16x32_bf16 v[16:19], a[28:31], v[76:79], v[16:19]
  v_mfma_f32_16x16x32_bf16 v[20:23], a[92:95], v[76:79], v[20:23]
  v_mfma_f32_16x16x32_bf16 v[24:27], a[156:159], v[76:79], v[24:27]
  v_mfma_f32_16x16x32_bf16 v[28:31], a[220:223], v[76:79], v[28:31]
  ds_read_b128 v[76:79], v9 offset:15360
  s_waitcnt vmcnt(0)
  s_mov_b64 exec, 1
  buffer_store_dword v4, v7, s[8:11], s92 offen
  s_mov_b64 exec, -1
  s_mov_b32 s92, 268435456
  v_cmp_eq_u32 vcc, 0, v5
  s_mov_b32 s93, 0
  s_cbranch_vccnz FL_NOPF_32
  s_mov_b32 s93, 1
  s_lshl_b32 s76, s87, 15
  s_add_u32 s76, s76, 38830080
  s_lshl_b32 s77, s91, 14
  s_add_u32 s76, s76, s77
  s_lshl_b32 s77, s16, 8
  s_add_u32 s76, s76, s77
  s_xor_b32 s77, s86, 16384
  s_lshl_b32 s78, s16, 12
  s_add_u32 s77, s77, s78
  s_add_u32 m0, s77, 0
  s_nop 0
  buffer_load_dwordx4 v2, s[8:11], s76 offen offset:0 sc1 lds
  s_add_u32 m0, s77, 960
  s_nop 0
  buffer_load_dwordx4 v2, s[8:11], s76 offen offset:64 sc1 lds
  s_add_u32 m0, s77, 1920
  s_nop 0
  buffer_load_dwordx4 v2, s[8:11], s76 offen offset:128 sc1 lds
  s_add_u32 m0, s77, 2880
  s_nop 0
  buffer_load_dwordx4 v2, s[8:11], s76 offen offset:192 sc1 lds
FL_NOPF_32:
  s_waitcnt lgkmcnt(7)
  v_mfma_f32_16x16x32_bf16 v[16:19], a[32:35], v[48:51], v[16:19]
  s_mul_i32 s76, s73, 524288
  s_add_u32 s76, s76, 43024384
  s_lshl_b32 s92, s73, 9
  v_mfma_f32_16x16x32_bf16 v[20:23], a[96:99], v[48:51], v[20:23]
  s_add_u32 s92, s92, 24608768
  v_mfma_f32_16x16x32_bf16 v[24:27], a[160:163], v[48:51], v[24:27]
  v_mfma_f32_16x16x32_bf16 v[28:31], a[224:227], v[48:51], v[28:31]
  s_waitcnt lgkmcnt(6)
  v_mfma_f32_16x16x32_bf16 v[16:19], a[36:39], v[52:55], v[16:19]
  v_mfma_f32_16x16x32_bf16 v[20:23], a[100:103], v[52:55], v[20:23]
  v_mfma_f32_16x16x32_bf16 v[24:27], a[164:167], v[52:55], v[24:27]
  v_mfma_f32_16x16x32_bf16 v[28:31], a[228:231], v[52:55], v[28:31]
  s_waitcnt lgkmcnt(5)
  v_mfma_f32_16x16x32_bf16 v[16:19], a[40:43], v[56:59], v[16:19]
  v_mfma_f32_16x16x32_bf16 v[20:23], a[104:107], v[56:59], v[20:23]
  v_mfma_f32_16x16x32_bf16 v[24:27], a[168:171], v[56:59], v[24:27]
  v_mfma_f32_16x16x32_bf16 v[28:31], a[232:235], v[56:59], v[28:31]
  s_waitcnt lgkmcnt(4)
  v_mfma_f32_16x16x32_bf16 v[16:19], a[44:47], v[60:63], v[16:19]
  v_mfma_f32_16x16x32_bf16 v[20:23], a[108:111], v[60:63], v[20:23]
  v_mfma_f32_16x16x32_bf16 v[24:27], a[172:175], v[60:63], v[24:27]
  v_mfma_f32_16x16x32_bf16 v[28:31], a[236:239], v[60:63], v[28:31]
  s_waitcnt lgkmcnt(3)
  v_mfma_f32_16x16x32_bf16 v[16:19], a[48:51], v[64:67], v[16:19]
  v_mfma_f32_16x16x32_bf16 v[20:23], a[112:115], v[64:67], v[20:23]
  v_mfma_f32_16x16x32_bf16 v[24:27], a[176:179], v[64:67], v[24:27]
  v_mfma_f32_16x16x32_bf16 v[28:31], a[240:243], v[64:67], v[28:31]
  s_waitcnt lgkmcnt(2)
  v_mfma_f32_16x16x32_bf16 v[16:19], a[52:55], v[68:71], v[16:19]
  v_mfma_f32_16x16x32_bf16 v[20:23], a[116:119], v[68:71], v[20:23]
  v_mfma_f32_16x16x32_bf16 v[24:27], a[180:183], v[68:71], v[24:27]
  v_mfma_f32_16x16x32_bf16 v[28:31], a[244:247], v[68:71], v[28:31]
  s_waitcnt lgkmcnt(1)
  v_mfma_f32_16x16x32_bf16 v[16:19], a[56:59], v[72:75], v[16:19]
  v_mfma_f32_16x16x32_bf16 v[20:23], a[120:123], v[72:75], v[20:23]
  v_mfma_f32_16x16x32_bf16 v[24:27], a[184:187], v[72:75], v[24:27]
  v_mfma_f32_16x16x32_bf16 v[28:31], a[248:251], v[72:75], v[28:31]
  s_waitcnt lgkmcnt(0)
  v_mfma_f32_16x16x32_bf16 v[16:19], a[60:63], v[76:79], v[16:19]
  v_mfma_f32_16x16x32_bf16 v[20:23], a[124:127], v[76:79], v[20:23]
  v_mfma_f32_16x16x32_bf16 v[24:27], a[188:191], v[76:79], v[24:27]
  v_mfma_f32_16x16x32_bf16 v[28:31], a[252:255], v[76:79], v[28:31]
  s_nop 4
  v_cvt_pk_bf16_f32 v80, v16, v17
  v_cvt_pk_bf16_f32 v88, v18, v19
  v_and_b32 v17, 0xffff0000, v80
  v_and_b32 v19, 0xffff0000, v88
  v_lshlrev_b32 v16, 16, v80
  v_lshlrev_b32 v18, 16, v88
  v_mul_f32 v82, 0xbfb8aa3b, v16
  v_mul_f32 v83, 0xbfb8aa3b, v17
  v_mul_f32 v90, 0xbfb8aa3b, v18
  v_mul_f32 v91, 0xbfb8aa3b, v19
  v_exp_f32 v82, v82
  v_exp_f32 v83, v83
  v_exp_f32 v90, v90
  v_exp_f32 v91, v91
  v_add_f32 v82, 1.0, v82
  v_add_f32 v83, 1.0, v83
  v_add_f32 v90, 1.0, v90
  v_add_f32 v91, 1.0, v91
  v_rcp_f32 v82, v82
  v_rcp_f32 v83, v83
  v_rcp_f32 v90, v90
  v_rcp_f32 v91, v91
  v_mul_f32 v16, v16, v82
  v_mul_f32 v17, v17, v83
  v_mul_f32 v18, v18, v90
  v_mul_f32 v19, v19, v91
  v_cvt_pk_bf16_f32 v80, v16, v17
  v_cvt_pk_bf16_f32 v88, v18, v19
  v_lshlrev_b32 v16, 16, v80
  v_and_b32 v17, 0xffff0000, v80
  v_lshlrev_b32 v18, 16, v88
  v_and_b32 v19, 0xffff0000, v88
  v_cvt_pk_bf16_f32 v80, v20, v21
  v_cvt_pk_bf16_f32 v88, v22, v23
  v_and_b32 v21, 0xffff0000, v80
  v_and_b32 v23, 0xffff0000, v88
  v_lshlrev_b32 v20, 16, v80
  v_lshlrev_b32 v22, 16, v88
  v_mul_f32 v82, 0xbfb8aa3b, v20
  v_mul_f32 v83, 0xbfb8aa3b, v21
  v_mul_f32 v90, 0xbfb8aa3b, v22
  v_mul_f32 v91, 0xbfb8aa3b, v23
  v_exp_f32 v82, v82
  v_exp_f32 v83, v83
  v_exp_f32 v90, v90
  v_exp_f32 v91, v91
  v_add_f32 v82, 1.0, v82
  v_add_f32 v83, 1.0, v83
  v_add_f32 v90, 1.0, v90
  v_add_f32 v91, 1.0, v91
  v_rcp_f32 v82, v82
  v_rcp_f32 v83, v83
  v_rcp_f32 v90, v90
  v_rcp_f32 v91, v91
  v_cvt_pk_bf16_f32 v81, v24, v25
  v_cvt_pk_bf16_f32 v89, v26, v27
  v_mul_f32 v20, v20, v82
  v_mul_f32 v21, v21, v83
  v_mul_f32 v22, v22, v90
  v_mul_f32 v23, v23, v91
  v_lshlrev_b32 v24, 16, v81
  v_and_b32 v25, 0xffff0000, v81
  v_lshlrev_b32 v26, 16, v89
  v_and_b32 v27, 0xffff0000, v89
  v_cvt_pk_bf16_f32 v81, v28, v29
  v_cvt_pk_bf16_f32 v80, v20, v21
  v_cvt_pk_bf16_f32 v89, v30, v31
  v_cvt_pk_bf16_f32 v88, v22, v23
  v_and_b32 v29, 0xffff0000, v81
  v_and_b32 v21, 0xffff0000, v80
  v_and_b32 v31, 0xffff0000, v89
  v_and_b32 v23, 0xffff0000, v88
  v_lshlrev_b32 v28, 16, v81
  v_lshlrev_b32 v20, 16, v80
  v_lshlrev_b32 v30, 16, v89
  v_lshlrev_b32 v22, 16, v88
  v_mul_f32 v16, v16, v24
  v_mul_f32 v17, v17, v25
  v_mul_f32 v18, v18, v26
  v_mul_f32 v19, v19, v27
  v_mul_f32 v20, v20, v28
  v_mul_f32 v21, v21, v29
  v_mul_f32 v22, v22, v30
  v_mul_f32 v23, v23, v31
  v_cvt_pk_bf16_f32 v96, v16, v17
  v_cvt_pk_bf16_f32 v97, v18, v19
  v_cvt_pk_bf16_f32 v98, v20, v21
  v_cvt_pk_bf16_f32 v99, v22, v23
  ds_write_b128 v8, v[96:99]
  s_waitcnt lgkmcnt(0)
  s_barrier
  ds_read_b128 v[104:107], v10 offset:0
  ds_read_b128 v[108:111], v10 offset:1024
  ds_read_b128 v[112:115], v10 offset:2048
  ds_read_b128 v[116:119], v10 offset:3072
  s_waitcnt lgkmcnt(3)
  v_mfma_f32_16x16x32_bf16 v[32:35], v[128:131], v[104:107], 0
  v_mfma_f32_16x16x32_bf16 v[36:39], v[144:147], v[104:107], 0
  s_waitcnt lgkmcnt(2)
  v_mfma_f32_16x16x32_bf16 v[32:35], v[132:135], v[108:111], v[32:35]
  v_mfma_f32_16x16x32_bf16 v[36:39], v[148:151], v[108:111], v[36:39]
  s_waitcnt lgkmcnt(1)
  v_mfma_f32_16x16x32_bf16 v[32:35], v[136:139], v[112:115], v[32:35]
  v_mfma_f32_16x16x32_bf16 v[36:39], v[152:155], v[112:115], v[36:39]
  s_waitcnt lgkmcnt(0)
  v_mfma_f32_16x16x32_bf16 v[32:35], v[140:143], v[116:119], v[32:35]
  v_mfma_f32_16x16x32_bf16 v[36:39], v[156:159], v[116:119], v[36:39]
  v_mfma_f32_16x16x32_bf16 v[40:43], v[160:163], v[104:107], 0
  v_mfma_f32_16x16x32_bf16 v[44:47], v[176:179], v[104:107], 0
  s_nop 4
  v_cvt_pk_bf16_f32 v120, v32, v33
  v_mfma_f32_16x16x32_bf16 v[40:43], v[164:167], v[108:111], v[40:43]
  v_cvt_pk_bf16_f32 v121, v34, v35
  v_mfma_f32_16x16x32_bf16 v[44:47], v[180:183], v[108:111], v[44:47]
  v_cvt_pk_bf16_f32 v122, v36, v37
  v_mfma_f32_16x16x32_bf16 v[40:43], v[168:171], v[112:115], v[40:43]
  v_cvt_pk_bf16_f32 v123, v38, v39
  v_mfma_f32_16x16x32_bf16 v[44:47], v[184:187], v[112:115], v[44:47]
  buffer_store_dwordx4 v[120:123], v6, s[8:11], s76 offen offset:0
  v_mfma_f32_16x16x32_bf16 v[40:43], v[172:175], v[116:119], v[40:43]
  v_mfma_f32_16x16x32_bf16 v[44:47], v[188:191], v[116:119], v[44:47]
  v_mfma_f32_16x16x32_bf16 v[48:51], v[192:195], v[104:107], 0
  v_mfma_f32_16x16x32_bf16 v[52:55], v[208:211], v[104:107], 0
  s_nop 4
  v_cvt_pk_bf16_f32 v124, v40, v41
  v_mfma_f32_16x16x32_bf16 v[48:51], v[196:199], v[108:111], v[48:51]
  v_cvt_pk_bf16_f32 v125, v42, v43
  v_mfma_f32_16x16x32_bf16 v[52:55], v[212:215], v[108:111], v[52:55]
  v_cvt_pk_bf16_f32 v126, v44, v45
  v_mfma_f32_16x16x32_bf16 v[48:51], v[200:203], v[112:115], v[48:51]
  v_cvt_pk_bf16_f32 v127, v46, v47
  v_mfma_f32_16x16x32_bf16 v[52:55], v[216:219], v[112:115], v[52:55]
  buffer_store_dwordx4 v[124:127], v6, s[8:11], s76 offen offset:64
  v_mfma_f32_16x16x32_bf16 v[48:51], v[204:207], v[116:119], v[48:51]
  v_mfma_f32_16x16x32_bf16 v[52:55], v[220:223], v[116:119], v[52:55]
  v_mfma_f32_16x16x32_bf16 v[56:59], v[224:227], v[104:107], 0
  v_mfma_f32_16x16x32_bf16 v[60:63], v[240:243], v[104:107], 0
  s_nop 4
  v_cvt_pk_bf16_f32 v120, v48, v49
  v_mfma_f32_16x16x32_bf16 v[56:59], v[228:231], v[108:111], v[56:59]
  v_cvt_pk_bf16_f32 v121, v50, v51
  v_mfma_f32_16x16x32_bf16 v[60:63], v[244:247], v[108:111], v[60:63]
  v_cvt_pk_bf16_f32 v122, v52, v53
  v_mfma_f32_16x16x32_bf16 v[56:59], v[232:235], v[112:115], v[56:59]
  v_cvt_pk_bf16_f32 v123, v54, v55
  v_mfma_f32_16x16x32_bf16 v[60:63], v[248:251], v[112:115], v[60:63]
  buffer_store_dwordx4 v[120:123], v6, s[8:11], s76 offen offset:128
  v_mfma_f32_16x16x32_bf16 v[56:59], v[236:239], v[116:119], v[56:59]
  v_mfma_f32_16x16x32_bf16 v[60:63], v[252:255], v[116:119], v[60:63]
  s_nop 6
  v_cvt_pk_bf16_f32 v124, v56, v57
  v_cvt_pk_bf16_f32 v125, v58, v59
  v_cvt_pk_bf16_f32 v126, v60, v61
  v_cvt_pk_bf16_f32 v127, v62, v63
  buffer_store_dwordx4 v[124:127], v6, s[8:11], s76 offen offset:192
  s_waitcnt vmcnt(0)
  s_mov_b64 exec, 1
  buffer_store_dword v4, v7, s[8:11], s92 offen
  s_mov_b64 exec, -1
  s_mov_b32 s92, 268435456
  s_xor_b32 s86, s86, 16384
  s_add_u32 s72, s72, 1
  s_cmp_lt_u32 s72, 64
  s_cbranch_scc1 F_LOOPL
  s_waitcnt vmcnt(0)
  s_mov_b64 exec, 1
  buffer_store_dword v4, v7, s[8:11], s92 offen
  s_mov_b64 exec, -1
  s_mov_b32 s92, 268435456
  s_endpgm
ROLE_BG:
  s_call_b64 s[100:101], VERIFY
  s_cbranch_scc1 VER_OK_33
  v_mov_b32 v0, v116
  s_waitcnt vmcnt(0) lgkmcnt(0)
  s_barrier
  s_branch DISPATCH
VER_OK_33:
  s_mov_b32 s70, s17
  s_lshr_b32 s71, s70, 5
  s_and_b32 s72, s70, 31
  v_and_b32 v14, 63, v0
  v_lshlrev_b32 v1, 4, v14
  s_lshl_b32 s34, s72, 13
  v_lshlrev_b32 v2, 3, v14
  v_and_b32 v3, 3, v14
  v_lshlrev_b32 v3, 2, v3
  s_lshl_b32 s34, s72, 4
  v_add_u32 v3, s34, v3
  v_mov_b32 v4, 1
  v_mov_b32 v6, v3
  v_and_b32 v3, 3, v14
  v_lshlrev_b32 v3, 6, v3
  s_lshl_b32 s34, s72, 8
  v_add_u32 v3, s34, v3
  v_and_b32 v15, 15, v14
  v_lshrrev_b32 v13, 4, v14
  v_lshlrev_b32 v13, 2, v13
  v_mov_b32 v5, 0xf149f2ca
  v_add_u32 v7, 0, v13
  v_cmp_le_u32 vcc, v7, v15
  s_nop 1
  v_cndmask_b32 v8, v5, 0, vcc
  v_add_u32 v7, 1, v13
  v_cmp_le_u32 vcc, v7, v15
  s_nop 1
  v_cndmask_b32 v9, v5, 0, vcc
  v_add_u32 v7, 2, v13
  v_cmp_le_u32 vcc, v7, v15
  s_nop 1
  v_cndmask_b32 v10, v5, 0, vcc
  v_add_u32 v7, 3, v13
  v_cmp_le_u32 vcc, v7, v15
  s_nop 1
  v_cndmask_b32 v11, v5, 0, vcc
  v_mov_b32 v12, v8
  v_mov_b32 v13, v9
  v_mov_b32 v14, v10
  v_mov_b32 v15, v11
  s_mov_b32 s34, -1
  s_mov_b32 s35, 0
  v_cndmask_b32 v16, v5, 0, s[34:35]
  v_cndmask_b32 v17, v5, 0, s[34:35]
  v_cndmask_b32 v18, v5, 0, s[34:35]
  v_cndmask_b32 v19, v5, 0, s[34:35]
  s_mov_b32 s60, 1040356334
  s_mov_b32 s73, 0
  s_mov_b32 s93, 0
  s_mov_b32 s92, 268435456
B_LOOPG:
  s_lshl_b32 s74, s71, 6
  s_add_u32 s74, s74, s73
  s_lshl_b32 s76, s74, 13
  s_add_u32 s76, s76, 22282240
  s_lshl_b32 s77, s74, 13
  s_add_u32 s77, s77, 23330816
  s_lshl_b32 s80, s74, 18
  s_lshl_b32 s35, s72, 13
  s_add_u32 s80, s80, s35
  s_add_u32 s80, s80, 110133248
  s_cmp_eq_u32 s93, 1
  s_cbranch_scc1 B_HAVE0G
B_KV0G:
  buffer_load_dword v5, v3, s[8:11], s76 offen sc1
  s_waitcnt vmcnt(0)
  s_mov_b64 exec, 15
  buffer_store_dword v4, v6, s[8:11], s92 offen sc1
  s_mov_b64 exec, -1
  s_mov_b32 s92, 268435456
  v_cmp_eq_u32 vcc, 0, v5
  s_nop 0
  s_cbranch_vccz B_KVO0G
  s_cmp_eq_u32 s19, 0
  s_cbranch_scc1 B_KVO0G
  s_sub_u32 s19, s19, 1
  s_sleep 1
  s_branch B_KV0G
B_KVO0G:
  s_lshl_b32 s34, s74, 18
  s_lshl_b32 s35, s72, 13
  s_add_u32 s34, s34, s35
  s_add_u32 s34, s34, 177242112
  buffer_load_dwordx4 a[0:3], v1, s[8:11], s34 offen offset:0 sc1
  buffer_load_dwordx4 a[4:7], v1, s[8:11], s34 offen offset:1024 sc1
  buffer_load_dwordx4 a[8:11], v1, s[8:11], s34 offen offset:2048 sc1
  buffer_load_dwordx4 a[12:15], v1, s[8:11], s34 offen offset:3072 sc1
  s_add_u32 s34, s34, 4096
  buffer_load_dwordx4 a[16:19], v1, s[8:11], s34 offen offset:0 sc1
  buffer_load_dwordx4 a[20:23], v1, s[8:11], s34 offen offset:1024 sc1
  buffer_load_dwordx4 a[24:27], v1, s[8:11], s34 offen offset:2048 sc1
  buffer_load_dwordx4 a[28:31], v1, s[8:11], s34 offen offset:3072 sc1
  s_lshl_b32 s34, s74, 19
  s_lshl_b32 s35, s72, 14
  s_add_u32 s34, s34, s35
  s_add_u32 s34, s34, 43024384
  buffer_load_dwordx4 a[32:35], v1, s[8:11], s34 offen offset:0 sc1
  buffer_load_dwordx4 a[48:51], v1, s[8:11], s34 offen offset:1024 sc1
  buffer_load_dwordx4 a[64:67], v1, s[8:11], s34 offen offset:2048 sc1
  buffer_load_dwordx4 a[68:71], v1, s[8:11], s34 offen offset:3072 sc1
  s_add_u32 s34, s34, 4096
  buffer_load_dwordx4 a[36:39], v1, s[8:11], s34 offen offset:0 sc1
  buffer_load_dwordx4 a[52:55], v1, s[8:11], s34 offen offset:1024 sc1
  buffer_load_dwordx4 a[72:75], v1, s[8:11], s34 offen offset:2048 sc1
  buffer_load_dwordx4 a[76:79], v1, s[8:11], s34 offen offset:3072 sc1
  s_add_u32 s34, s34, 4096
  buffer_load_dwordx4 a[40:43], v1, s[8:11], s34 offen offset:0 sc1
  buffer_load_dwordx4 a[56:59], v1, s[8:11], s34 offen offset:1024 sc1
  buffer_load_dwordx4 a[80:83], v1, s[8:11], s34 offen offset:2048 sc1
  buffer_load_dwordx4 a[84:87], v1, s[8:11], s34 offen offset:3072 sc1
  s_add_u32 s34, s34, 4096
  buffer_load_dwordx4 a[44:47], v1, s[8:11], s34 offen offset:0 sc1
  buffer_load_dwordx4 a[60:63], v1, s[8:11], s34 offen offset:1024 sc1
  buffer_load_dwordx4 a[88:91], v1, s[8:11], s34 offen offset:2048 sc1
  buffer_load_dwordx4 a[92:95], v1, s[8:11], s34 offen offset:3072 sc1
B_HAVE0G:
  s_add_u32 s36, s76, 8192
  s_cmp_lt_u32 s73, 63
  s_cselect_b32 s36, s36, 268435456
  buffer_load_dword v5, v3, s[8:11], s36 offen sc1
  buffer_load_dword v7, v3, s[8:11], s77 offen sc1
  s_waitcnt vmcnt(0)
  s_mov_b64 exec, 15
  buffer_store_dword v4, v6, s[8:11], s92 offen sc1
  s_mov_b64 exec, -1
  s_mov_b32 s92, 268435456
  v_cmp_eq_u32 vcc, 0, v7
  s_nop 0
  s_cbranch_vccz B0G_KMO
B0G_KMS:
  buffer_load_dword v7, v3, s[8:11], s77 offen sc1
  s_waitcnt vmcnt(0)
  v_cmp_eq_u32 vcc, 0, v7
  s_nop 0
  s_cbranch_vccz B0G_KMO
  s_cmp_eq_u32 s19, 0
  s_cbranch_scc1 B0G_KMO
  s_sub_u32 s19, s19, 1
  s_branch B0G_KMS
B0G_KMO:
  s_add_u32 s34, s80, 4096
  buffer_load_dwordx4 v[20:23], v1, s[8:11], s80 offen offset:0 sc1
  buffer_load_dwordx4 v[24:27], v1, s[8:11], s80 offen offset:2048 sc1
  buffer_load_dwordx4 v[28:31], v1, s[8:11], s34 offen offset:0 sc1
  buffer_load_dwordx4 v[32:35], v1, s[8:11], s34 offen offset:2048 sc1
  buffer_load_dwordx2 v[36:37], v2, s[8:11], s80 offen offset:1024 sc1
  buffer_load_dwordx2 v[38:39], v2, s[8:11], s80 offen offset:1536 sc1
  buffer_load_dwordx2 v[40:41], v2, s[8:11], s80 offen offset:3072 sc1
  buffer_load_dwordx2 v[42:43], v2, s[8:11], s80 offen offset:3584 sc1
  buffer_load_dwordx2 v[44:45], v2, s[8:11], s34 offen offset:1024 sc1
  buffer_load_dwordx2 v[46:47], v2, s[8:11], s34 offen offset:1536 sc1
  buffer_load_dwordx2 v[48:49], v2, s[8:11], s34 offen offset:3072 sc1
  buffer_load_dwordx2 v[50:51], v2, s[8:11], s34 offen offset:3584 sc1
  v_cmp_eq_u32 vcc, 0, v5
  s_nop 0
  s_cmp_eq_u64 vcc, 0
  s_cselect_b32 s93, 1, 0
  s_add_u32 s37, s74, 1
  s_lshl_b32 s82, s37, 18
  s_lshl_b32 s35, s72, 13
  s_add_u32 s82, s82, s35
  s_add_u32 s82, s82, 177242112
  s_lshl_b32 s83, s37, 19
  s_lshl_b32 s35, s72, 14
  s_add_u32 s83, s83, s35
  s_add_u32 s83, s83, 43024384
  s_cmp_eq_u32 s93, 1
  s_cselect_b32 s82, s82, 268435456
  s_cselect_b32 s83, s83, 268435456
  buffer_load_dwordx4 a[96:99], v1, s[8:11], s82 offen offset:0 sc1
  buffer_load_dwordx4 a[100:103], v1, s[8:11], s82 offen offset:1024 sc1
  buffer_load_dwordx4 a[104:107], v1, s[8:11], s82 offen offset:2048 sc1
  buffer_load_dwordx4 a[108:111], v1, s[8:11], s82 offen offset:3072 sc1
  s_add_u32 s82, s82, 4096
  buffer_load_dwordx4 a[112:115], v1, s[8:11], s82 offen offset:0 sc1
  buffer_load_dwordx4 a[116:119], v1, s[8:11], s82 offen offset:1024 sc1
  buffer_load_dwordx4 a[120:123], v1, s[8:11], s82 offen offset:2048 sc1
  buffer_load_dwordx4 a[124:127], v1, s[8:11], s82 offen offset:3072 sc1
  buffer_load_dwordx4 a[128:131], v1, s[8:11], s83 offen offset:0 sc1
  buffer_load_dwordx4 a[144:147], v1, s[8:11], s83 offen offset:1024 sc1
  buffer_load_dwordx4 a[160:163], v1, s[8:11], s83 offen offset:2048 sc1
  buffer_load_dwordx4 a[164:167], v1, s[8:11], s83 offen offset:3072 sc1
  s_add_u32 s83, s83, 4096
  buffer_load_dwordx4 a[132:135], v1, s[8:11], s83 offen offset:0 sc1
  buffer_load_dwordx4 a[148:151], v1, s[8:11], s83 offen offset:1024 sc1
  buffer_load_dwordx4 a[168:171], v1, s[8:11], s83 offen offset:2048 sc1
  buffer_load_dwordx4 a[172:175], v1, s[8:11], s83 offen offset:3072 sc1
  s_add_u32 s83, s83, 4096
  buffer_load_dwordx4 a[136:139], v1, s[8:11], s83 offen offset:0 sc1
  buffer_load_dwordx4 a[152:155], v1, s[8:11], s83 offen offset:1024 sc1
  buffer_load_dwordx4 a[176:179], v1, s[8:11], s83 offen offset:2048 sc1
  buffer_load_dwordx4 a[180:183], v1, s[8:11], s83 offen offset:3072 sc1
  s_add_u32 s83, s83, 4096
  buffer_load_dwordx4 a[140:143], v1, s[8:11], s83 offen offset:0 sc1
  buffer_load_dwordx4 a[156:159], v1, s[8:11], s83 offen offset:1024 sc1
  buffer_load_dwordx4 a[184:187], v1, s[8:11], s83 offen offset:2048 sc1
  buffer_load_dwordx4 a[188:191], v1, s[8:11], s83 offen offset:3072 sc1
  v_mfma_f32_16x16x32_bf16 v[52:55], a[32:35], a[0:3], v[8:11]
  v_mfma_f32_16x16x32_bf16 v[64:67], a[32:35], a[16:19], 0
  v_mfma_f32_16x16x32_bf16 v[68:71], a[48:51], a[16:19], v[12:15]
  v_mfma_f32_16x16x32_bf16 v[52:55], a[36:39], a[4:7], v[52:55]
  v_mfma_f32_16x16x32_bf16 v[64:67], a[36:39], a[20:23], v[64:67]
  v_mfma_f32_16x16x32_bf16 v[68:71], a[52:55], a[20:23], v[68:71]
  v_mfma_f32_16x16x32_bf16 v[52:55], a[40:43], a[8:11], v[52:55]
  v_mfma_f32_16x16x32_bf16 v[64:67], a[40:43], a[24:27], v[64:67]
  v_mfma_f32_16x16x32_bf16 v[68:71], a[56:59], a[24:27], v[68:71]
  v_mfma_f32_16x16x32_bf16 v[52:55], a[44:47], a[12:15], v[52:55]
  v_mfma_f32_16x16x32_bf16 v[64:67], a[44:47], a[28:31], v[64:67]
  v_mfma_f32_16x16x32_bf16 v[68:71], a[60:63], a[28:31], v[68:71]
  s_waitcnt vmcnt(24)
  v_mfma_f32_16x16x32_bf16 v[60:63], v[20:23], a[0:3], v[16:19]
  s_lshl_b32 s78, s74, 18
  s_nop 2
  v_max3_f32 v148, v52, v53, v54
  v_mfma_f32_16x16x32_bf16 v[60:63], v[24:27], a[4:7], v[60:63]
  s_lshl_b32 s35, s72, 13
  v_max3_f32 v150, v64, v65, v66
  v_mfma_f32_16x16x32_bf16 v[60:63], v[28:31], a[8:11], v[60:63]
  s_add_u32 s78, s78, s35
  v_max3_f32 v150, v150, v67, v68
  v_mfma_f32_16x16x32_bf16 v[60:63], v[32:35], a[12:15], v[60:63]
  s_add_u32 s78, s78, 143687680
  v_max3_f32 v150, v150, v69, v70
  v_mfma_f32_16x16x32_bf16 v[72:75], v[20:23], a[16:19], v[16:19]
  s_add_u32 s36, s78, 4096
  v_mov_b32 v88, 0x3f803f80
  v_mfma_f32_16x16x32_bf16 v[72:75], v[24:27], a[20:23], v[72:75]
  s_lshl_b32 s92, s74, 9
  v_mov_b32 v89, 0x3f803f80
  v_mfma_f32_16x16x32_bf16 v[72:75], v[28:31], a[24:27], v[72:75]
  s_add_u32 s92, s92, 24379392
  v_max3_f32 v148, v148, v55, v60
  v_mfma_f32_16x16x32_bf16 v[72:75], v[32:35], a[28:31], v[72:75]
  v_max3_f32 v148, v148, v61, v62
  v_max_f32 v148, v148, v63
  v_mov_b32 v149, v148
  v_mov_b32 v90, 0x3f803f80
  s_nop 0
  v_permlane16_swap_b32 v148, v149
  v_max_f32 v148, v148, v149
  v_mov_b32 v149, v148
  v_mov_b32 v91, 0x3f803f80
  s_nop 0
  v_permlane32_swap_b32 v148, v149
  v_max_f32 v148, v148, v149
  v_mul_f32 v148, s60, v148
  v_fma_f32 v52, v52, s60, -v148
  v_fma_f32 v53, v53, s60, -v148
  v_fma_f32 v54, v54, s60, -v148
  v_fma_f32 v55, v55, s60, -v148
  v_exp_f32 v52, v52
  v_exp_f32 v53, v53
  v_exp_f32 v54, v54
  v_exp_f32 v55, v55
  v_cvt_pk_bf16_f32 v76, v52, v53
  v_cvt_pk_bf16_f32 v77, v54, v55
  v_mov_b32 v78, 0
  v_mov_b32 v79, 0
  v_max3_f32 v150, v150, v71, v72
  s_nop 0
  v_mfma_f32_16x16x32_bf16 v[92:95], v[88:91], v[76:79], 0
  v_max3_f32 v150, v150, v73, v74
  v_max_f32 v150, v150, v75
  v_mov_b32 v151, v150
  v_fma_f32 v60, v60, s60, -v148
  v_fma_f32 v61, v61, s60, -v148
  v_fma_f32 v62, v62, s60, -v148
  v_fma_f32 v63, v63, s60, -v148
  v_exp_f32 v60, v60
  v_exp_f32 v61, v61
  v_exp_f32 v62, v62
  v_exp_f32 v63, v63
  v_permlane16_swap_b32 v150, v151
  v_max_f32 v150, v150, v151
  v_cvt_pk_bf16_f32 v84, v60, v61
  v_cvt_pk_bf16_f32 v85, v62, v63
  v_mov_b32 v151, v150
  v_mov_b32 v78, 0
  v_mfma_f32_16x16x16_bf16 v[92:95], v[88:89], v[84:85], v[92:95]
  v_permlane32_swap_b32 v150, v151
  v_max_f32 v150, v150, v151
  v_mul_f32 v150, s60, v150
  v_fma_f32 v64, v64, s60, -v150
  v_fma_f32 v65, v65, s60, -v150
  v_fma_f32 v66, v66, s60, -v150
  v_fma_f32 v67, v67, s60, -v150
  v_fma_f32 v68, v68, s60, -v150
  v_fma_f32 v69, v69, s60, -v150
  v_fma_f32 v70, v70, s60, -v150
  v_fma_f32 v71, v71, s60, -v150
  v_exp_f32 v64, v64
  v_exp_f32 v65, v65
  v_exp_f32 v66, v66
  v_exp_f32 v67, v67
  v_exp_f32 v68, v68
  v_exp_f32 v69, v69
  v_exp_f32 v70, v70
  v_exp_f32 v71, v71
  v_cvt_pk_bf16_f32 v80, v64, v65
  v_cvt_pk_bf16_f32 v81, v66, v67
  v_cvt_pk_bf16_f32 v82, v68, v69
  v_cvt_pk_bf16_f32 v83, v70, v71
  v_rcp_f32 v149, v92
  s_nop 0
  v_mfma_f32_16x16x32_bf16 v[96:99], v[88:91], v[80:83], 0
  v_fma_f32 v72, v72, s60, -v150
  v_fma_f32 v73, v73, s60, -v150
  v_fma_f32 v74, v74, s60, -v150
  v_fma_f32 v75, v75, s60, -v150
  v_mul_f32 v52, v52, v149
  v_mul_f32 v53, v53, v149
  v_mul_f32 v54, v54, v149
  v_mul_f32 v55, v55, v149
  v_cvt_pk_bf16_f32 v76, v52, v53
  v_cvt_pk_bf16_f32 v77, v54, v55
  v_exp_f32 v72, v72
  v_exp_f32 v73, v73
  v_exp_f32 v74, v74
  v_exp_f32 v75, v75
  v_mov_b32 v79, 0
  v_cvt_pk_bf16_f32 v86, v72, v73
  s_nop 0
  v_mfma_f32_16x16x32_bf16 v[100:103], a[64:67], v[76:79], 0
  v_cvt_pk_bf16_f32 v87, v74, v75
  v_mfma_f32_16x16x32_bf16 v[104:107], a[68:71], v[76:79], 0
  v_mul_f32 v60, v60, v149
  v_mul_f32 v61, v61, v149
  v_mfma_f32_16x16x32_bf16 v[108:111], a[72:75], v[76:79], 0
  v_mul_f32 v62, v62, v149
  v_mul_f32 v63, v63, v149
  v_mfma_f32_16x16x32_bf16 v[112:115], a[76:79], v[76:79], 0
  v_cvt_pk_bf16_f32 v84, v60, v61
  v_mfma_f32_16x16x32_bf16 v[116:119], a[80:83], v[76:79], 0
  v_cvt_pk_bf16_f32 v85, v62, v63
  v_mfma_f32_16x16x32_bf16 v[120:123], a[84:87], v[76:79], 0
  v_mfma_f32_16x16x32_bf16 v[124:127], a[88:91], v[76:79], 0
  v_mfma_f32_16x16x32_bf16 v[128:131], a[92:95], v[76:79], 0
  v_mfma_f32_16x16x16_bf16 v[96:99], v[88:89], v[86:87], v[96:99]
  v_mfma_f32_16x16x16_bf16 v[100:103], v[36:37], v[84:85], v[100:103]
  v_mfma_f32_16x16x16_bf16 v[104:107], v[38:39], v[84:85], v[104:107]
  v_mfma_f32_16x16x16_bf16 v[108:111], v[40:41], v[84:85], v[108:111]
  s_nop 4
  v_rcp_f32 v151, v96
  v_mfma_f32_16x16x16_bf16 v[112:115], v[42:43], v[84:85], v[112:115]
  v_mul_f32 v64, v64, v151
  v_mul_f32 v65, v65, v151
  v_mfma_f32_16x16x16_bf16 v[116:119], v[44:45], v[84:85], v[116:119]
  v_mul_f32 v66, v66, v151
  v_mul_f32 v67, v67, v151
  v_mfma_f32_16x16x16_bf16 v[120:123], v[46:47], v[84:85], v[120:123]
  v_mul_f32 v68, v68, v151
  v_mul_f32 v69, v69, v151
  v_mfma_f32_16x16x16_bf16 v[124:127], v[48:49], v[84:85], v[124:127]
  v_mul_f32 v70, v70, v151
  v_mul_f32 v71, v71, v151
  v_mfma_f32_16x16x16_bf16 v[128:131], v[50:51], v[84:85], v[128:131]
  v_cvt_pk_bf16_f32 v80, v64, v65
  v_cvt_pk_bf16_f32 v81, v66, v67
  v_cvt_pk_bf16_f32 v82, v68, v69
  v_cvt_pk_bf16_f32 v83, v70, v71
  v_cvt_pk_bf16_f32 v132, v100, v101
  v_cvt_pk_bf16_f32 v133, v102, v103
  v_mfma_f32_16x16x32_bf16 v[100:103], a[64:67], v[80:83], 0
  v_cvt_pk_bf16_f32 v134, v104, v105
  v_cvt_pk_bf16_f32 v135, v106, v107
  v_mfma_f32_16x16x32_bf16 v[104:107], a[68:71], v[80:83], 0
  buffer_store_dwordx4 v[132:135], v1, s[8:11], s78 offen offset:0 sc1
  v_cvt_pk_bf16_f32 v136, v108, v109
  v_cvt_pk_bf16_f32 v137, v110, v111
  v_mfma_f32_16x16x32_bf16 v[108:111], a[72:75], v[80:83], 0
  v_cvt_pk_bf16_f32 v138, v112, v113
  v_cvt_pk_bf16_f32 v139, v114, v115
  v_mfma_f32_16x16x32_bf16 v[112:115], a[76:79], v[80:83], 0
  v_cvt_pk_bf16_f32 v140, v116, v117
  v_cvt_pk_bf16_f32 v141, v118, v119
  v_mfma_f32_16x16x32_bf16 v[116:119], a[80:83], v[80:83], 0
  v_cvt_pk_bf16_f32 v142, v120, v121
  v_cvt_pk_bf16_f32 v143, v122, v123
  v_mfma_f32_16x16x32_bf16 v[120:123], a[84:87], v[80:83], 0
  v_cvt_pk_bf16_f32 v144, v124, v125
  v_cvt_pk_bf16_f32 v145, v126, v127
  v_mfma_f32_16x16x32_bf16 v[124:127], a[88:91], v[80:83], 0
  buffer_store_dwordx4 v[136:139], v1, s[8:11], s78 offen offset:1024 sc1
  v_cvt_pk_bf16_f32 v146, v128, v129
  v_cvt_pk_bf16_f32 v147, v130, v131
  v_mfma_f32_16x16x32_bf16 v[128:131], a[92:95], v[80:83], 0
  v_mul_f32 v72, v72, v151
  v_mul_f32 v73, v73, v151
  v_mul_f32 v74, v74, v151
  v_mul_f32 v75, v75, v151
  v_cvt_pk_bf16_f32 v86, v72, v73
  v_cvt_pk_bf16_f32 v87, v74, v75
  s_nop 1
  v_mfma_f32_16x16x16_bf16 v[100:103], v[36:37], v[86:87], v[100:103]
  v_mfma_f32_16x16x16_bf16 v[104:107], v[38:39], v[86:87], v[104:107]
  v_mfma_f32_16x16x16_bf16 v[108:111], v[40:41], v[86:87], v[108:111]
  buffer_store_dwordx4 v[140:143], v1, s[8:11], s78 offen offset:2048 sc1
  v_mfma_f32_16x16x16_bf16 v[112:115], v[42:43], v[86:87], v[112:115]
  s_nop 3
  v_cvt_pk_bf16_f32 v132, v100, v101
  v_mfma_f32_16x16x16_bf16 v[116:119], v[44:45], v[86:87], v[116:119]
  v_cvt_pk_bf16_f32 v133, v102, v103
  v_mfma_f32_16x16x16_bf16 v[120:123], v[46:47], v[86:87], v[120:123]
  v_cvt_pk_bf16_f32 v134, v104, v105
  v_mfma_f32_16x16x16_bf16 v[124:127], v[48:49], v[86:87], v[124:127]
  v_cvt_pk_bf16_f32 v135, v106, v107
  v_mfma_f32_16x16x16_bf16 v[128:131], v[50:51], v[86:87], v[128:131]
  v_cvt_pk_bf16_f32 v136, v108, v109
  v_cvt_pk_bf16_f32 v137, v110, v111
  v_cvt_pk_bf16_f32 v138, v112, v113
  buffer_store_dwordx4 v[144:147], v1, s[8:11], s78 offen offset:3072 sc1
  v_cvt_pk_bf16_f32 v139, v114, v115
  v_cvt_pk_bf16_f32 v140, v116, v117
  v_cvt_pk_bf16_f32 v141, v118, v119
  v_cvt_pk_bf16_f32 v142, v120, v121
  v_cvt_pk_bf16_f32 v143, v122, v123
  v_cvt_pk_bf16_f32 v144, v124, v125
  v_cvt_pk_bf16_f32 v145, v126, v127
  v_cvt_pk_bf16_f32 v146, v128, v129
  v_cvt_pk_bf16_f32 v147, v130, v131
  buffer_store_dwordx4 v[132:135], v1, s[8:11], s36 offen offset:0 sc1
  buffer_store_dwordx4 v[136:139], v1, s[8:11], s36 offen offset:1024 sc1
  buffer_store_dwordx4 v[140:143], v1, s[8:11], s36 offen offset:2048 sc1
  buffer_store_dwordx4 v[144:147], v1, s[8:11], s36 offen offset:3072 sc1
  s_add_u32 s73, s73, 1
  s_lshl_b32 s74, s71, 6
  s_add_u32 s74, s74, s73
  s_lshl_b32 s76, s74, 13
  s_add_u32 s76, s76, 22282240
  s_lshl_b32 s77, s74, 13
  s_add_u32 s77, s77, 23330816
  s_lshl_b32 s80, s74, 18
  s_lshl_b32 s35, s72, 13
  s_add_u32 s80, s80, s35
  s_add_u32 s80, s80, 110133248
  s_cmp_eq_u32 s93, 1
  s_cbranch_scc1 B_HAVE1G
B_KV1G:
  buffer_load_dword v5, v3, s[8:11], s76 offen sc1
  s_waitcnt vmcnt(0)
  s_mov_b64 exec, 15
  buffer_store_dword v4, v6, s[8:11], s92 offen sc1
  s_mov_b64 exec, -1
  s_mov_b32 s92, 268435456
  v_cmp_eq_u32 vcc, 0, v5
  s_nop 0
  s_cbranch_vccz B_KVO1G
  s_cmp_eq_u32 s19, 0
  s_cbranch_scc1 B_KVO1G
  s_sub_u32 s19, s19, 1
  s_sleep 1
  s_branch B_KV1G
B_KVO1G:
  s_lshl_b32 s34, s74, 18
  s_lshl_b32 s35, s72, 13
  s_add_u32 s34, s34, s35
  s_add_u32 s34, s34, 177242112
  buffer_load_dwordx4 a[96:99], v1, s[8:11], s34 offen offset:0 sc1
  buffer_load_dwordx4 a[100:103], v1, s[8:11], s34 offen offset:1024 sc1
  buffer_load_dwordx4 a[104:107], v1, s[8:11], s34 offen offset:2048 sc1
  buffer_load_dwordx4 a[108:111], v1, s[8:11], s34 offen offset:3072 sc1
  s_add_u32 s34, s34, 4096
  buffer_load_dwordx4 a[112:115], v1, s[8:11], s34 offen offset:0 sc1
  buffer_load_dwordx4 a[116:119], v1, s[8:11], s34 offen offset:1024 sc1
  buffer_load_dwordx4 a[120:123], v1, s[8:11], s34 offen offset:2048 sc1
  buffer_load_dwordx4 a[124:127], v1, s[8:11], s34 offen offset:3072 sc1
  s_lshl_b32 s34, s74, 19
  s_lshl_b32 s35, s72, 14
  s_add_u32 s34, s34, s35
  s_add_u32 s34, s34, 43024384
  buffer_load_dwordx4 a[128:131], v1, s[8:11], s34 offen offset:0 sc1
  buffer_load_dwordx4 a[144:147], v1, s[8:11], s34 offen offset:1024 sc1
  buffer_load_dwordx4 a[160:163], v1, s[8:11], s34 offen offset:2048 sc1
  buffer_load_dwordx4 a[164:167], v1, s[8:11], s34 offen offset:3072 sc1
  s_add_u32 s34, s34, 4096
  buffer_load_dwordx4 a[132:135], v1, s[8:11], s34 offen offset:0 sc1
  buffer_load_dwordx4 a[148:151], v1, s[8:11], s34 offen offset:1024 sc1
  buffer_load_dwordx4 a[168:171], v1, s[8:11], s34 offen offset:2048 sc1
  buffer_load_dwordx4 a[172:175], v1, s[8:11], s34 offen offset:3072 sc1
  s_add_u32 s34, s34, 4096
  buffer_load_dwordx4 a[136:139], v1, s[8:11], s34 offen offset:0 sc1
  buffer_load_dwordx4 a[152:155], v1, s[8:11], s34 offen offset:1024 sc1
  buffer_load_dwordx4 a[176:179], v1, s[8:11], s34 offen offset:2048 sc1
  buffer_load_dwordx4 a[180:183], v1, s[8:11], s34 offen offset:3072 sc1
  s_add_u32 s34, s34, 4096
  buffer_load_dwordx4 a[140:143], v1, s[8:11], s34 offen offset:0 sc1
  buffer_load_dwordx4 a[156:159], v1, s[8:11], s34 offen offset:1024 sc1
  buffer_load_dwordx4 a[184:187], v1, s[8:11], s34 offen offset:2048 sc1
  buffer_load_dwordx4 a[188:191], v1, s[8:11], s34 offen offset:3072 sc1
B_HAVE1G:
  s_add_u32 s36, s76, 8192
  s_cmp_lt_u32 s73, 63
  s_cselect_b32 s36, s36, 268435456
  buffer_load_dword v5, v3, s[8:11], s36 offen sc1
  buffer_load_dword v7, v3, s[8:11], s77 offen sc1
  s_waitcnt vmcnt(0)
  s_mov_b64 exec, 15
  buffer_store_dword v4, v6, s[8:11], s92 offen sc1
  s_mov_b64 exec, -1
  s_mov_b32 s92, 268435456
  v_cmp_eq_u32 vcc, 0, v7
  s_nop 0
  s_cbranch_vccz B1G_KMO
B1G_KMS:
  buffer_load_dword v7, v3, s[8:11], s77 offen sc1
  s_waitcnt vmcnt(0)
  v_cmp_eq_u32 vcc, 0, v7
  s_nop 0
  s_cbranch_vccz B1G_KMO
  s_cmp_eq_u32 s19, 0
  s_cbranch_scc1 B1G_KMO
  s_sub_u32 s19, s19, 1
  s_branch B1G_KMS
B1G_KMO:
  s_add_u32 s34, s80, 4096
  buffer_load_dwordx4 v[20:23], v1, s[8:11], s80 offen offset:0 sc1
  buffer_load_dwordx4 v[24:27], v1, s[8:11], s80 offen offset:2048 sc1
  buffer_load_dwordx4 v[28:31], v1, s[8:11], s34 offen offset:0 sc1
  buffer_load_dwordx4 v[32:35], v1, s[8:11], s34 offen offset:2048 sc1
  buffer_load_dwordx2 v[36:37], v2, s[8:11], s80 offen offset:1024 sc1
  buffer_load_dwordx2 v[38:39], v2, s[8:11], s80 offen offset:1536 sc1
  buffer_load_dwordx2 v[40:41], v2, s[8:11], s80 offen offset:3072 sc1
  buffer_load_dwordx2 v[42:43], v2, s[8:11], s80 offen offset:3584 sc1
  buffer_load_dwordx2 v[44:45], v2, s[8:11], s34 offen offset:1024 sc1
  buffer_load_dwordx2 v[46:47], v2, s[8:11], s34 offen offset:1536 sc1
  buffer_load_dwordx2 v[48:49], v2, s[8:11], s34 offen offset:3072 sc1
  buffer_load_dwordx2 v[50:51], v2, s[8:11], s34 offen offset:3584 sc1
  v_cmp_eq_u32 vcc, 0, v5
  s_nop 0
  s_cmp_eq_u64 vcc, 0
  s_cselect_b32 s93, 1, 0
  s_add_u32 s37, s74, 1
  s_lshl_b32 s82, s37, 18
  s_lshl_b32 s35, s72, 13
  s_add_u32 s82, s82, s35
  s_add_u32 s82, s82, 177242112
  s_lshl_b32 s83, s37, 19
  s_lshl_b32 s35, s72, 14
  s_add_u32 s83, s83, s35
  s_add_u32 s83, s83, 43024384
  s_cmp_eq_u32 s93, 1
  s_cselect_b32 s82, s82, 268435456
  s_cselect_b32 s83, s83, 268435456
  buffer_load_dwordx4 a[0:3], v1, s[8:11], s82 offen offset:0 sc1
  buffer_load_dwordx4 a[4:7], v1, s[8:11], s82 offen offset:1024 sc1
  buffer_load_dwordx4 a[8:11], v1, s[8:11], s82 offen offset:2048 sc1
  buffer_load_dwordx4 a[12:15], v1, s[8:11], s82 offen offset:3072 sc1
  s_add_u32 s82, s82, 4096
  buffer_load_dwordx4 a[16:19], v1, s[8:11], s82 offen offset:0 sc1
  buffer_load_dwordx4 a[20:23], v1, s[8:11], s82 offen offset:1024 sc1
  buffer_load_dwordx4 a[24:27], v1, s[8:11], s82 offen offset:2048 sc1
  buffer_load_dwordx4 a[28:31], v1, s[8:11], s82 offen offset:3072 sc1
  buffer_load_dwordx4 a[32:35], v1, s[8:11], s83 offen offset:0 sc1
  buffer_load_dwordx4 a[48:51], v1, s[8:11], s83 offen offset:1024 sc1
  buffer_load_dwordx4 a[64:67], v1, s[8:11], s83 offen offset:2048 sc1
  buffer_load_dwordx4 a[68:71], v1, s[8:11], s83 offen offset:3072 sc1
  s_add_u32 s83, s83, 4096
  buffer_load_dwordx4 a[36:39], v1, s[8:11], s83 offen offset:0 sc1
  buffer_load_dwordx4 a[52:55], v1, s[8:11], s83 offen offset:1024 sc1
  buffer_load_dwordx4 a[72:75], v1, s[8:11], s83 offen offset:2048 sc1
  buffer_load_dwordx4 a[76:79], v1, s[8:11], s83 offen offset:3072 sc1
  s_add_u32 s83, s83, 4096
  buffer_load_dwordx4 a[40:43], v1, s[8:11], s83 offen offset:0 sc1
  buffer_load_dwordx4 a[56:59], v1, s[8:11], s83 offen offset:1024 sc1
  buffer_load_dwordx4 a[80:83], v1, s[8:11], s83 offen offset:2048 sc1
  buffer_load_dwordx4 a[84:87], v1, s[8:11], s83 offen offset:3072 sc1
  s_add_u32 s83, s83, 4096
  buffer_load_dwordx4 a[44:47], v1, s[8:11], s83 offen offset:0 sc1
  buffer_load_dwordx4 a[60:63], v1, s[8:11], s83 offen offset:1024 sc1
  buffer_load_dwordx4 a[88:91], v1, s[8:11], s83 offen offset:2048 sc1
  buffer_load_dwordx4 a[92:95], v1, s[8:11], s83 offen offset:3072 sc1
  v_mfma_f32_16x16x32_bf16 v[52:55], a[128:131], a[96:99], v[8:11]
  v_mfma_f32_16x16x32_bf16 v[64:67], a[128:131], a[112:115], 0
  v_mfma_f32_16x16x32_bf16 v[68:71], a[144:147], a[112:115], v[12:15]
  v_mfma_f32_16x16x32_bf16 v[52:55], a[132:135], a[100:103], v[52:55]
  v_mfma_f32_16x16x32_bf16 v[64:67], a[132:135], a[116:119], v[64:67]
  v_mfma_f32_16x16x32_bf16 v[68:71], a[148:151], a[116:119], v[68:71]
  v_mfma_f32_16x16x32_bf16 v[52:55], a[136:139], a[104:107], v[52:55]
  v_mfma_f32_16x16x32_bf16 v[64:67], a[136:139], a[120:123], v[64:67]
  v_mfma_f32_16x16x32_bf16 v[68:71], a[152:155], a[120:123], v[68:71]
  v_mfma_f32_16x16x32_bf16 v[52:55], a[140:143], a[108:111], v[52:55]
  v_mfma_f32_16x16x32_bf16 v[64:67], a[140:143], a[124:127], v[64:67]
  v_mfma_f32_16x16x32_bf16 v[68:71], a[156:159], a[124:127], v[68:71]
  s_waitcnt vmcnt(24)
  v_mfma_f32_16x16x32_bf16 v[60:63], v[20:23], a[96:99], v[16:19]
  s_lshl_b32 s78, s74, 18
  s_nop 2
  v_max3_f32 v148, v52, v53, v54
  v_mfma_f32_16x16x32_bf16 v[60:63], v[24:27], a[100:103], v[60:63]
  s_lshl_b32 s35, s72, 13
  v_max3_f32 v150, v64, v65, v66
  v_mfma_f32_16x16x32_bf16 v[60:63], v[28:31], a[104:107], v[60:63]
  s_add_u32 s78, s78, s35
  v_max3_f32 v150, v150, v67, v68
  v_mfma_f32_16x16x32_bf16 v[60:63], v[32:35], a[108:111], v[60:63]
  s_add_u32 s78, s78, 143687680
  v_max3_f32 v150, v150, v69, v70
  v_mfma_f32_16x16x32_bf16 v[72:75], v[20:23], a[112:115], v[16:19]
  s_add_u32 s36, s78, 4096
  v_mov_b32 v88, 0x3f803f80
  v_mfma_f32_16x16x32_bf16 v[72:75], v[24:27], a[116:119], v[72:75]
  s_lshl_b32 s92, s74, 9
  v_mov_b32 v89, 0x3f803f80
  v_mfma_f32_16x16x32_bf16 v[72:75], v[28:31], a[120:123], v[72:75]
  s_add_u32 s92, s92, 24379392
  v_max3_f32 v148, v148, v55, v60
  v_mfma_f32_16x16x32_bf16 v[72:75], v[32:35], a[124:127], v[72:75]
  v_max3_f32 v148, v148, v61, v62
  v_max_f32 v148, v148, v63
  v_mov_b32 v149, v148
  v_mov_b32 v90, 0x3f803f80
  s_nop 0
  v_permlane16_swap_b32 v148, v149
  v_max_f32 v148, v148, v149
  v_mov_b32 v149, v148
  v_mov_b32 v91, 0x3f803f80
  s_nop 0
  v_permlane32_swap_b32 v148, v149
  v_max_f32 v148, v148, v149
  v_mul_f32 v148, s60, v148
  v_fma_f32 v52, v52, s60, -v148
  v_fma_f32 v53, v53, s60, -v148
  v_fma_f32 v54, v54, s60, -v148
  v_fma_f32 v55, v55, s60, -v148
  v_exp_f32 v52, v52
  v_exp_f32 v53, v53
  v_exp_f32 v54, v54
  v_exp_f32 v55, v55
  v_cvt_pk_bf16_f32 v76, v52, v53
  v_cvt_pk_bf16_f32 v77, v54, v55
  v_mov_b32 v78, 0
  v_mov_b32 v79, 0
  v_max3_f32 v150, v150, v71, v72
  s_nop 0
  v_mfma_f32_16x16x32_bf16 v[92:95], v[88:91], v[76:79], 0
  v_max3_f32 v150, v150, v73, v74
  v_max_f32 v150, v150, v75
  v_mov_b32 v151, v150
  v_fma_f32 v60, v60, s60, -v148
  v_fma_f32 v61, v61, s60, -v148
  v_fma_f32 v62, v62, s60, -v148
  v_fma_f32 v63, v63, s60, -v148
  v_exp_f32 v60, v60
  v_exp_f32 v61, v61
  v_exp_f32 v62, v62
  v_exp_f32 v63, v63
  v_permlane16_swap_b32 v150, v151
  v_max_f32 v150, v150, v151
  v_cvt_pk_bf16_f32 v84, v60, v61
  v_cvt_pk_bf16_f32 v85, v62, v63
  v_mov_b32 v151, v150
  v_mov_b32 v78, 0
  v_mfma_f32_16x16x16_bf16 v[92:95], v[88:89], v[84:85], v[92:95]
  v_permlane32_swap_b32 v150, v151
  v_max_f32 v150, v150, v151
  v_mul_f32 v150, s60, v150
  v_fma_f32 v64, v64, s60, -v150
  v_fma_f32 v65, v65, s60, -v150
  v_fma_f32 v66, v66, s60, -v150
  v_fma_f32 v67, v67, s60, -v150
  v_fma_f32 v68, v68, s60, -v150
  v_fma_f32 v69, v69, s60, -v150
  v_fma_f32 v70, v70, s60, -v150
  v_fma_f32 v71, v71, s60, -v150
  v_exp_f32 v64, v64
  v_exp_f32 v65, v65
  v_exp_f32 v66, v66
  v_exp_f32 v67, v67
  v_exp_f32 v68, v68
  v_exp_f32 v69, v69
  v_exp_f32 v70, v70
  v_exp_f32 v71, v71
  v_cvt_pk_bf16_f32 v80, v64, v65
  v_cvt_pk_bf16_f32 v81, v66, v67
  v_cvt_pk_bf16_f32 v82, v68, v69
  v_cvt_pk_bf16_f32 v83, v70, v71
  v_rcp_f32 v149, v92
  s_nop 0
  v_mfma_f32_16x16x32_bf16 v[96:99], v[88:91], v[80:83], 0
  v_fma_f32 v72, v72, s60, -v150
  v_fma_f32 v73, v73, s60, -v150
  v_fma_f32 v74, v74, s60, -v150
  v_fma_f32 v75, v75, s60, -v150
  v_mul_f32 v52, v52, v149
  v_mul_f32 v53, v53, v149
  v_mul_f32 v54, v54, v149
  v_mul_f32 v55, v55, v149
  v_cvt_pk_bf16_f32 v76, v52, v53
  v_cvt_pk_bf16_f32 v77, v54, v55
  v_exp_f32 v72, v72
  v_exp_f32 v73, v73
  v_exp_f32 v74, v74
  v_exp_f32 v75, v75
  v_mov_b32 v79, 0
  v_cvt_pk_bf16_f32 v86, v72, v73
  s_nop 0
  v_mfma_f32_16x16x32_bf16 v[100:103], a[160:163], v[76:79], 0
  v_cvt_pk_bf16_f32 v87, v74, v75
  v_mfma_f32_16x16x32_bf16 v[104:107], a[164:167], v[76:79], 0
  v_mul_f32 v60, v60, v149
  v_mul_f32 v61, v61, v149
  v_mfma_f32_16x16x32_bf16 v[108:111], a[168:171], v[76:79], 0
  v_mul_f32 v62, v62, v149
  v_mul_f32 v63, v63, v149
  v_mfma_f32_16x16x32_bf16 v[112:115], a[172:175], v[76:79], 0
  v_cvt_pk_bf16_f32 v84, v60, v61
  v_mfma_f32_16x16x32_bf16 v[116:119], a[176:179], v[76:79], 0
  v_cvt_pk_bf16_f32 v85, v62, v63
  v_mfma_f32_16x16x32_bf16 v[120:123], a[180:183], v[76:79], 0
  v_mfma_f32_16x16x32_bf16 v[124:127], a[184:187], v[76:79], 0
  v_mfma_f32_16x16x32_bf16 v[128:131], a[188:191], v[76:79], 0
  v_mfma_f32_16x16x16_bf16 v[96:99], v[88:89], v[86:87], v[96:99]
  v_mfma_f32_16x16x16_bf16 v[100:103], v[36:37], v[84:85], v[100:103]
  v_mfma_f32_16x16x16_bf16 v[104:107], v[38:39], v[84:85], v[104:107]
  v_mfma_f32_16x16x16_bf16 v[108:111], v[40:41], v[84:85], v[108:111]
  s_nop 4
  v_rcp_f32 v151, v96
  v_mfma_f32_16x16x16_bf16 v[112:115], v[42:43], v[84:85], v[112:115]
  v_mul_f32 v64, v64, v151
  v_mul_f32 v65, v65, v151
  v_mfma_f32_16x16x16_bf16 v[116:119], v[44:45], v[84:85], v[116:119]
  v_mul_f32 v66, v66, v151
  v_mul_f32 v67, v67, v151
  v_mfma_f32_16x16x16_bf16 v[120:123], v[46:47], v[84:85], v[120:123]
  v_mul_f32 v68, v68, v151
  v_mul_f32 v69, v69, v151
  v_mfma_f32_16x16x16_bf16 v[124:127], v[48:49], v[84:85], v[124:127]
  v_mul_f32 v70, v70, v151
  v_mul_f32 v71, v71, v151
  v_mfma_f32_16x16x16_bf16 v[128:131], v[50:51], v[84:85], v[128:131]
  v_cvt_pk_bf16_f32 v80, v64, v65
  v_cvt_pk_bf16_f32 v81, v66, v67
  v_cvt_pk_bf16_f32 v82, v68, v69
  v_cvt_pk_bf16_f32 v83, v70, v71
  v_cvt_pk_bf16_f32 v132, v100, v101
  v_cvt_pk_bf16_f32 v133, v102, v103
  v_mfma_f32_16x16x32_bf16 v[100:103], a[160:163], v[80:83], 0
  v_cvt_pk_bf16_f32 v134, v104, v105
  v_cvt_pk_bf16_f32 v135, v106, v107
  v_mfma_f32_16x16x32_bf16 v[104:107], a[164:167], v[80:83], 0
  buffer_store_dwordx4 v[132:135], v1, s[8:11], s78 offen offset:0 sc1
  v_cvt_pk_bf16_f32 v136, v108, v109
  v_cvt_pk_bf16_f32 v137, v110, v111
  v_mfma_f32_16x16x32_bf16 v[108:111], a[168:171], v[80:83], 0
  v_cvt_pk_bf16_f32 v138, v112, v113
  v_cvt_pk_bf16_f32 v139, v114, v115
  v_mfma_f32_16x16x32_bf16 v[112:115], a[172:175], v[80:83], 0
  v_cvt_pk_bf16_f32 v140, v116, v117
  v_cvt_pk_bf16_f32 v141, v118, v119
  v_mfma_f32_16x16x32_bf16 v[116:119], a[176:179], v[80:83], 0
  v_cvt_pk_bf16_f32 v142, v120, v121
  v_cvt_pk_bf16_f32 v143, v122, v123
  v_mfma_f32_16x16x32_bf16 v[120:123], a[180:183], v[80:83], 0
  v_cvt_pk_bf16_f32 v144, v124, v125
  v_cvt_pk_bf16_f32 v145, v126, v127
  v_mfma_f32_16x16x32_bf16 v[124:127], a[184:187], v[80:83], 0
  buffer_store_dwordx4 v[136:139], v1, s[8:11], s78 offen offset:1024 sc1
  v_cvt_pk_bf16_f32 v146, v128, v129
  v_cvt_pk_bf16_f32 v147, v130, v131
  v_mfma_f32_16x16x32_bf16 v[128:131], a[188:191], v[80:83], 0
  v_mul_f32 v72, v72, v151
  v_mul_f32 v73, v73, v151
  v_mul_f32 v74, v74, v151
  v_mul_f32 v75, v75, v151
  v_cvt_pk_bf16_f32 v86, v72, v73
  v_cvt_pk_bf16_f32 v87, v74, v75
  s_nop 1
  v_mfma_f32_16x16x16_bf16 v[100:103], v[36:37], v[86:87], v[100:103]
  v_mfma_f32_16x16x16_bf16 v[104:107], v[38:39], v[86:87], v[104:107]
  v_mfma_f32_16x16x16_bf16 v[108:111], v[40:41], v[86:87], v[108:111]
  buffer_store_dwordx4 v[140:143], v1, s[8:11], s78 offen offset:2048 sc1
  v_mfma_f32_16x16x16_bf16 v[112:115], v[42:43], v[86:87], v[112:115]
  s_nop 3
  v_cvt_pk_bf16_f32 v132, v100, v101
  v_mfma_f32_16x16x16_bf16 v[116:119], v[44:45], v[86:87], v[116:119]
  v_cvt_pk_bf16_f32 v133, v102, v103
  v_mfma_f32_16x16x16_bf16 v[120:123], v[46:47], v[86:87], v[120:123]
  v_cvt_pk_bf16_f32 v134, v104, v105
  v_mfma_f32_16x16x16_bf16 v[124:127], v[48:49], v[86:87], v[124:127]
  v_cvt_pk_bf16_f32 v135, v106, v107
  v_mfma_f32_16x16x16_bf16 v[128:131], v[50:51], v[86:87], v[128:131]
  v_cvt_pk_bf16_f32 v136, v108, v109
  v_cvt_pk_bf16_f32 v137, v110, v111
  v_cvt_pk_bf16_f32 v138, v112, v113
  buffer_store_dwordx4 v[144:147], v1, s[8:11], s78 offen offset:3072 sc1
  v_cvt_pk_bf16_f32 v139, v114, v115
  v_cvt_pk_bf16_f32 v140, v116, v117
  v_cvt_pk_bf16_f32 v141, v118, v119
  v_cvt_pk_bf16_f32 v142, v120, v121
  v_cvt_pk_bf16_f32 v143, v122, v123
  v_cvt_pk_bf16_f32 v144, v124, v125
  v_cvt_pk_bf16_f32 v145, v126, v127
  v_cvt_pk_bf16_f32 v146, v128, v129
  v_cvt_pk_bf16_f32 v147, v130, v131
  buffer_store_dwordx4 v[132:135], v1, s[8:11], s36 offen offset:0 sc1
  buffer_store_dwordx4 v[136:139], v1, s[8:11], s36 offen offset:1024 sc1
  buffer_store_dwordx4 v[140:143], v1, s[8:11], s36 offen offset:2048 sc1
  buffer_store_dwordx4 v[144:147], v1, s[8:11], s36 offen offset:3072 sc1
  s_add_u32 s73, s73, 1
  s_cmp_lt_u32 s73, 64
  s_cbranch_scc1 B_LOOPG
  s_waitcnt vmcnt(0)
  s_mov_b64 exec, 15
  buffer_store_dword v4, v6, s[8:11], s92 offen sc1
  s_mov_b64 exec, -1
  s_mov_b32 s92, 268435456
  s_endpgm
ROLE_CG:
  s_lshr_b32 s70, s17, 4
  s_lshr_b32 s71, s17, 1
  s_and_b32 s71, s71, 7
  s_and_b32 s72, s17, 1
  v_and_b32 v14, 63, v0
  v_lshlrev_b32 v1, 4, v14
  v_and_b32 v2, 15, v14
  v_lshlrev_b32 v2, 2, v2
  s_lshl_b32 s76, s71, 6
  v_add_u32 v2, s76, v2
  v_mov_b32 v3, 1
  v_and_b32 v15, 15, v14
  v_lshrrev_b32 v13, 4, v14
  v_lshlrev_b32 v5, 10, v15
  v_lshl_add_u32 v5, v13, 4, v5
  s_lshl_b32 s76, s72, 3
  s_lshl_b32 s77, s16, 1
  s_add_u32 s76, s76, s77
  s_lshl_b32 s77, s76, 6
  s_lshl_b32 s78, s71, 15
  s_add_u32 s77, s77, s78
  v_add_u32 v5, s77, v5
  s_and_b32 s77, s17, 15
  s_lshl_b32 s77, s77, 2
  s_add_u32 s77, s77, s16
  s_lshl_b32 s77, s77, 2
  v_mov_b32 v6, s77
  s_cmp_eq_u32 s70, 0
  s_cbranch_scc1 CG_NOSTAGE_34
  s_call_b64 s[100:101], VERIFY
  s_cbranch_scc1 VER_OK_36
  v_mov_b32 v0, v116
  s_waitcnt vmcnt(0) lgkmcnt(0)
  s_barrier
  s_branch DISPATCH
VER_OK_36:
  v_mbcnt_lo_u32_b32 v116, -1, 0
  v_mbcnt_hi_u32_b32 v116, -1, v116
  v_and_b32 v116, 31, v116
  v_lshlrev_b32 v116, 6, v116
  s_mov_b32 s44, 24805376
CG_GOSPIN_35:
  buffer_load_dword v117, v116, s[8:11], s44 offen sc1
  s_waitcnt vmcnt(0)
  v_cmp_eq_u32 vcc, 0, v117
  s_nop 0
  s_cbranch_vccz CG_NOSTAGE_34
  s_cmp_eq_u32 s19, 0
  s_cbranch_scc1 CG_NOSTAGE_34
  s_sub_u32 s19, s19, 1
  s_sleep 8
  s_branch CG_GOSPIN_35
CG_NOSTAGE_34:
  s_lshl_b32 s41, s16, 15
  v_lshrrev_b32 v100, 4, v14
  v_lshlrev_b32 v100, 3, v100
  v_lshrrev_b32 v102, 2, v14
  v_and_b32 v102, 3, v102
  v_add_u32 v100, v100, v102
  v_lshlrev_b32 v100, 6, v100
  v_and_b32 v102, 3, v14
  v_lshl_add_u32 v100, v102, 4, v100
  v_add_u32 v100, s41, v100
  v_lshrrev_b32 v102, 2, v14
  s_mov_b32 s40, 1024
  v_mul_lo_u32 v102, v102, s40
  v_and_b32 v101, 3, v14
  v_lshl_add_u32 v102, v101, 4, v102
  s_lshl_b32 s44, s71, 19
  s_lshl_b32 s45, s76, 6
  s_add_u32 s44, s44, s45
  s_load_dwordx2 s[42:43], s[0:1], 40
  s_waitcnt lgkmcnt(0)
  s_mov_b32 s36, s42
  s_and_b32 s37, s43, 0xffff
  s_mov_b32 s38, 4194304
  s_mov_b32 s39, 0x20000
  s_add_u32 s40, s44, 0
  s_add_u32 m0, s41, 0
  s_nop 0
  buffer_load_dwordx4 v102, s[36:39], s40 offen lds
  s_add_u32 s40, s40, 16384
  s_add_u32 m0, s41, 1024
  s_nop 0
  buffer_load_dwordx4 v102, s[36:39], s40 offen lds
  s_add_u32 s40, s44, 64
  s_add_u32 m0, s41, 2048
  s_nop 0
  buffer_load_dwordx4 v102, s[36:39], s40 offen lds
  s_add_u32 s40, s40, 16384
  s_add_u32 m0, s41, 3072
  s_nop 0
  buffer_load_dwordx4 v102, s[36:39], s40 offen lds
  s_add_u32 s40, s44, 32768
  s_add_u32 m0, s41, 4096
  s_nop 0
  buffer_load_dwordx4 v102, s[36:39], s40 offen lds
  s_add_u32 s40, s40, 16384
  s_add_u32 m0, s41, 5120
  s_nop 0
  buffer_load_dwordx4 v102, s[36:39], s40 offen lds
  s_add_u32 s40, s44, 32832
  s_add_u32 m0, s41, 6144
  s_nop 0
  buffer_load_dwordx4 v102, s[36:39], s40 offen lds
  s_add_u32 s40, s40, 16384
  s_add_u32 m0, s41, 7168
  s_nop 0
  buffer_load_dwordx4 v102, s[36:39], s40 offen lds
  s_add_u32 s40, s44, 65536
  s_add_u32 m0, s41, 8192
  s_nop 0
  buffer_load_dwordx4 v102, s[36:39], s40 offen lds
  s_add_u32 s40, s40, 16384
  s_add_u32 m0, s41, 9216
  s_nop 0
  buffer_load_dwordx4 v102, s[36:39], s40 offen lds
  s_add_u32 s40, s44, 65600
  s_add_u32 m0, s41, 10240
  s_nop 0
  buffer_load_dwordx4 v102, s[36:39], s40 offen lds
  s_add_u32 s40, s40, 16384
  s_add_u32 m0, s41, 11264
  s_nop 0
  buffer_load_dwordx4 v102, s[36:39], s40 offen lds
  s_add_u32 s40, s44, 98304
  s_add_u32 m0, s41, 12288
  s_nop 0
  buffer_load_dwordx4 v102, s[36:39], s40 offen lds
  s_add_u32 s40, s40, 16384
  s_add_u32 m0, s41, 13312
  s_nop 0
  buffer_load_dwordx4 v102, s[36:39], s40 offen lds
  s_add_u32 s40, s44, 98368
  s_add_u32 m0, s41, 14336
  s_nop 0
  buffer_load_dwordx4 v102, s[36:39], s40 offen lds
  s_add_u32 s40, s40, 16384
  s_add_u32 m0, s41, 15360
  s_nop 0
  buffer_load_dwordx4 v102, s[36:39], s40 offen lds
  s_add_u32 s40, s44, 131072
  s_add_u32 m0, s41, 16384
  s_nop 0
  buffer_load_dwordx4 v102, s[36:39], s40 offen lds
  s_add_u32 s40, s40, 16384
  s_add_u32 m0, s41, 17408
  s_nop 0
  buffer_load_dwordx4 v102, s[36:39], s40 offen lds
  s_add_u32 s40, s44, 131136
  s_add_u32 m0, s41, 18432
  s_nop 0
  buffer_load_dwordx4 v102, s[36:39], s40 offen lds
  s_add_u32 s40, s40, 16384
  s_add_u32 m0, s41, 19456
  s_nop 0
  buffer_load_dwordx4 v102, s[36:39], s40 offen lds
  s_add_u32 s40, s44, 163840
  s_add_u32 m0, s41, 20480
  s_nop 0
  buffer_load_dwordx4 v102, s[36:39], s40 offen lds
  s_add_u32 s40, s40, 16384
  s_add_u32 m0, s41, 21504
  s_nop 0
  buffer_load_dwordx4 v102, s[36:39], s40 offen lds
  s_add_u32 s40, s44, 163904
  s_add_u32 m0, s41, 22528
  s_nop 0
  buffer_load_dwordx4 v102, s[36:39], s40 offen lds
  s_add_u32 s40, s40, 16384
  s_add_u32 m0, s41, 23552
  s_nop 0
  buffer_load_dwordx4 v102, s[36:39], s40 offen lds
  s_add_u32 s40, s44, 196608
  s_add_u32 m0, s41, 24576
  s_nop 0
  buffer_load_dwordx4 v102, s[36:39], s40 offen lds
  s_add_u32 s40, s40, 16384
  s_add_u32 m0, s41, 25600
  s_nop 0
  buffer_load_dwordx4 v102, s[36:39], s40 offen lds
  s_add_u32 s40, s44, 196672
  s_add_u32 m0, s41, 26624
  s_nop 0
  buffer_load_dwordx4 v102, s[36:39], s40 offen lds
  s_add_u32 s40, s40, 16384
  s_add_u32 m0, s41, 27648
  s_nop 0
  buffer_load_dwordx4 v102, s[36:39], s40 offen lds
  s_add_u32 s40, s44, 229376
  s_add_u32 m0, s41, 28672
  s_nop 0
  buffer_load_dwordx4 v102, s[36:39], s40 offen lds
  s_add_u32 s40, s40, 16384
  s_add_u32 m0, s41, 29696
  s_nop 0
  buffer_load_dwordx4 v102, s[36:39], s40 offen lds
  s_add_u32 s40, s44, 229440
  s_add_u32 m0, s41, 30720
  s_nop 0
  buffer_load_dwordx4 v102, s[36:39], s40 offen lds
  s_add_u32 s40, s40, 16384
  s_add_u32 m0, s41, 31744
  s_nop 0
  buffer_load_dwordx4 v102, s[36:39], s40 offen lds
  s_waitcnt vmcnt(16)
  ds_read_b64_tr_b16 a[0:1], v100 offset:0
  ds_read_b64_tr_b16 a[2:3], v100 offset:256
  ds_read_b64_tr_b16 a[64:65], v100 offset:8
  ds_read_b64_tr_b16 a[66:67], v100 offset:264
  ds_read_b64_tr_b16 a[128:129], v100 offset:2048
  ds_read_b64_tr_b16 a[130:131], v100 offset:2304
  ds_read_b64_tr_b16 a[192:193], v100 offset:2056
  ds_read_b64_tr_b16 a[194:195], v100 offset:2312
  s_waitcnt lgkmcnt(4)
  ds_read_b64_tr_b16 a[4:5], v100 offset:4096
  ds_read_b64_tr_b16 a[6:7], v100 offset:4352
  ds_read_b64_tr_b16 a[68:69], v100 offset:4104
  ds_read_b64_tr_b16 a[70:71], v100 offset:4360
  ds_read_b64_tr_b16 a[132:133], v100 offset:6144
  ds_read_b64_tr_b16 a[134:135], v100 offset:6400
  ds_read_b64_tr_b16 a[196:197], v100 offset:6152
  ds_read_b64_tr_b16 a[198:199], v100 offset:6408
  s_waitcnt lgkmcnt(4)
  ds_read_b64_tr_b16 a[8:9], v100 offset:8192
  ds_read_b64_tr_b16 a[10:11], v100 offset:8448
  ds_read_b64_tr_b16 a[72:73], v100 offset:8200
  ds_read_b64_tr_b16 a[74:75], v100 offset:8456
  ds_read_b64_tr_b16 a[136:137], v100 offset:10240
  ds_read_b64_tr_b16 a[138:139], v100 offset:10496
  ds_read_b64_tr_b16 a[200:201], v100 offset:10248
  ds_read_b64_tr_b16 a[202:203], v100 offset:10504
  s_waitcnt lgkmcnt(4)
  ds_read_b64_tr_b16 a[12:13], v100 offset:12288
  ds_read_b64_tr_b16 a[14:15], v100 offset:12544
  ds_read_b64_tr_b16 a[76:77], v100 offset:12296
  ds_read_b64_tr_b16 a[78:79], v100 offset:12552
  ds_read_b64_tr_b16 a[140:141], v100 offset:14336
  ds_read_b64_tr_b16 a[142:143], v100 offset:14592
  ds_read_b64_tr_b16 a[204:205], v100 offset:14344
  ds_read_b64_tr_b16 a[206:207], v100 offset:14600
  s_waitcnt lgkmcnt(4)
  s_waitcnt lgkmcnt(0)
  s_add_u32 s40, s44, 262144
  s_add_u32 m0, s41, 0
  s_nop 0
  buffer_load_dwordx4 v102, s[36:39], s40 offen lds
  s_add_u32 s40, s40, 16384
  s_add_u32 m0, s41, 1024
  s_nop 0
  buffer_load_dwordx4 v102, s[36:39], s40 offen lds
  s_add_u32 s40, s44, 262208
  s_add_u32 m0, s41, 2048
  s_nop 0
  buffer_load_dwordx4 v102, s[36:39], s40 offen lds
  s_add_u32 s40, s40, 16384
  s_add_u32 m0, s41, 3072
  s_nop 0
  buffer_load_dwordx4 v102, s[36:39], s40 offen lds
  s_add_u32 s40, s44, 294912
  s_add_u32 m0, s41, 4096
  s_nop 0
  buffer_load_dwordx4 v102, s[36:39], s40 offen lds
  s_add_u32 s40, s40, 16384
  s_add_u32 m0, s41, 5120
  s_nop 0
  buffer_load_dwordx4 v102, s[36:39], s40 offen lds
  s_add_u32 s40, s44, 294976
  s_add_u32 m0, s41, 6144
  s_nop 0
  buffer_load_dwordx4 v102, s[36:39], s40 offen lds
  s_add_u32 s40, s40, 16384
  s_add_u32 m0, s41, 7168
  s_nop 0
  buffer_load_dwordx4 v102, s[36:39], s40 offen lds
  s_add_u32 s40, s44, 327680
  s_add_u32 m0, s41, 8192
  s_nop 0
  buffer_load_dwordx4 v102, s[36:39], s40 offen lds
  s_add_u32 s40, s40, 16384
  s_add_u32 m0, s41, 9216
  s_nop 0
  buffer_load_dwordx4 v102, s[36:39], s40 offen lds
  s_add_u32 s40, s44, 327744
  s_add_u32 m0, s41, 10240
  s_nop 0
  buffer_load_dwordx4 v102, s[36:39], s40 offen lds
  s_add_u32 s40, s40, 16384
  s_add_u32 m0, s41, 11264
  s_nop 0
  buffer_load_dwordx4 v102, s[36:39], s40 offen lds
  s_add_u32 s40, s44, 360448
  s_add_u32 m0, s41, 12288
  s_nop 0
  buffer_load_dwordx4 v102, s[36:39], s40 offen lds
  s_add_u32 s40, s40, 16384
  s_add_u32 m0, s41, 13312
  s_nop 0
  buffer_load_dwordx4 v102, s[36:39], s40 offen lds
  s_add_u32 s40, s44, 360512
  s_add_u32 m0, s41, 14336
  s_nop 0
  buffer_load_dwordx4 v102, s[36:39], s40 offen lds
  s_add_u32 s40, s40, 16384
  s_add_u32 m0, s41, 15360
  s_nop 0
  buffer_load_dwordx4 v102, s[36:39], s40 offen lds
  s_waitcnt vmcnt(16)
  ds_read_b64_tr_b16 a[16:17], v100 offset:16384
  ds_read_b64_tr_b16 a[18:19], v100 offset:16640
  ds_read_b64_tr_b16 a[80:81], v100 offset:16392
  ds_read_b64_tr_b16 a[82:83], v100 offset:16648
  ds_read_b64_tr_b16 a[144:145], v100 offset:18432
  ds_read_b64_tr_b16 a[146:147], v100 offset:18688
  ds_read_b64_tr_b16 a[208:209], v100 offset:18440
  ds_read_b64_tr_b16 a[210:211], v100 offset:18696
  s_waitcnt lgkmcnt(4)
  ds_read_b64_tr_b16 a[20:21], v100 offset:20480
  ds_read_b64_tr_b16 a[22:23], v100 offset:20736
  ds_read_b64_tr_b16 a[84:85], v100 offset:20488
  ds_read_b64_tr_b16 a[86:87], v100 offset:20744
  ds_read_b64_tr_b16 a[148:149], v100 offset:22528
  ds_read_b64_tr_b16 a[150:151], v100 offset:22784
  ds_read_b64_tr_b16 a[212:213], v100 offset:22536
  ds_read_b64_tr_b16 a[214:215], v100 offset:22792
  s_waitcnt lgkmcnt(4)
  ds_read_b64_tr_b16 a[24:25], v100 offset:24576
  ds_read_b64_tr_b16 a[26:27], v100 offset:24832
  ds_read_b64_tr_b16 a[88:89], v100 offset:24584
  ds_read_b64_tr_b16 a[90:91], v100 offset:24840
  ds_read_b64_tr_b16 a[152:153], v100 offset:26624
  ds_read_b64_tr_b16 a[154:155], v100 offset:26880
  ds_read_b64_tr_b16 a[216:217], v100 offset:26632
  ds_read_b64_tr_b16 a[218:219], v100 offset:26888
  s_waitcnt lgkmcnt(4)
  ds_read_b64_tr_b16 a[28:29], v100 offset:28672
  ds_read_b64_tr_b16 a[30:31], v100 offset:28928
  ds_read_b64_tr_b16 a[92:93], v100 offset:28680
  ds_read_b64_tr_b16 a[94:95], v100 offset:28936
  ds_read_b64_tr_b16 a[156:157], v100 offset:30720
  ds_read_b64_tr_b16 a[158:159], v100 offset:30976
  ds_read_b64_tr_b16 a[220:221], v100 offset:30728
  ds_read_b64_tr_b16 a[222:223], v100 offset:30984
  s_waitcnt lgkmcnt(4)
  s_waitcnt lgkmcnt(0)
  s_add_u32 s40, s44, 393216
  s_add_u32 m0, s41, 16384
  s_nop 0
  buffer_load_dwordx4 v102, s[36:39], s40 offen lds
  s_add_u32 s40, s40, 16384
  s_add_u32 m0, s41, 17408
  s_nop 0
  buffer_load_dwordx4 v102, s[36:39], s40 offen lds
  s_add_u32 s40, s44, 393280
  s_add_u32 m0, s41, 18432
  s_nop 0
  buffer_load_dwordx4 v102, s[36:39], s40 offen lds
  s_add_u32 s40, s40, 16384
  s_add_u32 m0, s41, 19456
  s_nop 0
  buffer_load_dwordx4 v102, s[36:39], s40 offen lds
  s_add_u32 s40, s44, 425984
  s_add_u32 m0, s41, 20480
  s_nop 0
  buffer_load_dwordx4 v102, s[36:39], s40 offen lds
  s_add_u32 s40, s40, 16384
  s_add_u32 m0, s41, 21504
  s_nop 0
  buffer_load_dwordx4 v102, s[36:39], s40 offen lds
  s_add_u32 s40, s44, 426048
  s_add_u32 m0, s41, 22528
  s_nop 0
  buffer_load_dwordx4 v102, s[36:39], s40 offen lds
  s_add_u32 s40, s40, 16384
  s_add_u32 m0, s41, 23552
  s_nop 0
  buffer_load_dwordx4 v102, s[36:39], s40 offen lds
  s_add_u32 s40, s44, 458752
  s_add_u32 m0, s41, 24576
  s_nop 0
  buffer_load_dwordx4 v102, s[36:39], s40 offen lds
  s_add_u32 s40, s40, 16384
  s_add_u32 m0, s41, 25600
  s_nop 0
  buffer_load_dwordx4 v102, s[36:39], s40 offen lds
  s_add_u32 s40, s44, 458816
  s_add_u32 m0, s41, 26624
  s_nop 0
  buffer_load_dwordx4 v102, s[36:39], s40 offen lds
  s_add_u32 s40, s40, 16384
  s_add_u32 m0, s41, 27648
  s_nop 0
  buffer_load_dwordx4 v102, s[36:39], s40 offen lds
  s_add_u32 s40, s44, 491520
  s_add_u32 m0, s41, 28672
  s_nop 0
  buffer_load_dwordx4 v102, s[36:39], s40 offen lds
  s_add_u32 s40, s40, 16384
  s_add_u32 m0, s41, 29696
  s_nop 0
  buffer_load_dwordx4 v102, s[36:39], s40 offen lds
  s_add_u32 s40, s44, 491584
  s_add_u32 m0, s41, 30720
  s_nop 0
  buffer_load_dwordx4 v102, s[36:39], s40 offen lds
  s_add_u32 s40, s40, 16384
  s_add_u32 m0, s41, 31744
  s_nop 0
  buffer_load_dwordx4 v102, s[36:39], s40 offen lds
  s_waitcnt vmcnt(16)
  ds_read_b64_tr_b16 a[32:33], v100 offset:0
  ds_read_b64_tr_b16 a[34:35], v100 offset:256
  ds_read_b64_tr_b16 a[96:97], v100 offset:8
  ds_read_b64_tr_b16 a[98:99], v100 offset:264
  ds_read_b64_tr_b16 a[160:161], v100 offset:2048
  ds_read_b64_tr_b16 a[162:163], v100 offset:2304
  ds_read_b64_tr_b16 a[224:225], v100 offset:2056
  ds_read_b64_tr_b16 a[226:227], v100 offset:2312
  s_waitcnt lgkmcnt(4)
  ds_read_b64_tr_b16 a[36:37], v100 offset:4096
  ds_read_b64_tr_b16 a[38:39], v100 offset:4352
  ds_read_b64_tr_b16 a[100:101], v100 offset:4104
  ds_read_b64_tr_b16 a[102:103], v100 offset:4360
  ds_read_b64_tr_b16 a[164:165], v100 offset:6144
  ds_read_b64_tr_b16 a[166:167], v100 offset:6400
  ds_read_b64_tr_b16 a[228:229], v100 offset:6152
  ds_read_b64_tr_b16 a[230:231], v100 offset:6408
  s_waitcnt lgkmcnt(4)
  ds_read_b64_tr_b16 a[40:41], v100 offset:8192
  ds_read_b64_tr_b16 a[42:43], v100 offset:8448
  ds_read_b64_tr_b16 a[104:105], v100 offset:8200
  ds_read_b64_tr_b16 a[106:107], v100 offset:8456
  ds_read_b64_tr_b16 a[168:169], v100 offset:10240
  ds_read_b64_tr_b16 a[170:171], v100 offset:10496
  ds_read_b64_tr_b16 a[232:233], v100 offset:10248
  ds_read_b64_tr_b16 a[234:235], v100 offset:10504
  s_waitcnt lgkmcnt(4)
  ds_read_b64_tr_b16 a[44:45], v100 offset:12288
  ds_read_b64_tr_b16 a[46:47], v100 offset:12544
  ds_read_b64_tr_b16 a[108:109], v100 offset:12296
  ds_read_b64_tr_b16 a[110:111], v100 offset:12552
  ds_read_b64_tr_b16 a[172:173], v100 offset:14336
  ds_read_b64_tr_b16 a[174:175], v100 offset:14592
  ds_read_b64_tr_b16 a[236:237], v100 offset:14344
  ds_read_b64_tr_b16 a[238:239], v100 offset:14600
  s_waitcnt lgkmcnt(4)
  s_waitcnt lgkmcnt(0)
  s_waitcnt vmcnt(0)
  ds_read_b64_tr_b16 a[48:49], v100 offset:16384
  ds_read_b64_tr_b16 a[50:51], v100 offset:16640
  ds_read_b64_tr_b16 a[112:113], v100 offset:16392
  ds_read_b64_tr_b16 a[114:115], v100 offset:16648
  ds_read_b64_tr_b16 a[176:177], v100 offset:18432
  ds_read_b64_tr_b16 a[178:179], v100 offset:18688
  ds_read_b64_tr_b16 a[240:241], v100 offset:18440
  ds_read_b64_tr_b16 a[242:243], v100 offset:18696
  s_waitcnt lgkmcnt(4)
  ds_read_b64_tr_b16 a[52:53], v100 offset:20480
  ds_read_b64_tr_b16 a[54:55], v100 offset:20736
  ds_read_b64_tr_b16 a[116:117], v100 offset:20488
  ds_read_b64_tr_b16 a[118:119], v100 offset:20744
  ds_read_b64_tr_b16 a[180:181], v100 offset:22528
  ds_read_b64_tr_b16 a[182:183], v100 offset:22784
  ds_read_b64_tr_b16 a[244:245], v100 offset:22536
  ds_read_b64_tr_b16 a[246:247], v100 offset:22792
  s_waitcnt lgkmcnt(4)
  ds_read_b64_tr_b16 a[56:57], v100 offset:24576
  ds_read_b64_tr_b16 a[58:59], v100 offset:24832
  ds_read_b64_tr_b16 a[120:121], v100 offset:24584
  ds_read_b64_tr_b16 a[122:123], v100 offset:24840
  ds_read_b64_tr_b16 a[184:185], v100 offset:26624
  ds_read_b64_tr_b16 a[186:187], v100 offset:26880
  ds_read_b64_tr_b16 a[248:249], v100 offset:26632
  ds_read_b64_tr_b16 a[250:251], v100 offset:26888
  s_waitcnt lgkmcnt(4)
  ds_read_b64_tr_b16 a[60:61], v100 offset:28672
  ds_read_b64_tr_b16 a[62:63], v100 offset:28928
  ds_read_b64_tr_b16 a[124:125], v100 offset:28680
  ds_read_b64_tr_b16 a[126:127], v100 offset:28936
  ds_read_b64_tr_b16 a[188:189], v100 offset:30720
  ds_read_b64_tr_b16 a[190:191], v100 offset:30976
  ds_read_b64_tr_b16 a[252:253], v100 offset:30728
  ds_read_b64_tr_b16 a[254:255], v100 offset:30984
  s_waitcnt lgkmcnt(4)
  s_waitcnt lgkmcnt(0)
  s_call_b64 s[100:101], VERIFY
  s_cbranch_scc1 VER_OK_37
  v_mov_b32 v0, v116
  s_waitcnt vmcnt(0) lgkmcnt(0)
  s_barrier
  s_branch DISPATCH
VER_OK_37:
  s_barrier
  s_mov_b32 s73, 0
  s_mov_b32 s93, 0
  s_mov_b32 s92, 268435456
  s_mov_b32 s86, 0
C_LOOPG:
  s_lshl_b32 s74, s70, 6
  s_add_u32 s74, s74, s73
  s_lshl_b32 s84, s74, 9
  s_add_u32 s84, s84, 24379392
  s_add_u32 s85, s84, 512
  s_cmp_lt_u32 s73, 63
  s_cselect_b32 s85, s85, 268435456
  s_cmp_eq_u32 s93, 1
  s_cbranch_scc1 CG_HAVE_38
CG_W_SPIN_40:
  buffer_load_dword v4, v2, s[8:11], s84 offen sc1
  s_waitcnt vmcnt(0)
  s_mov_b64 exec, 1
  buffer_store_dword v3, v6, s[8:11], s92 offen sc1
  s_mov_b64 exec, -1
  s_mov_b32 s92, 268435456
  v_cmp_eq_u32 vcc, 0, v4
  s_nop 0
  s_cbranch_vccz CG_W_OK_41
  s_cmp_eq_u32 s19, 0
  s_cbranch_scc1 CG_W_OK_41
  s_sub_u32 s19, s19, 1
  s_sleep 1
  s_branch CG_W_SPIN_40
CG_W_OK_41:
  s_add_u32 s76, s74, 0
  s_lshl_b32 s76, s76, 18
  s_lshl_b32 s77, s71, 15
  s_add_u32 s76, s76, s77
  s_add_u32 s76, s76, 143687680
  s_lshl_b32 s77, s16, 13
  s_add_u32 s76, s76, s77
  s_xor_b32 s78, s86, 0
  s_add_u32 s77, s77, s78
  s_add_u32 m0, s77, 0
  s_nop 0
  buffer_load_dwordx4 v1, s[8:11], s76 offen offset:0 sc1 lds
  s_add_u32 m0, s77, 0
  s_nop 0
  buffer_load_dwordx4 v1, s[8:11], s76 offen offset:1024 sc1 lds
  s_add_u32 m0, s77, 0
  s_nop 0
  buffer_load_dwordx4 v1, s[8:11], s76 offen offset:2048 sc1 lds
  s_add_u32 m0, s77, 0
  s_nop 0
  buffer_load_dwordx4 v1, s[8:11], s76 offen offset:3072 sc1 lds
  s_add_u32 m0, s77, 4096
  s_add_u32 s76, s76, 4096
  buffer_load_dwordx4 v1, s[8:11], s76 offen offset:0 sc1 lds
  s_add_u32 m0, s77, 4096
  s_nop 0
  buffer_load_dwordx4 v1, s[8:11], s76 offen offset:1024 sc1 lds
  s_add_u32 m0, s77, 4096
  s_nop 0
  buffer_load_dwordx4 v1, s[8:11], s76 offen offset:2048 sc1 lds
  s_add_u32 m0, s77, 4096
  s_nop 0
  buffer_load_dwordx4 v1, s[8:11], s76 offen offset:3072 sc1 lds
  s_waitcnt vmcnt(0)
  s_branch CG_GO_39
CG_HAVE_38:
  s_waitcnt vmcnt(4)
CG_GO_39:
  buffer_load_dword v4, v2, s[8:11], s85 offen sc1
  s_waitcnt lgkmcnt(0)
  s_barrier
  v_add_u32 v7, s86, v1
  ds_read_b128 v[48:51], v7 offset:0
  ds_read_b128 v[52:55], v7 offset:1024
  ds_read_b128 v[56:59], v7 offset:2048
  ds_read_b128 v[60:63], v7 offset:3072
  ds_read_b128 v[64:67], v7 offset:8192
  ds_read_b128 v[68:71], v7 offset:9216
  ds_read_b128 v[72:75], v7 offset:10240
  ds_read_b128 v[76:79], v7 offset:11264
  s_waitcnt lgkmcnt(7)
  v_mfma_f32_16x16x32_bf16 v[16:19], a[0:3], v[48:51], 0
  v_mfma_f32_16x16x32_bf16 v[20:23], a[64:67], v[48:51], 0
  v_mfma_f32_16x16x32_bf16 v[24:27], a[128:131], v[48:51], 0
  v_mfma_f32_16x16x32_bf16 v[28:31], a[192:195], v[48:51], 0
  ds_read_b128 v[48:51], v7 offset:16384
  s_waitcnt lgkmcnt(7)
  v_mfma_f32_16x16x32_bf16 v[16:19], a[4:7], v[52:55], v[16:19]
  v_mfma_f32_16x16x32_bf16 v[20:23], a[68:71], v[52:55], v[20:23]
  v_mfma_f32_16x16x32_bf16 v[24:27], a[132:135], v[52:55], v[24:27]
  v_mfma_f32_16x16x32_bf16 v[28:31], a[196:199], v[52:55], v[28:31]
  ds_read_b128 v[52:55], v7 offset:17408
  s_waitcnt lgkmcnt(7)
  v_mfma_f32_16x16x32_bf16 v[16:19], a[8:11], v[56:59], v[16:19]
  v_mfma_f32_16x16x32_bf16 v[20:23], a[72:75], v[56:59], v[20:23]
  v_mfma_f32_16x16x32_bf16 v[24:27], a[136:139], v[56:59], v[24:27]
  v_mfma_f32_16x16x32_bf16 v[28:31], a[200:203], v[56:59], v[28:31]
  ds_read_b128 v[56:59], v7 offset:18432
  s_waitcnt lgkmcnt(7)
  v_mfma_f32_16x16x32_bf16 v[16:19], a[12:15], v[60:63], v[16:19]
  v_mfma_f32_16x16x32_bf16 v[20:23], a[76:79], v[60:63], v[20:23]
  v_mfma_f32_16x16x32_bf16 v[24:27], a[140:143], v[60:63], v[24:27]
  v_mfma_f32_16x16x32_bf16 v[28:31], a[204:207], v[60:63], v[28:31]
  ds_read_b128 v[60:63], v7 offset:19456
  s_waitcnt lgkmcnt(7)
  v_mfma_f32_16x16x32_bf16 v[16:19], a[16:19], v[64:67], v[16:19]
  v_mfma_f32_16x16x32_bf16 v[20:23], a[80:83], v[64:67], v[20:23]
  v_mfma_f32_16x16x32_bf16 v[24:27], a[144:147], v[64:67], v[24:27]
  v_mfma_f32_16x16x32_bf16 v[28:31], a[208:211], v[64:67], v[28:31]
  ds_read_b128 v[64:67], v7 offset:24576
  s_waitcnt lgkmcnt(7)
  v_mfma_f32_16x16x32_bf16 v[16:19], a[20:23], v[68:71], v[16:19]
  v_mfma_f32_16x16x32_bf16 v[20:23], a[84:87], v[68:71], v[20:23]
  v_mfma_f32_16x16x32_bf16 v[24:27], a[148:151], v[68:71], v[24:27]
  v_mfma_f32_16x16x32_bf16 v[28:31], a[212:215], v[68:71], v[28:31]
  ds_read_b128 v[68:71], v7 offset:25600
  s_waitcnt lgkmcnt(7)
  v_mfma_f32_16x16x32_bf16 v[16:19], a[24:27], v[72:75], v[16:19]
  v_mfma_f32_16x16x32_bf16 v[20:23], a[88:91], v[72:75], v[20:23]
  v_mfma_f32_16x16x32_bf16 v[24:27], a[152:155], v[72:75], v[24:27]
  v_mfma_f32_16x16x32_bf16 v[28:31], a[216:219], v[72:75], v[28:31]
  ds_read_b128 v[72:75], v7 offset:26624
  s_waitcnt lgkmcnt(7)
  v_mfma_f32_16x16x32_bf16 v[16:19], a[28:31], v[76:79], v[16:19]
  v_mfma_f32_16x16x32_bf16 v[20:23], a[92:95], v[76:79], v[20:23]
  v_mfma_f32_16x16x32_bf16 v[24:27], a[156:159], v[76:79], v[24:27]
  v_mfma_f32_16x16x32_bf16 v[28:31], a[220:223], v[76:79], v[28:31]
  ds_read_b128 v[76:79], v7 offset:27648
  s_waitcnt lgkmcnt(7)
  v_mfma_f32_16x16x32_bf16 v[16:19], a[32:35], v[48:51], v[16:19]
  v_mfma_f32_16x16x32_bf16 v[20:23], a[96:99], v[48:51], v[20:23]
  v_mfma_f32_16x16x32_bf16 v[24:27], a[160:163], v[48:51], v[24:27]
  v_mfma_f32_16x16x32_bf16 v[28:31], a[224:227], v[48:51], v[28:31]
  ds_read_b128 v[48:51], v7 offset:4096
  s_waitcnt lgkmcnt(7)
  v_mfma_f32_16x16x32_bf16 v[16:19], a[36:39], v[52:55], v[16:19]
  v_mfma_f32_16x16x32_bf16 v[20:23], a[100:103], v[52:55], v[20:23]
  v_mfma_f32_16x16x32_bf16 v[24:27], a[164:167], v[52:55], v[24:27]
  v_mfma_f32_16x16x32_bf16 v[28:31], a[228:231], v[52:55], v[28:31]
  ds_read_b128 v[52:55], v7 offset:5120
  s_waitcnt lgkmcnt(7)
  v_mfma_f32_16x16x32_bf16 v[16:19], a[40:43], v[56:59], v[16:19]
  v_mfma_f32_16x16x32_bf16 v[20:23], a[104:107], v[56:59], v[20:23]
  v_mfma_f32_16x16x32_bf16 v[24:27], a[168:171], v[56:59], v[24:27]
  v_mfma_f32_16x16x32_bf16 v[28:31], a[232:235], v[56:59], v[28:31]
  ds_read_b128 v[56:59], v7 offset:6144
  s_waitcnt lgkmcnt(7)
  v_mfma_f32_16x16x32_bf16 v[16:19], a[44:47], v[60:63], v[16:19]
  v_mfma_f32_16x16x32_bf16 v[20:23], a[108:111], v[60:63], v[20:23]
  v_mfma_f32_16x16x32_bf16 v[24:27], a[172:175], v[60:63], v[24:27]
  v_mfma_f32_16x16x32_bf16 v[28:31], a[236:239], v[60:63], v[28:31]
  ds_read_b128 v[60:63], v7 offset:7168
  s_waitcnt lgkmcnt(7)
  v_mfma_f32_16x16x32_bf16 v[16:19], a[48:51], v[64:67], v[16:19]
  v_mfma_f32_16x16x32_bf16 v[20:23], a[112:115], v[64:67], v[20:23]
  v_mfma_f32_16x16x32_bf16 v[24:27], a[176:179], v[64:67], v[24:27]
  v_mfma_f32_16x16x32_bf16 v[28:31], a[240:243], v[64:67], v[28:31]
  ds_read_b128 v[64:67], v7 offset:12288
  s_waitcnt lgkmcnt(7)
  v_mfma_f32_16x16x32_bf16 v[16:19], a[52:55], v[68:71], v[16:19]
  v_mfma_f32_16x16x32_bf16 v[20:23], a[116:119], v[68:71], v[20:23]
  v_mfma_f32_16x16x32_bf16 v[24:27], a[180:183], v[68:71], v[24:27]
  v_mfma_f32_16x16x32_bf16 v[28:31], a[244:247], v[68:71], v[28:31]
  ds_read_b128 v[68:71], v7 offset:13312
  s_waitcnt vmcnt(0)
  s_mov_b64 exec, 1
  buffer_store_dword v3, v6, s[8:11], s92 offen sc1
  s_mov_b64 exec, -1
  s_mov_b32 s92, 268435456
  v_cmp_eq_u32 vcc, 0, v4
  s_mov_b32 s93, 0
  s_cbranch_vccnz CG_NOPF_42
  s_mov_b32 s93, 1
  s_add_u32 s76, s74, 1
  s_lshl_b32 s76, s76, 18
  s_lshl_b32 s77, s71, 15
  s_add_u32 s76, s76, s77
  s_add_u32 s76, s76, 143687680
  s_lshl_b32 s77, s16, 13
  s_add_u32 s76, s76, s77
  s_xor_b32 s78, s86, 32768
  s_add_u32 s77, s77, s78
  s_add_u32 m0, s77, 0
  s_nop 0
  buffer_load_dwordx4 v1, s[8:11], s76 offen offset:0 sc1 lds
  s_add_u32 m0, s77, 0
  s_nop 0
  buffer_load_dwordx4 v1, s[8:11], s76 offen offset:1024 sc1 lds
  s_add_u32 m0, s77, 0
  s_nop 0
  buffer_load_dwordx4 v1, s[8:11], s76 offen offset:2048 sc1 lds
  s_add_u32 m0, s77, 0
  s_nop 0
  buffer_load_dwordx4 v1, s[8:11], s76 offen offset:3072 sc1 lds
  s_add_u32 m0, s77, 4096
  s_add_u32 s76, s76, 4096
  buffer_load_dwordx4 v1, s[8:11], s76 offen offset:0 sc1 lds
  s_add_u32 m0, s77, 4096
  s_nop 0
  buffer_load_dwordx4 v1, s[8:11], s76 offen offset:1024 sc1 lds
  s_add_u32 m0, s77, 4096
  s_nop 0
  buffer_load_dwordx4 v1, s[8:11], s76 offen offset:2048 sc1 lds
  s_add_u32 m0, s77, 4096
  s_nop 0
  buffer_load_dwordx4 v1, s[8:11], s76 offen offset:3072 sc1 lds
CG_NOPF_42:
  s_waitcnt lgkmcnt(7)
  v_mfma_f32_16x16x32_bf16 v[16:19], a[56:59], v[72:75], v[16:19]
  s_lshl_b32 s76, s74, 18
  s_add_u32 s76, s76, 177242112
  s_add_u32 s77, s76, 16384
  v_mfma_f32_16x16x32_bf16 v[20:23], a[120:123], v[72:75], v[20:23]
  s_lshl_b32 s92, s74, 8
  s_add_u32 s92, s92, 24444928
  v_mfma_f32_16x16x32_bf16 v[24:27], a[184:187], v[72:75], v[24:27]
  v_mfma_f32_16x16x32_bf16 v[28:31], a[248:251], v[72:75], v[28:31]
  ds_read_b128 v[72:75], v7 offset:14336
  s_waitcnt lgkmcnt(7)
  v_mfma_f32_16x16x32_bf16 v[16:19], a[60:63], v[76:79], v[16:19]
  v_mfma_f32_16x16x32_bf16 v[20:23], a[124:127], v[76:79], v[20:23]
  v_mfma_f32_16x16x32_bf16 v[24:27], a[188:191], v[76:79], v[24:27]
  v_mfma_f32_16x16x32_bf16 v[28:31], a[252:255], v[76:79], v[28:31]
  ds_read_b128 v[76:79], v7 offset:15360
  s_nop 3
  v_cvt_pk_bf16_f32 v96, v16, v17
  s_waitcnt lgkmcnt(7)
  v_mfma_f32_16x16x32_bf16 v[32:35], a[0:3], v[48:51], 0
  v_cvt_pk_bf16_f32 v97, v18, v19
  v_mfma_f32_16x16x32_bf16 v[36:39], a[64:67], v[48:51], 0
  v_cvt_pk_bf16_f32 v98, v20, v21
  v_mfma_f32_16x16x32_bf16 v[40:43], a[128:131], v[48:51], 0
  v_cvt_pk_bf16_f32 v99, v22, v23
  v_mfma_f32_16x16x32_bf16 v[44:47], a[192:195], v[48:51], 0
  ds_read_b128 v[48:51], v7 offset:20480
  v_cvt_pk_bf16_f32 v100, v24, v25
  s_waitcnt lgkmcnt(7)
  v_mfma_f32_16x16x32_bf16 v[32:35], a[4:7], v[52:55], v[32:35]
  buffer_store_dwordx4 v[96:99], v5, s[8:11], s76 offen offset:0 sc1
  v_cvt_pk_bf16_f32 v101, v26, v27
  v_mfma_f32_16x16x32_bf16 v[36:39], a[68:71], v[52:55], v[36:39]
  v_cvt_pk_bf16_f32 v102, v28, v29
  v_mfma_f32_16x16x32_bf16 v[40:43], a[132:135], v[52:55], v[40:43]
  v_cvt_pk_bf16_f32 v103, v30, v31
  v_mfma_f32_16x16x32_bf16 v[44:47], a[196:199], v[52:55], v[44:47]
  ds_read_b128 v[52:55], v7 offset:21504
  s_waitcnt lgkmcnt(7)
  v_mfma_f32_16x16x32_bf16 v[32:35], a[8:11], v[56:59], v[32:35]
  v_mfma_f32_16x16x32_bf16 v[36:39], a[72:75], v[56:59], v[36:39]
  v_mfma_f32_16x16x32_bf16 v[40:43], a[136:139], v[56:59], v[40:43]
  buffer_store_dwordx4 v[100:103], v5, s[8:11], s76 offen offset:64 sc1
  v_mfma_f32_16x16x32_bf16 v[44:47], a[200:203], v[56:59], v[44:47]
  ds_read_b128 v[56:59], v7 offset:22528
  s_waitcnt lgkmcnt(7)
  v_mfma_f32_16x16x32_bf16 v[32:35], a[12:15], v[60:63], v[32:35]
  v_mfma_f32_16x16x32_bf16 v[36:39], a[76:79], v[60:63], v[36:39]
  v_mfma_f32_16x16x32_bf16 v[40:43], a[140:143], v[60:63], v[40:43]
  v_mfma_f32_16x16x32_bf16 v[44:47], a[204:207], v[60:63], v[44:47]
  ds_read_b128 v[60:63], v7 offset:23552
  s_waitcnt lgkmcnt(7)
  v_mfma_f32_16x16x32_bf16 v[32:35], a[16:19], v[64:67], v[32:35]
  v_mfma_f32_16x16x32_bf16 v[36:39], a[80:83], v[64:67], v[36:39]
  v_mfma_f32_16x16x32_bf16 v[40:43], a[144:147], v[64:67], v[40:43]
  v_mfma_f32_16x16x32_bf16 v[44:47], a[208:211], v[64:67], v[44:47]
  ds_read_b128 v[64:67], v7 offset:28672
  s_waitcnt lgkmcnt(7)
  v_mfma_f32_16x16x32_bf16 v[32:35], a[20:23], v[68:71], v[32:35]
  v_mfma_f32_16x16x32_bf16 v[36:39], a[84:87], v[68:71], v[36:39]
  v_mfma_f32_16x16x32_bf16 v[40:43], a[148:151], v[68:71], v[40:43]
  v_mfma_f32_16x16x32_bf16 v[44:47], a[212:215], v[68:71], v[44:47]
  ds_read_b128 v[68:71], v7 offset:29696
  s_waitcnt lgkmcnt(7)
  v_mfma_f32_16x16x32_bf16 v[32:35], a[24:27], v[72:75], v[32:35]
  v_mfma_f32_16x16x32_bf16 v[36:39], a[88:91], v[72:75], v[36:39]
  v_mfma_f32_16x16x32_bf16 v[40:43], a[152:155], v[72:75], v[40:43]
  v_mfma_f32_16x16x32_bf16 v[44:47], a[216:219], v[72:75], v[44:47]
  ds_read_b128 v[72:75], v7 offset:30720
  s_waitcnt lgkmcnt(7)
  v_mfma_f32_16x16x32_bf16 v[32:35], a[28:31], v[76:79], v[32:35]
  v_mfma_f32_16x16x32_bf16 v[36:39], a[92:95], v[76:79], v[36:39]
  v_mfma_f32_16x16x32_bf16 v[40:43], a[156:159], v[76:79], v[40:43]
  v_mfma_f32_16x16x32_bf16 v[44:47], a[220:223], v[76:79], v[44:47]
  ds_read_b128 v[76:79], v7 offset:31744
  s_waitcnt lgkmcnt(7)
  v_mfma_f32_16x16x32_bf16 v[32:35], a[32:35], v[48:51], v[32:35]
  v_mfma_f32_16x16x32_bf16 v[36:39], a[96:99], v[48:51], v[36:39]
  v_mfma_f32_16x16x32_bf16 v[40:43], a[160:163], v[48:51], v[40:43]
  v_mfma_f32_16x16x32_bf16 v[44:47], a[224:227], v[48:51], v[44:47]
  s_waitcnt lgkmcnt(6)
  v_mfma_f32_16x16x32_bf16 v[32:35], a[36:39], v[52:55], v[32:35]
  v_mfma_f32_16x16x32_bf16 v[36:39], a[100:103], v[52:55], v[36:39]
  v_mfma_f32_16x16x32_bf16 v[40:43], a[164:167], v[52:55], v[40:43]
  v_mfma_f32_16x16x32_bf16 v[44:47], a[228:231], v[52:55], v[44:47]
  s_waitcnt lgkmcnt(5)
  v_mfma_f32_16x16x32_bf16 v[32:35], a[40:43], v[56:59], v[32:35]
  v_mfma_f32_16x16x32_bf16 v[36:39], a[104:107], v[56:59], v[36:39]
  v_mfma_f32_16x16x32_bf16 v[40:43], a[168:171], v[56:59], v[40:43]
  v_mfma_f32_16x16x32_bf16 v[44:47], a[232:235], v[56:59], v[44:47]
  s_waitcnt lgkmcnt(4)
  v_mfma_f32_16x16x32_bf16 v[32:35], a[44:47], v[60:63], v[32:35]
  v_mfma_f32_16x16x32_bf16 v[36:39], a[108:111], v[60:63], v[36:39]
  v_mfma_f32_16x16x32_bf16 v[40:43], a[172:175], v[60:63], v[40:43]
  v_mfma_f32_16x16x32_bf16 v[44:47], a[236:239], v[60:63], v[44:47]
  s_waitcnt lgkmcnt(3)
  v_mfma_f32_16x16x32_bf16 v[32:35], a[48:51], v[64:67], v[32:35]
  v_mfma_f32_16x16x32_bf16 v[36:39], a[112:115], v[64:67], v[36:39]
  v_mfma_f32_16x16x32_bf16 v[40:43], a[176:179], v[64:67], v[40:43]
  v_mfma_f32_16x16x32_bf16 v[44:47], a[240:243], v[64:67], v[44:47]
  s_waitcnt lgkmcnt(2)
  v_mfma_f32_16x16x32_bf16 v[32:35], a[52:55], v[68:71], v[32:35]
  v_mfma_f32_16x16x32_bf16 v[36:39], a[116:119], v[68:71], v[36:39]
  v_mfma_f32_16x16x32_bf16 v[40:43], a[180:183], v[68:71], v[40:43]
  v_mfma_f32_16x16x32_bf16 v[44:47], a[244:247], v[68:71], v[44:47]
  s_waitcnt lgkmcnt(1)
  v_mfma_f32_16x16x32_bf16 v[32:35], a[56:59], v[72:75], v[32:35]
  v_mfma_f32_16x16x32_bf16 v[36:39], a[120:123], v[72:75], v[36:39]
  v_mfma_f32_16x16x32_bf16 v[40:43], a[184:187], v[72:75], v[40:43]
  v_mfma_f32_16x16x32_bf16 v[44:47], a[248:251], v[72:75], v[44:47]
  s_waitcnt lgkmcnt(0)
  v_mfma_f32_16x16x32_bf16 v[32:35], a[60:63], v[76:79], v[32:35]
  v_mfma_f32_16x16x32_bf16 v[36:39], a[124:127], v[76:79], v[36:39]
  v_mfma_f32_16x16x32_bf16 v[40:43], a[188:191], v[76:79], v[40:43]
  v_mfma_f32_16x16x32_bf16 v[44:47], a[252:255], v[76:79], v[44:47]
  s_nop 4
  v_cvt_pk_bf16_f32 v104, v32, v33
  v_cvt_pk_bf16_f32 v105, v34, v35
  v_cvt_pk_bf16_f32 v106, v36, v37
  v_cvt_pk_bf16_f32 v107, v38, v39
  buffer_store_dwordx4 v[104:107], v5, s[8:11], s77 offen offset:0 sc1
  v_cvt_pk_bf16_f32 v108, v40, v41
  v_cvt_pk_bf16_f32 v109, v42, v43
  v_cvt_pk_bf16_f32 v110, v44, v45
  v_cvt_pk_bf16_f32 v111, v46, v47
  buffer_store_dwordx4 v[108:111], v5, s[8:11], s77 offen offset:64 sc1
  s_xor_b32 s86, s86, 32768
  s_add_u32 s73, s73, 1
  s_cmp_lt_u32 s73, 64
  s_cbranch_scc1 C_LOOPG
  s_waitcnt vmcnt(0)
  s_mov_b64 exec, 1
  buffer_store_dword v3, v6, s[8:11], s92 offen sc1
  s_mov_b64 exec, -1
  s_mov_b32 s92, 268435456
  s_endpgm
ROLE_FG:
  s_mul_i32 s71, s17, 4682
  s_lshr_b32 s71, s71, 16
  s_mul_i32 s76, s71, 14
  s_sub_u32 s70, s17, s76
  v_and_b32 v14, 63, v0
  v_lshlrev_b32 v1, 4, v14
  v_and_b32 v15, 15, v14
  v_lshrrev_b32 v13, 4, v14
  v_lshlrev_b32 v2, 10, v15
  v_lshl_add_u32 v2, v13, 4, v2
  v_and_b32 v3, 15, v14
  v_lshlrev_b32 v3, 6, v3
  v_mov_b32 v4, 1
  s_lshl_b32 s76, s70, 15
  s_lshl_b32 s77, s16, 8
  s_add_u32 s76, s76, s77
  v_add_u32 v6, s76, v2
  s_lshl_b32 s76, s70, 2
  s_add_u32 s76, s76, s16
  s_lshl_b32 s77, s76, 2
  v_mov_b32 v7, s77
  s_lshl_b32 s77, s16, 10
  s_add_u32 s77, s77, 65536
  v_add_u32 v8, s77, v1
  v_add_u32 v10, 65536, v1
  s_lshr_b32 s74, s71, 1
  s_cmp_eq_u32 s74, 0
  s_cbranch_scc1 FG_NOSTAGE_43
  s_call_b64 s[100:101], VERIFY
  s_cbranch_scc1 VER_OK_45
  v_mov_b32 v0, v116
  s_waitcnt vmcnt(0) lgkmcnt(0)
  s_barrier
  s_branch DISPATCH
VER_OK_45:
  v_mbcnt_lo_u32_b32 v116, -1, 0
  v_mbcnt_hi_u32_b32 v116, -1, v116
  v_and_b32 v116, 31, v116
  v_lshlrev_b32 v116, 6, v116
  s_mov_b32 s44, 24805376
FG_GOSPIN_44:
  buffer_load_dword v117, v116, s[8:11], s44 offen sc1
  s_waitcnt vmcnt(0)
  v_cmp_eq_u32 vcc, 0, v117
  s_nop 0
  s_cbranch_vccz FG_NOSTAGE_43
  s_cmp_eq_u32 s19, 0
  s_cbranch_scc1 FG_NOSTAGE_43
  s_sub_u32 s19, s19, 1
  s_sleep 8
  s_branch FG_GOSPIN_44
FG_NOSTAGE_43:
  s_lshl_b32 s41, s16, 15
  v_lshrrev_b32 v100, 4, v14
  v_lshlrev_b32 v100, 3, v100
  v_lshrrev_b32 v102, 2, v14
  v_and_b32 v102, 3, v102
  v_add_u32 v100, v100, v102
  v_lshlrev_b32 v100, 6, v100
  v_and_b32 v102, 3, v14
  v_lshl_add_u32 v100, v102, 4, v100
  v_add_u32 v100, s41, v100
  v_lshrrev_b32 v102, 2, v14
  s_mov_b32 s40, 3584
  v_mul_lo_u32 v102, v102, s40
  v_and_b32 v101, 3, v14
  v_lshl_add_u32 v102, v101, 4, v102
  v_lshrrev_b32 v103, 2, v14
  s_mov_b32 s40, 1024
  v_mul_lo_u32 v103, v103, s40
  v_and_b32 v101, 3, v14
  v_lshl_add_u32 v103, v101, 4, v103
  s_lshl_b32 s44, s76, 6
  s_lshl_b32 s45, s70, 17
  s_lshl_b32 s46, s16, 8
  s_add_u32 s45, s45, s46
  s_load_dwordx2 s[42:43], s[0:1], 64
  s_waitcnt lgkmcnt(0)
  s_mov_b32 s36, s42
  s_and_b32 s37, s43, 0xffff
  s_mov_b32 s38, 1835008
  s_mov_b32 s39, 0x20000
  s_add_u32 s40, s44, 0
  s_add_u32 m0, s41, 0
  s_nop 0
  buffer_load_dwordx4 v102, s[36:39], s40 offen lds
  s_add_u32 s40, s40, 57344
  s_add_u32 m0, s41, 1024
  s_nop 0
  buffer_load_dwordx4 v102, s[36:39], s40 offen lds
  s_add_u32 s40, s44, 114688
  s_add_u32 m0, s41, 2048
  s_nop 0
  buffer_load_dwordx4 v102, s[36:39], s40 offen lds
  s_add_u32 s40, s40, 57344
  s_add_u32 m0, s41, 3072
  s_nop 0
  buffer_load_dwordx4 v102, s[36:39], s40 offen lds
  s_add_u32 s40, s44, 229376
  s_add_u32 m0, s41, 4096
  s_nop 0
  buffer_load_dwordx4 v102, s[36:39], s40 offen lds
  s_add_u32 s40, s40, 57344
  s_add_u32 m0, s41, 5120
  s_nop 0
  buffer_load_dwordx4 v102, s[36:39], s40 offen lds
  s_add_u32 s40, s44, 344064
  s_add_u32 m0, s41, 6144
  s_nop 0
  buffer_load_dwordx4 v102, s[36:39], s40 offen lds
  s_add_u32 s40, s40, 57344
  s_add_u32 m0, s41, 7168
  s_nop 0
  buffer_load_dwordx4 v102, s[36:39], s40 offen lds
  s_add_u32 s40, s44, 458752
  s_add_u32 m0, s41, 8192
  s_nop 0
  buffer_load_dwordx4 v102, s[36:39], s40 offen lds
  s_add_u32 s40, s40, 57344
  s_add_u32 m0, s41, 9216
  s_nop 0
  buffer_load_dwordx4 v102, s[36:39], s40 offen lds
  s_add_u32 s40, s44, 573440
  s_add_u32 m0, s41, 10240
  s_nop 0
  buffer_load_dwordx4 v102, s[36:39], s40 offen lds
  s_add_u32 s40, s40, 57344
  s_add_u32 m0, s41, 11264
  s_nop 0
  buffer_load_dwordx4 v102, s[36:39], s40 offen lds
  s_add_u32 s40, s44, 688128
  s_add_u32 m0, s41, 12288
  s_nop 0
  buffer_load_dwordx4 v102, s[36:39], s40 offen lds
  s_add_u32 s40, s40, 57344
  s_add_u32 m0, s41, 13312
  s_nop 0
  buffer_load_dwordx4 v102, s[36:39], s40 offen lds
  s_add_u32 s40, s44, 802816
  s_add_u32 m0, s41, 14336
  s_nop 0
  buffer_load_dwordx4 v102, s[36:39], s40 offen lds
  s_add_u32 s40, s40, 57344
  s_add_u32 m0, s41, 15360
  s_nop 0
  buffer_load_dwordx4 v102, s[36:39], s40 offen lds
  s_add_u32 s40, s44, 917504
  s_add_u32 m0, s41, 16384
  s_nop 0
  buffer_load_dwordx4 v102, s[36:39], s40 offen lds
  s_add_u32 s40, s40, 57344
  s_add_u32 m0, s41, 17408
  s_nop 0
  buffer_load_dwordx4 v102, s[36:39], s40 offen lds
  s_add_u32 s40, s44, 1032192
  s_add_u32 m0, s41, 18432
  s_nop 0
  buffer_load_dwordx4 v102, s[36:39], s40 offen lds
  s_add_u32 s40, s40, 57344
  s_add_u32 m0, s41, 19456
  s_nop 0
  buffer_load_dwordx4 v102, s[36:39], s40 offen lds
  s_add_u32 s40, s44, 1146880
  s_add_u32 m0, s41, 20480
  s_nop 0
  buffer_load_dwordx4 v102, s[36:39], s40 offen lds
  s_add_u32 s40, s40, 57344
  s_add_u32 m0, s41, 21504
  s_nop 0
  buffer_load_dwordx4 v102, s[36:39], s40 offen lds
  s_add_u32 s40, s44, 1261568
  s_add_u32 m0, s41, 22528
  s_nop 0
  buffer_load_dwordx4 v102, s[36:39], s40 offen lds
  s_add_u32 s40, s40, 57344
  s_add_u32 m0, s41, 23552
  s_nop 0
  buffer_load_dwordx4 v102, s[36:39], s40 offen lds
  s_add_u32 s40, s44, 1376256
  s_add_u32 m0, s41, 24576
  s_nop 0
  buffer_load_dwordx4 v102, s[36:39], s40 offen lds
  s_add_u32 s40, s40, 57344
  s_add_u32 m0, s41, 25600
  s_nop 0
  buffer_load_dwordx4 v102, s[36:39], s40 offen lds
  s_add_u32 s40, s44, 1490944
  s_add_u32 m0, s41, 26624
  s_nop 0
  buffer_load_dwordx4 v102, s[36:39], s40 offen lds
  s_add_u32 s40, s40, 57344
  s_add_u32 m0, s41, 27648
  s_nop 0
  buffer_load_dwordx4 v102, s[36:39], s40 offen lds
  s_add_u32 s40, s44, 1605632
  s_add_u32 m0, s41, 28672
  s_nop 0
  buffer_load_dwordx4 v102, s[36:39], s40 offen lds
  s_add_u32 s40, s40, 57344
  s_add_u32 m0, s41, 29696
  s_nop 0
  buffer_load_dwordx4 v102, s[36:39], s40 offen lds
  s_add_u32 s40, s44, 1720320
  s_add_u32 m0, s41, 30720
  s_nop 0
  buffer_load_dwordx4 v102, s[36:39], s40 offen lds
  s_add_u32 s40, s40, 57344
  s_add_u32 m0, s41, 31744
  s_nop 0
  buffer_load_dwordx4 v102, s[36:39], s40 offen lds
  s_waitcnt vmcnt(16)
  ds_read_b64_tr_b16 a[0:1], v100 offset:0
  ds_read_b64_tr_b16 a[2:3], v100 offset:256
  ds_read_b64_tr_b16 a[64:65], v100 offset:8
  ds_read_b64_tr_b16 a[66:67], v100 offset:264
  ds_read_b64_tr_b16 a[4:5], v100 offset:2048
  ds_read_b64_tr_b16 a[6:7], v100 offset:2304
  ds_read_b64_tr_b16 a[68:69], v100 offset:2056
  ds_read_b64_tr_b16 a[70:71], v100 offset:2312
  s_waitcnt lgkmcnt(4)
  ds_read_b64_tr_b16 a[8:9], v100 offset:4096
  ds_read_b64_tr_b16 a[10:11], v100 offset:4352
  ds_read_b64_tr_b16 a[72:73], v100 offset:4104
  ds_read_b64_tr_b16 a[74:75], v100 offset:4360
  ds_read_b64_tr_b16 a[12:13], v100 offset:6144
  ds_read_b64_tr_b16 a[14:15], v100 offset:6400
  ds_read_b64_tr_b16 a[76:77], v100 offset:6152
  ds_read_b64_tr_b16 a[78:79], v100 offset:6408
  s_waitcnt lgkmcnt(4)
  ds_read_b64_tr_b16 a[16:17], v100 offset:8192
  ds_read_b64_tr_b16 a[18:19], v100 offset:8448
  ds_read_b64_tr_b16 a[80:81], v100 offset:8200
  ds_read_b64_tr_b16 a[82:83], v100 offset:8456
  ds_read_b64_tr_b16 a[20:21], v100 offset:10240
  ds_read_b64_tr_b16 a[22:23], v100 offset:10496
  ds_read_b64_tr_b16 a[84:85], v100 offset:10248
  ds_read_b64_tr_b16 a[86:87], v100 offset:10504
  s_waitcnt lgkmcnt(4)
  ds_read_b64_tr_b16 a[24:25], v100 offset:12288
  ds_read_b64_tr_b16 a[26:27], v100 offset:12544
  ds_read_b64_tr_b16 a[88:89], v100 offset:12296
  ds_read_b64_tr_b16 a[90:91], v100 offset:12552
  ds_read_b64_tr_b16 a[28:29], v100 offset:14336
  ds_read_b64_tr_b16 a[30:31], v100 offset:14592
  ds_read_b64_tr_b16 a[92:93], v100 offset:14344
  ds_read_b64_tr_b16 a[94:95], v100 offset:14600
  s_waitcnt lgkmcnt(4)
  s_waitcnt lgkmcnt(0)
  s_load_dwordx2 s[42:43], s[0:1], 72
  s_waitcnt lgkmcnt(0)
  s_mov_b32 s36, s42
  s_and_b32 s37, s43, 0xffff
  s_mov_b32 s38, 1835008
  s_mov_b32 s39, 0x20000
  s_add_u32 s40, s44, 0
  s_add_u32 m0, s41, 0
  s_nop 0
  buffer_load_dwordx4 v102, s[36:39], s40 offen lds
  s_add_u32 s40, s40, 57344
  s_add_u32 m0, s41, 1024
  s_nop 0
  buffer_load_dwordx4 v102, s[36:39], s40 offen lds
  s_add_u32 s40, s44, 114688
  s_add_u32 m0, s41, 2048
  s_nop 0
  buffer_load_dwordx4 v102, s[36:39], s40 offen lds
  s_add_u32 s40, s40, 57344
  s_add_u32 m0, s41, 3072
  s_nop 0
  buffer_load_dwordx4 v102, s[36:39], s40 offen lds
  s_add_u32 s40, s44, 229376
  s_add_u32 m0, s41, 4096
  s_nop 0
  buffer_load_dwordx4 v102, s[36:39], s40 offen lds
  s_add_u32 s40, s40, 57344
  s_add_u32 m0, s41, 5120
  s_nop 0
  buffer_load_dwordx4 v102, s[36:39], s40 offen lds
  s_add_u32 s40, s44, 344064
  s_add_u32 m0, s41, 6144
  s_nop 0
  buffer_load_dwordx4 v102, s[36:39], s40 offen lds
  s_add_u32 s40, s40, 57344
  s_add_u32 m0, s41, 7168
  s_nop 0
  buffer_load_dwordx4 v102, s[36:39], s40 offen lds
  s_add_u32 s40, s44, 458752
  s_add_u32 m0, s41, 8192
  s_nop 0
  buffer_load_dwordx4 v102, s[36:39], s40 offen lds
  s_add_u32 s40, s40, 57344
  s_add_u32 m0, s41, 9216
  s_nop 0
  buffer_load_dwordx4 v102, s[36:39], s40 offen lds
  s_add_u32 s40, s44, 573440
  s_add_u32 m0, s41, 10240
  s_nop 0
  buffer_load_dwordx4 v102, s[36:39], s40 offen lds
  s_add_u32 s40, s40, 57344
  s_add_u32 m0, s41, 11264
  s_nop 0
  buffer_load_dwordx4 v102, s[36:39], s40 offen lds
  s_add_u32 s40, s44, 688128
  s_add_u32 m0, s41, 12288
  s_nop 0
  buffer_load_dwordx4 v102, s[36:39], s40 offen lds
  s_add_u32 s40, s40, 57344
  s_add_u32 m0, s41, 13312
  s_nop 0
  buffer_load_dwordx4 v102, s[36:39], s40 offen lds
  s_add_u32 s40, s44, 802816
  s_add_u32 m0, s41, 14336
  s_nop 0
  buffer_load_dwordx4 v102, s[36:39], s40 offen lds
  s_add_u32 s40, s40, 57344
  s_add_u32 m0, s41, 15360
  s_nop 0
  buffer_load_dwordx4 v102, s[36:39], s40 offen lds
  s_waitcnt vmcnt(16)
  ds_read_b64_tr_b16 a[32:33], v100 offset:16384
  ds_read_b64_tr_b16 a[34:35], v100 offset:16640
  ds_read_b64_tr_b16 a[96:97], v100 offset:16392
  ds_read_b64_tr_b16 a[98:99], v100 offset:16648
  ds_read_b64_tr_b16 a[36:37], v100 offset:18432
  ds_read_b64_tr_b16 a[38:39], v100 offset:18688
  ds_read_b64_tr_b16 a[100:101], v100 offset:18440
  ds_read_b64_tr_b16 a[102:103], v100 offset:18696
  s_waitcnt lgkmcnt(4)
  ds_read_b64_tr_b16 a[40:41], v100 offset:20480
  ds_read_b64_tr_b16 a[42:43], v100 offset:20736
  ds_read_b64_tr_b16 a[104:105], v100 offset:20488
  ds_read_b64_tr_b16 a[106:107], v100 offset:20744
  ds_read_b64_tr_b16 a[44:45], v100 offset:22528
  ds_read_b64_tr_b16 a[46:47], v100 offset:22784
  ds_read_b64_tr_b16 a[108:109], v100 offset:22536
  ds_read_b64_tr_b16 a[110:111], v100 offset:22792
  s_waitcnt lgkmcnt(4)
  ds_read_b64_tr_b16 a[48:49], v100 offset:24576
  ds_read_b64_tr_b16 a[50:51], v100 offset:24832
  ds_read_b64_tr_b16 a[112:113], v100 offset:24584
  ds_read_b64_tr_b16 a[114:115], v100 offset:24840
  ds_read_b64_tr_b16 a[52:53], v100 offset:26624
  ds_read_b64_tr_b16 a[54:55], v100 offset:26880
  ds_read_b64_tr_b16 a[116:117], v100 offset:26632
  ds_read_b64_tr_b16 a[118:119], v100 offset:26888
  s_waitcnt lgkmcnt(4)
  ds_read_b64_tr_b16 a[56:57], v100 offset:28672
  ds_read_b64_tr_b16 a[58:59], v100 offset:28928
  ds_read_b64_tr_b16 a[120:121], v100 offset:28680
  ds_read_b64_tr_b16 a[122:123], v100 offset:28936
  ds_read_b64_tr_b16 a[60:61], v100 offset:30720
  ds_read_b64_tr_b16 a[62:63], v100 offset:30976
  ds_read_b64_tr_b16 a[124:125], v100 offset:30728
  ds_read_b64_tr_b16 a[126:127], v100 offset:30984
  s_waitcnt lgkmcnt(4)
  s_waitcnt lgkmcnt(0)
  s_add_u32 s40, s44, 917504
  s_add_u32 m0, s41, 16384
  s_nop 0
  buffer_load_dwordx4 v102, s[36:39], s40 offen lds
  s_add_u32 s40, s40, 57344
  s_add_u32 m0, s41, 17408
  s_nop 0
  buffer_load_dwordx4 v102, s[36:39], s40 offen lds
  s_add_u32 s40, s44, 1032192
  s_add_u32 m0, s41, 18432
  s_nop 0
  buffer_load_dwordx4 v102, s[36:39], s40 offen lds
  s_add_u32 s40, s40, 57344
  s_add_u32 m0, s41, 19456
  s_nop 0
  buffer_load_dwordx4 v102, s[36:39], s40 offen lds
  s_add_u32 s40, s44, 1146880
  s_add_u32 m0, s41, 20480
  s_nop 0
  buffer_load_dwordx4 v102, s[36:39], s40 offen lds
  s_add_u32 s40, s40, 57344
  s_add_u32 m0, s41, 21504
  s_nop 0
  buffer_load_dwordx4 v102, s[36:39], s40 offen lds
  s_add_u32 s40, s44, 1261568
  s_add_u32 m0, s41, 22528
  s_nop 0
  buffer_load_dwordx4 v102, s[36:39], s40 offen lds
  s_add_u32 s40, s40, 57344
  s_add_u32 m0, s41, 23552
  s_nop 0
  buffer_load_dwordx4 v102, s[36:39], s40 offen lds
  s_add_u32 s40, s44, 1376256
  s_add_u32 m0, s41, 24576
  s_nop 0
  buffer_load_dwordx4 v102, s[36:39], s40 offen lds
  s_add_u32 s40, s40, 57344
  s_add_u32 m0, s41, 25600
  s_nop 0
  buffer_load_dwordx4 v102, s[36:39], s40 offen lds
  s_add_u32 s40, s44, 1490944
  s_add_u32 m0, s41, 26624
  s_nop 0
  buffer_load_dwordx4 v102, s[36:39], s40 offen lds
  s_add_u32 s40, s40, 57344
  s_add_u32 m0, s41, 27648
  s_nop 0
  buffer_load_dwordx4 v102, s[36:39], s40 offen lds
  s_add_u32 s40, s44, 1605632
  s_add_u32 m0, s41, 28672
  s_nop 0
  buffer_load_dwordx4 v102, s[36:39], s40 offen lds
  s_add_u32 s40, s40, 57344
  s_add_u32 m0, s41, 29696
  s_nop 0
  buffer_load_dwordx4 v102, s[36:39], s40 offen lds
  s_add_u32 s40, s44, 1720320
  s_add_u32 m0, s41, 30720
  s_nop 0
  buffer_load_dwordx4 v102, s[36:39], s40 offen lds
  s_add_u32 s40, s40, 57344
  s_add_u32 m0, s41, 31744
  s_nop 0
  buffer_load_dwordx4 v102, s[36:39], s40 offen lds
  s_waitcnt vmcnt(16)
  ds_read_b64_tr_b16 a[128:129], v100 offset:0
  ds_read_b64_tr_b16 a[130:131], v100 offset:256
  ds_read_b64_tr_b16 a[192:193], v100 offset:8
  ds_read_b64_tr_b16 a[194:195], v100 offset:264
  ds_read_b64_tr_b16 a[132:133], v100 offset:2048
  ds_read_b64_tr_b16 a[134:135], v100 offset:2304
  ds_read_b64_tr_b16 a[196:197], v100 offset:2056
  ds_read_b64_tr_b16 a[198:199], v100 offset:2312
  s_waitcnt lgkmcnt(4)
  ds_read_b64_tr_b16 a[136:137], v100 offset:4096
  ds_read_b64_tr_b16 a[138:139], v100 offset:4352
  ds_read_b64_tr_b16 a[200:201], v100 offset:4104
  ds_read_b64_tr_b16 a[202:203], v100 offset:4360
  ds_read_b64_tr_b16 a[140:141], v100 offset:6144
  ds_read_b64_tr_b16 a[142:143], v100 offset:6400
  ds_read_b64_tr_b16 a[204:205], v100 offset:6152
  ds_read_b64_tr_b16 a[206:207], v100 offset:6408
  s_waitcnt lgkmcnt(4)
  ds_read_b64_tr_b16 a[144:145], v100 offset:8192
  ds_read_b64_tr_b16 a[146:147], v100 offset:8448
  ds_read_b64_tr_b16 a[208:209], v100 offset:8200
  ds_read_b64_tr_b16 a[210:211], v100 offset:8456
  ds_read_b64_tr_b16 a[148:149], v100 offset:10240
  ds_read_b64_tr_b16 a[150:151], v100 offset:10496
  ds_read_b64_tr_b16 a[212:213], v100 offset:10248
  ds_read_b64_tr_b16 a[214:215], v100 offset:10504
  s_waitcnt lgkmcnt(4)
  ds_read_b64_tr_b16 a[152:153], v100 offset:12288
  ds_read_b64_tr_b16 a[154:155], v100 offset:12544
  ds_read_b64_tr_b16 a[216:217], v100 offset:12296
  ds_read_b64_tr_b16 a[218:219], v100 offset:12552
  ds_read_b64_tr_b16 a[156:157], v100 offset:14336
  ds_read_b64_tr_b16 a[158:159], v100 offset:14592
  ds_read_b64_tr_b16 a[220:221], v100 offset:14344
  ds_read_b64_tr_b16 a[222:223], v100 offset:14600
  s_waitcnt lgkmcnt(4)
  s_waitcnt lgkmcnt(0)
  s_load_dwordx2 s[42:43], s[0:1], 80
  s_waitcnt lgkmcnt(0)
  s_mov_b32 s36, s42
  s_and_b32 s37, s43, 0xffff
  s_mov_b32 s38, 1835008
  s_mov_b32 s39, 0x20000
  s_add_u32 s40, s45, 0
  s_add_u32 m0, s41, 0
  s_nop 0
  buffer_load_dwordx4 v103, s[36:39], s40 offen lds
  s_add_u32 s40, s40, 16384
  s_add_u32 m0, s41, 1024
  s_nop 0
  buffer_load_dwordx4 v103, s[36:39], s40 offen lds
  s_add_u32 s40, s45, 32768
  s_add_u32 m0, s41, 2048
  s_nop 0
  buffer_load_dwordx4 v103, s[36:39], s40 offen lds
  s_add_u32 s40, s40, 16384
  s_add_u32 m0, s41, 3072
  s_nop 0
  buffer_load_dwordx4 v103, s[36:39], s40 offen lds
  s_add_u32 s40, s45, 65536
  s_add_u32 m0, s41, 4096
  s_nop 0
  buffer_load_dwordx4 v103, s[36:39], s40 offen lds
  s_add_u32 s40, s40, 16384
  s_add_u32 m0, s41, 5120
  s_nop 0
  buffer_load_dwordx4 v103, s[36:39], s40 offen lds
  s_add_u32 s40, s45, 98304
  s_add_u32 m0, s41, 6144
  s_nop 0
  buffer_load_dwordx4 v103, s[36:39], s40 offen lds
  s_add_u32 s40, s40, 16384
  s_add_u32 m0, s41, 7168
  s_nop 0
  buffer_load_dwordx4 v103, s[36:39], s40 offen lds
  s_add_u32 s40, s45, 64
  s_add_u32 m0, s41, 8192
  s_nop 0
  buffer_load_dwordx4 v103, s[36:39], s40 offen lds
  s_add_u32 s40, s40, 16384
  s_add_u32 m0, s41, 9216
  s_nop 0
  buffer_load_dwordx4 v103, s[36:39], s40 offen lds
  s_add_u32 s40, s45, 32832
  s_add_u32 m0, s41, 10240
  s_nop 0
  buffer_load_dwordx4 v103, s[36:39], s40 offen lds
  s_add_u32 s40, s40, 16384
  s_add_u32 m0, s41, 11264
  s_nop 0
  buffer_load_dwordx4 v103, s[36:39], s40 offen lds
  s_add_u32 s40, s45, 65600
  s_add_u32 m0, s41, 12288
  s_nop 0
  buffer_load_dwordx4 v103, s[36:39], s40 offen lds
  s_add_u32 s40, s40, 16384
  s_add_u32 m0, s41, 13312
  s_nop 0
  buffer_load_dwordx4 v103, s[36:39], s40 offen lds
  s_add_u32 s40, s45, 98368
  s_add_u32 m0, s41, 14336
  s_nop 0
  buffer_load_dwordx4 v103, s[36:39], s40 offen lds
  s_add_u32 s40, s40, 16384
  s_add_u32 m0, s41, 15360
  s_nop 0
  buffer_load_dwordx4 v103, s[36:39], s40 offen lds
  s_waitcnt vmcnt(16)
  ds_read_b64_tr_b16 a[160:161], v100 offset:16384
  ds_read_b64_tr_b16 a[162:163], v100 offset:16640
  ds_read_b64_tr_b16 a[224:225], v100 offset:16392
  ds_read_b64_tr_b16 a[226:227], v100 offset:16648
  ds_read_b64_tr_b16 a[164:165], v100 offset:18432
  ds_read_b64_tr_b16 a[166:167], v100 offset:18688
  ds_read_b64_tr_b16 a[228:229], v100 offset:18440
  ds_read_b64_tr_b16 a[230:231], v100 offset:18696
  s_waitcnt lgkmcnt(4)
  ds_read_b64_tr_b16 a[168:169], v100 offset:20480
  ds_read_b64_tr_b16 a[170:171], v100 offset:20736
  ds_read_b64_tr_b16 a[232:233], v100 offset:20488
  ds_read_b64_tr_b16 a[234:235], v100 offset:20744
  ds_read_b64_tr_b16 a[172:173], v100 offset:22528
  ds_read_b64_tr_b16 a[174:175], v100 offset:22784
  ds_read_b64_tr_b16 a[236:237], v100 offset:22536
  ds_read_b64_tr_b16 a[238:239], v100 offset:22792
  s_waitcnt lgkmcnt(4)
  ds_read_b64_tr_b16 a[176:177], v100 offset:24576
  ds_read_b64_tr_b16 a[178:179], v100 offset:24832
  ds_read_b64_tr_b16 a[240:241], v100 offset:24584
  ds_read_b64_tr_b16 a[242:243], v100 offset:24840
  ds_read_b64_tr_b16 a[180:181], v100 offset:26624
  ds_read_b64_tr_b16 a[182:183], v100 offset:26880
  ds_read_b64_tr_b16 a[244:245], v100 offset:26632
  ds_read_b64_tr_b16 a[246:247], v100 offset:26888
  s_waitcnt lgkmcnt(4)
  ds_read_b64_tr_b16 a[184:185], v100 offset:28672
  ds_read_b64_tr_b16 a[186:187], v100 offset:28928
  ds_read_b64_tr_b16 a[248:249], v100 offset:28680
  ds_read_b64_tr_b16 a[250:251], v100 offset:28936
  ds_read_b64_tr_b16 a[188:189], v100 offset:30720
  ds_read_b64_tr_b16 a[190:191], v100 offset:30976
  ds_read_b64_tr_b16 a[252:253], v100 offset:30728
  ds_read_b64_tr_b16 a[254:255], v100 offset:30984
  s_waitcnt lgkmcnt(4)
  s_waitcnt lgkmcnt(0)
  s_add_u32 s40, s45, 128
  s_add_u32 m0, s41, 16384
  s_nop 0
  buffer_load_dwordx4 v103, s[36:39], s40 offen lds
  s_add_u32 s40, s40, 16384
  s_add_u32 m0, s41, 17408
  s_nop 0
  buffer_load_dwordx4 v103, s[36:39], s40 offen lds
  s_add_u32 s40, s45, 32896
  s_add_u32 m0, s41, 18432
  s_nop 0
  buffer_load_dwordx4 v103, s[36:39], s40 offen lds
  s_add_u32 s40, s40, 16384
  s_add_u32 m0, s41, 19456
  s_nop 0
  buffer_load_dwordx4 v103, s[36:39], s40 offen lds
  s_add_u32 s40, s45, 65664
  s_add_u32 m0, s41, 20480
  s_nop 0
  buffer_load_dwordx4 v103, s[36:39], s40 offen lds
  s_add_u32 s40, s40, 16384
  s_add_u32 m0, s41, 21504
  s_nop 0
  buffer_load_dwordx4 v103, s[36:39], s40 offen lds
  s_add_u32 s40, s45, 98432
  s_add_u32 m0, s41, 22528
  s_nop 0
  buffer_load_dwordx4 v103, s[36:39], s40 offen lds
  s_add_u32 s40, s40, 16384
  s_add_u32 m0, s41, 23552
  s_nop 0
  buffer_load_dwordx4 v103, s[36:39], s40 offen lds
  s_add_u32 s40, s45, 192
  s_add_u32 m0, s41, 24576
  s_nop 0
  buffer_load_dwordx4 v103, s[36:39], s40 offen lds
  s_add_u32 s40, s40, 16384
  s_add_u32 m0, s41, 25600
  s_nop 0
  buffer_load_dwordx4 v103, s[36:39], s40 offen lds
  s_add_u32 s40, s45, 32960
  s_add_u32 m0, s41, 26624
  s_nop 0
  buffer_load_dwordx4 v103, s[36:39], s40 offen lds
  s_add_u32 s40, s40, 16384
  s_add_u32 m0, s41, 27648
  s_nop 0
  buffer_load_dwordx4 v103, s[36:39], s40 offen lds
  s_add_u32 s40, s45, 65728
  s_add_u32 m0, s41, 28672
  s_nop 0
  buffer_load_dwordx4 v103, s[36:39], s40 offen lds
  s_add_u32 s40, s40, 16384
  s_add_u32 m0, s41, 29696
  s_nop 0
  buffer_load_dwordx4 v103, s[36:39], s40 offen lds
  s_add_u32 s40, s45, 98496
  s_add_u32 m0, s41, 30720
  s_nop 0
  buffer_load_dwordx4 v103, s[36:39], s40 offen lds
  s_add_u32 s40, s40, 16384
  s_add_u32 m0, s41, 31744
  s_nop 0
  buffer_load_dwordx4 v103, s[36:39], s40 offen lds
  s_waitcnt vmcnt(16)
  ds_read_b64_tr_b16 v[128:129], v100 offset:0
  ds_read_b64_tr_b16 v[130:131], v100 offset:256
  ds_read_b64_tr_b16 v[144:145], v100 offset:8
  ds_read_b64_tr_b16 v[146:147], v100 offset:264
  ds_read_b64_tr_b16 v[132:133], v100 offset:2048
  ds_read_b64_tr_b16 v[134:135], v100 offset:2304
  ds_read_b64_tr_b16 v[148:149], v100 offset:2056
  ds_read_b64_tr_b16 v[150:151], v100 offset:2312
  s_waitcnt lgkmcnt(4)
  ds_read_b64_tr_b16 v[136:137], v100 offset:4096
  ds_read_b64_tr_b16 v[138:139], v100 offset:4352
  ds_read_b64_tr_b16 v[152:153], v100 offset:4104
  ds_read_b64_tr_b16 v[154:155], v100 offset:4360
  ds_read_b64_tr_b16 v[140:141], v100 offset:6144
  ds_read_b64_tr_b16 v[142:143], v100 offset:6400
  ds_read_b64_tr_b16 v[156:157], v100 offset:6152
  ds_read_b64_tr_b16 v[158:159], v100 offset:6408
  s_waitcnt lgkmcnt(4)
  ds_read_b64_tr_b16 v[160:161], v100 offset:8192
  ds_read_b64_tr_b16 v[162:163], v100 offset:8448
  ds_read_b64_tr_b16 v[176:177], v100 offset:8200
  ds_read_b64_tr_b16 v[178:179], v100 offset:8456
  ds_read_b64_tr_b16 v[164:165], v100 offset:10240
  ds_read_b64_tr_b16 v[166:167], v100 offset:10496
  ds_read_b64_tr_b16 v[180:181], v100 offset:10248
  ds_read_b64_tr_b16 v[182:183], v100 offset:10504
  s_waitcnt lgkmcnt(4)
  ds_read_b64_tr_b16 v[168:169], v100 offset:12288
  ds_read_b64_tr_b16 v[170:171], v100 offset:12544
  ds_read_b64_tr_b16 v[184:185], v100 offset:12296
  ds_read_b64_tr_b16 v[186:187], v100 offset:12552
  ds_read_b64_tr_b16 v[172:173], v100 offset:14336
  ds_read_b64_tr_b16 v[174:175], v100 offset:14592
  ds_read_b64_tr_b16 v[188:189], v100 offset:14344
  ds_read_b64_tr_b16 v[190:191], v100 offset:14600
  s_waitcnt lgkmcnt(4)
  s_waitcnt lgkmcnt(0)
  s_waitcnt vmcnt(0)
  ds_read_b64_tr_b16 v[192:193], v100 offset:16384
  ds_read_b64_tr_b16 v[194:195], v100 offset:16640
  ds_read_b64_tr_b16 v[208:209], v100 offset:16392
  ds_read_b64_tr_b16 v[210:211], v100 offset:16648
  ds_read_b64_tr_b16 v[196:197], v100 offset:18432
  ds_read_b64_tr_b16 v[198:199], v100 offset:18688
  ds_read_b64_tr_b16 v[212:213], v100 offset:18440
  ds_read_b64_tr_b16 v[214:215], v100 offset:18696
  s_waitcnt lgkmcnt(4)
  ds_read_b64_tr_b16 v[200:201], v100 offset:20480
  ds_read_b64_tr_b16 v[202:203], v100 offset:20736
  ds_read_b64_tr_b16 v[216:217], v100 offset:20488
  ds_read_b64_tr_b16 v[218:219], v100 offset:20744
  ds_read_b64_tr_b16 v[204:205], v100 offset:22528
  ds_read_b64_tr_b16 v[206:207], v100 offset:22784
  ds_read_b64_tr_b16 v[220:221], v100 offset:22536
  ds_read_b64_tr_b16 v[222:223], v100 offset:22792
  s_waitcnt lgkmcnt(4)
  ds_read_b64_tr_b16 v[224:225], v100 offset:24576
  ds_read_b64_tr_b16 v[226:227], v100 offset:24832
  ds_read_b64_tr_b16 v[240:241], v100 offset:24584
  ds_read_b64_tr_b16 v[242:243], v100 offset:24840
  ds_read_b64_tr_b16 v[228:229], v100 offset:26624
  ds_read_b64_tr_b16 v[230:231], v100 offset:26880
  ds_read_b64_tr_b16 v[244:245], v100 offset:26632
  ds_read_b64_tr_b16 v[246:247], v100 offset:26888
  s_waitcnt lgkmcnt(4)
  ds_read_b64_tr_b16 v[232:233], v100 offset:28672
  ds_read_b64_tr_b16 v[234:235], v100 offset:28928
  ds_read_b64_tr_b16 v[248:249], v100 offset:28680
  ds_read_b64_tr_b16 v[250:251], v100 offset:28936
  ds_read_b64_tr_b16 v[236:237], v100 offset:30720
  ds_read_b64_tr_b16 v[238:239], v100 offset:30976
  ds_read_b64_tr_b16 v[252:253], v100 offset:30728
  ds_read_b64_tr_b16 v[254:255], v100 offset:30984
  s_waitcnt lgkmcnt(4)
  s_waitcnt lgkmcnt(0)
  s_call_b64 s[100:101], VERIFY
  s_cbranch_scc1 VER_OK_46
  v_mov_b32 v0, v116
  s_waitcnt vmcnt(0) lgkmcnt(0)
  s_barrier
  s_branch DISPATCH
VER_OK_46:
  s_barrier
  s_and_b32 s91, s71, 1
  s_lshr_b32 s74, s71, 1
  s_mov_b32 s72, 0
  v_and_b32 v14, 63, v0
  v_and_b32 v3, 7, v14
  v_lshlrev_b32 v3, 6, v3
  s_lshl_b32 s76, s91, 9
  v_add_u32 v3, s76, v3
  s_lshl_b32 s76, s91, 14
  v_add_u32 v6, s76, v6
  s_lshl_b32 s76, s91, 8
  v_add_u32 v7, s76, v7
  s_mov_b32 s93, 0
  s_mov_b32 s92, 268435456
  s_mov_b32 s86, 0
F_LOOPG:
  s_lshl_b32 s73, s74, 6
  s_add_u32 s73, s73, s72
  s_add_u32 s90, s72, 1
  s_add_u32 s87, s73, 1
  s_lshl_b32 s84, s73, 10
  s_add_u32 s84, s84, 24477696
  s_lshl_b32 s85, s87, 10
  s_add_u32 s85, s85, 24477696
  s_cmp_lt_u32 s90, 64
  s_cselect_b32 s85, s85, 268435456
  s_cmp_eq_u32 s93, 1
  s_cbranch_scc1 FG_HAVE_47
FG_W_SPIN_49:
  buffer_load_dword v5, v3, s[8:11], s84 offen sc1
  s_waitcnt vmcnt(0)
  s_mov_b64 exec, 1
  buffer_store_dword v4, v7, s[8:11], s92 offen sc1
  s_mov_b64 exec, -1
  s_mov_b32 s92, 268435456
  v_cmp_eq_u32 vcc, 0, v5
  s_nop 0
  s_cbranch_vccz FG_W_OK_50
  s_cmp_eq_u32 s19, 0
  s_cbranch_scc1 FG_W_OK_50
  s_sub_u32 s19, s19, 1
  s_sleep 1
  s_branch FG_W_SPIN_49
FG_W_OK_50:
  s_lshl_b32 s76, s73, 15
  s_add_u32 s76, s76, 38830080
  s_lshl_b32 s77, s91, 14
  s_add_u32 s76, s76, s77
  s_lshl_b32 s77, s16, 8
  s_add_u32 s76, s76, s77
  s_xor_b32 s77, s86, 0
  s_lshl_b32 s78, s16, 12
  s_add_u32 s77, s77, s78
  s_add_u32 m0, s77, 0
  s_nop 0
  buffer_load_dwordx4 v2, s[8:11], s76 offen offset:0 sc1 lds
  s_add_u32 m0, s77, 960
  s_nop 0
  buffer_load_dwordx4 v2, s[8:11], s76 offen offset:64 sc1 lds
  s_add_u32 m0, s77, 1920
  s_nop 0
  buffer_load_dwordx4 v2, s[8:11], s76 offen offset:128 sc1 lds
  s_add_u32 m0, s77, 2880
  s_nop 0
  buffer_load_dwordx4 v2, s[8:11], s76 offen offset:192 sc1 lds
  s_waitcnt vmcnt(0)
  s_branch FG_GO_48
FG_HAVE_47:
  s_waitcnt vmcnt(4)
FG_GO_48:
  buffer_load_dword v5, v3, s[8:11], s85 offen sc1
  s_waitcnt lgkmcnt(0)
  s_barrier
  v_add_u32 v9, s86, v1
  ds_read_b128 v[48:51], v9 offset:0
  ds_read_b128 v[52:55], v9 offset:1024
  ds_read_b128 v[56:59], v9 offset:2048
  ds_read_b128 v[60:63], v9 offset:3072
  ds_read_b128 v[64:67], v9 offset:4096
  ds_read_b128 v[68:71], v9 offset:5120
  ds_read_b128 v[72:75], v9 offset:6144
  ds_read_b128 v[76:79], v9 offset:7168
  s_waitcnt lgkmcnt(7)
  v_mfma_f32_16x16x32_bf16 v[16:19], a[0:3], v[48:51], 0
  v_mfma_f32_16x16x32_bf16 v[20:23], a[64:67], v[48:51], 0
  v_mfma_f32_16x16x32_bf16 v[24:27], a[128:131], v[48:51], 0
  v_mfma_f32_16x16x32_bf16 v[28:31], a[192:195], v[48:51], 0
  ds_read_b128 v[48:51], v9 offset:8192
  s_waitcnt lgkmcnt(7)
  v_mfma_f32_16x16x32_bf16 v[16:19], a[4:7], v[52:55], v[16:19]
  v_mfma_f32_16x16x32_bf16 v[20:23], a[68:71], v[52:55], v[20:23]
  v_mfma_f32_16x16x32_bf16 v[24:27], a[132:135], v[52:55], v[24:27]
  v_mfma_f32_16x16x32_bf16 v[28:31], a[196:199], v[52:55], v[28:31]
  ds_read_b128 v[52:55], v9 offset:9216
  s_waitcnt lgkmcnt(7)
  v_mfma_f32_16x16x32_bf16 v[16:19], a[8:11], v[56:59], v[16:19]
  v_mfma_f32_16x16x32_bf16 v[20:23], a[72:75], v[56:59], v[20:23]
  v_mfma_f32_16x16x32_bf16 v[24:27], a[136:139], v[56:59], v[24:27]
  v_mfma_f32_16x16x32_bf16 v[28:31], a[200:203], v[56:59], v[28:31]
  ds_read_b128 v[56:59], v9 offset:10240
  s_waitcnt lgkmcnt(7)
  v_mfma_f32_16x16x32_bf16 v[16:19], a[12:15], v[60:63], v[16:19]
  v_mfma_f32_16x16x32_bf16 v[20:23], a[76:79], v[60:63], v[20:23]
  v_mfma_f32_16x16x32_bf16 v[24:27], a[140:143], v[60:63], v[24:27]
  v_mfma_f32_16x16x32_bf16 v[28:31], a[204:207], v[60:63], v[28:31]
  ds_read_b128 v[60:63], v9 offset:11264
  s_waitcnt lgkmcnt(7)
  v_mfma_f32_16x16x32_bf16 v[16:19], a[16:19], v[64:67], v[16:19]
  v_mfma_f32_16x16x32_bf16 v[20:23], a[80:83], v[64:67], v[20:23]
  v_mfma_f32_16x16x32_bf16 v[24:27], a[144:147], v[64:67], v[24:27]
  v_mfma_f32_16x16x32_bf16 v[28:31], a[208:211], v[64:67], v[28:31]
  ds_read_b128 v[64:67], v9 offset:12288
  s_waitcnt lgkmcnt(7)
  v_mfma_f32_16x16x32_bf16 v[16:19], a[20:23], v[68:71], v[16:19]
  v_mfma_f32_16x16x32_bf16 v[20:23], a[84:87], v[68:71], v[20:23]
  v_mfma_f32_16x16x32_bf16 v[24:27], a[148:151], v[68:71], v[24:27]
  v_mfma_f32_16x16x32_bf16 v[28:31], a[212:215], v[68:71], v[28:31]
  ds_read_b128 v[68:71], v9 offset:13312
  s_waitcnt lgkmcnt(7)
  v_mfma_f32_16x16x32_bf16 v[16:19], a[24:27], v[72:75], v[16:19]
  v_mfma_f32_16x16x32_bf16 v[20:23], a[88:91], v[72:75], v[20:23]
  v_mfma_f32_16x16x32_bf16 v[24:27], a[152:155], v[72:75], v[24:27]
  v_mfma_f32_16x16x32_bf16 v[28:31], a[216:219], v[72:75], v[28:31]
  ds_read_b128 v[72:75], v9 offset:14336
  s_waitcnt lgkmcnt(7)
  v_mfma_f32_16x16x32_bf16 v[16:19], a[28:31], v[76:79], v[16:19]
  v_mfma_f32_16x16x32_bf16 v[20:23], a[92:95], v[76:79], v[20:23]
  v_mfma_f32_16x16x32_bf16 v[24:27], a[156:159], v[76:79], v[24:27]
  v_mfma_f32_16x16x32_bf16 v[28:31], a[220:223], v[76:79], v[28:31]
  ds_read_b128 v[76:79], v9 offset:15360
  s_waitcnt vmcnt(0)
  s_mov_b64 exec, 1
  buffer_store_dword v4, v7, s[8:11], s92 offen sc1
  s_mov_b64 exec, -1
  s_mov_b32 s92, 268435456
  v_cmp_eq_u32 vcc, 0, v5
  s_mov_b32 s93, 0
  s_cbranch_vccnz FG_NOPF_51
  s_mov_b32 s93, 1
  s_lshl_b32 s76, s87, 15
  s_add_u32 s76, s76, 38830080
  s_lshl_b32 s77, s91, 14
  s_add_u32 s76, s76, s77
  s_lshl_b32 s77, s16, 8
  s_add_u32 s76, s76, s77
  s_xor_b32 s77, s86, 16384
  s_lshl_b32 s78, s16, 12
  s_add_u32 s77, s77, s78
  s_add_u32 m0, s77, 0
  s_nop 0
  buffer_load_dwordx4 v2, s[8:11], s76 offen offset:0 sc1 lds
  s_add_u32 m0, s77, 960
  s_nop 0
  buffer_load_dwordx4 v2, s[8:11], s76 offen offset:64 sc1 lds
  s_add_u32 m0, s77, 1920
  s_nop 0
  buffer_load_dwordx4 v2, s[8:11], s76 offen offset:128 sc1 lds
  s_add_u32 m0, s77, 2880
  s_nop 0
  buffer_load_dwordx4 v2, s[8:11], s76 offen offset:192 sc1 lds
FG_NOPF_51:
  s_waitcnt lgkmcnt(7)
  v_mfma_f32_16x16x32_bf16 v[16:19], a[32:35], v[48:51], v[16:19]
  s_mul_i32 s76, s73, 524288
  s_add_u32 s76, s76, 43024384
  s_lshl_b32 s92, s73, 9
  v_mfma_f32_16x16x32_bf16 v[20:23], a[96:99], v[48:51], v[20:23]
  s_add_u32 s92, s92, 24608768
  v_mfma_f32_16x16x32_bf16 v[24:27], a[160:163], v[48:51], v[24:27]
  v_mfma_f32_16x16x32_bf16 v[28:31], a[224:227], v[48:51], v[28:31]
  s_waitcnt lgkmcnt(6)
  v_mfma_f32_16x16x32_bf16 v[16:19], a[36:39], v[52:55], v[16:19]
  v_mfma_f32_16x16x32_bf16 v[20:23], a[100:103], v[52:55], v[20:23]
  v_mfma_f32_16x16x32_bf16 v[24:27], a[164:167], v[52:55], v[24:27]
  v_mfma_f32_16x16x32_bf16 v[28:31], a[228:231], v[52:55], v[28:31]
  s_waitcnt lgkmcnt(5)
  v_mfma_f32_16x16x32_bf16 v[16:19], a[40:43], v[56:59], v[16:19]
  v_mfma_f32_16x16x32_bf16 v[20:23], a[104:107], v[56:59], v[20:23]
  v_mfma_f32_16x16x32_bf16 v[24:27], a[168:171], v[56:59], v[24:27]
  v_mfma_f32_16x16x32_bf16 v[28:31], a[232:235], v[56:59], v[28:31]
  s_waitcnt lgkmcnt(4)
  v_mfma_f32_16x16x32_bf16 v[16:19], a[44:47], v[60:63], v[16:19]
  v_mfma_f32_16x16x32_bf16 v[20:23], a[108:111], v[60:63], v[20:23]
  v_mfma_f32_16x16x32_bf16 v[24:27], a[172:175], v[60:63], v[24:27]
  v_mfma_f32_16x16x32_bf16 v[28:31], a[236:239], v[60:63], v[28:31]
  s_waitcnt lgkmcnt(3)
  v_mfma_f32_16x16x32_bf16 v[16:19], a[48:51], v[64:67], v[16:19]
  v_mfma_f32_16x16x32_bf16 v[20:23], a[112:115], v[64:67], v[20:23]
  v_mfma_f32_16x16x32_bf16 v[24:27], a[176:179], v[64:67], v[24:27]
  v_mfma_f32_16x16x32_bf16 v[28:31], a[240:243], v[64:67], v[28:31]
  s_waitcnt lgkmcnt(2)
  v_mfma_f32_16x16x32_bf16 v[16:19], a[52:55], v[68:71], v[16:19]
  v_mfma_f32_16x16x32_bf16 v[20:23], a[116:119], v[68:71], v[20:23]
  v_mfma_f32_16x16x32_bf16 v[24:27], a[180:183], v[68:71], v[24:27]
  v_mfma_f32_16x16x32_bf16 v[28:31], a[244:247], v[68:71], v[28:31]
  s_waitcnt lgkmcnt(1)
  v_mfma_f32_16x16x32_bf16 v[16:19], a[56:59], v[72:75], v[16:19]
  v_mfma_f32_16x16x32_bf16 v[20:23], a[120:123], v[72:75], v[20:23]
  v_mfma_f32_16x16x32_bf16 v[24:27], a[184:187], v[72:75], v[24:27]
  v_mfma_f32_16x16x32_bf16 v[28:31], a[248:251], v[72:75], v[28:31]
  s_waitcnt lgkmcnt(0)
  v_mfma_f32_16x16x32_bf16 v[16:19], a[60:63], v[76:79], v[16:19]
  v_mfma_f32_16x16x32_bf16 v[20:23], a[124:127], v[76:79], v[20:23]
  v_mfma_f32_16x16x32_bf16 v[24:27], a[188:191], v[76:79], v[24:27]
  v_mfma_f32_16x16x32_bf16 v[28:31], a[252:255], v[76:79], v[28:31]
  s_nop 4
  v_cvt_pk_bf16_f32 v80, v16, v17
  v_cvt_pk_bf16_f32 v88, v18, v19
  v_and_b32 v17, 0xffff0000, v80
  v_and_b32 v19, 0xffff0000, v88
  v_lshlrev_b32 v16, 16, v80
  v_lshlrev_b32 v18, 16, v88
  v_mul_f32 v82, 0xbfb8aa3b, v16
  v_mul_f32 v83, 0xbfb8aa3b, v17
  v_mul_f32 v90, 0xbfb8aa3b, v18
  v_mul_f32 v91, 0xbfb8aa3b, v19
  v_exp_f32 v82, v82
  v_exp_f32 v83, v83
  v_exp_f32 v90, v90
  v_exp_f32 v91, v91
  v_add_f32 v82, 1.0, v82
  v_add_f32 v83, 1.0, v83
  v_add_f32 v90, 1.0, v90
  v_add_f32 v91, 1.0, v91
  v_rcp_f32 v82, v82
  v_rcp_f32 v83, v83
  v_rcp_f32 v90, v90
  v_rcp_f32 v91, v91
  v_mul_f32 v16, v16, v82
  v_mul_f32 v17, v17, v83
  v_mul_f32 v18, v18, v90
  v_mul_f32 v19, v19, v91
  v_cvt_pk_bf16_f32 v80, v16, v17
  v_cvt_pk_bf16_f32 v88, v18, v19
  v_lshlrev_b32 v16, 16, v80
  v_and_b32 v17, 0xffff0000, v80
  v_lshlrev_b32 v18, 16, v88
  v_and_b32 v19, 0xffff0000, v88
  v_cvt_pk_bf16_f32 v80, v20, v21
  v_cvt_pk_bf16_f32 v88, v22, v23
  v_and_b32 v21, 0xffff0000, v80
  v_and_b32 v23, 0xffff0000, v88
  v_lshlrev_b32 v20, 16, v80
  v_lshlrev_b32 v22, 16, v88
  v_mul_f32 v82, 0xbfb8aa3b, v20
  v_mul_f32 v83, 0xbfb8aa3b, v21
  v_mul_f32 v90, 0xbfb8aa3b, v22
  v_mul_f32 v91, 0xbfb8aa3b, v23
  v_exp_f32 v82, v82
  v_exp_f32 v83, v83
  v_exp_f32 v90, v90
  v_exp_f32 v91, v91
  v_add_f32 v82, 1.0, v82
  v_add_f32 v83, 1.0, v83
  v_add_f32 v90, 1.0, v90
  v_add_f32 v91, 1.0, v91
  v_rcp_f32 v82, v82
  v_rcp_f32 v83, v83
  v_rcp_f32 v90, v90
  v_rcp_f32 v91, v91
  v_cvt_pk_bf16_f32 v81, v24, v25
  v_cvt_pk_bf16_f32 v89, v26, v27
  v_mul_f32 v20, v20, v82
  v_mul_f32 v21, v21, v83
  v_mul_f32 v22, v22, v90
  v_mul_f32 v23, v23, v91
  v_lshlrev_b32 v24, 16, v81
  v_and_b32 v25, 0xffff0000, v81
  v_lshlrev_b32 v26, 16, v89
  v_and_b32 v27, 0xffff0000, v89
  v_cvt_pk_bf16_f32 v81, v28, v29
  v_cvt_pk_bf16_f32 v80, v20, v21
  v_cvt_pk_bf16_f32 v89, v30, v31
  v_cvt_pk_bf16_f32 v88, v22, v23
  v_and_b32 v29, 0xffff0000, v81
  v_and_b32 v21, 0xffff0000, v80
  v_and_b32 v31, 0xffff0000, v89
  v_and_b32 v23, 0xffff0000, v88
  v_lshlrev_b32 v28, 16, v81
  v_lshlrev_b32 v20, 16, v80
  v_lshlrev_b32 v30, 16, v89
  v_lshlrev_b32 v22, 16, v88
  v_mul_f32 v16, v16, v24
  v_mul_f32 v17, v17, v25
  v_mul_f32 v18, v18, v26
  v_mul_f32 v19, v19, v27
  v_mul_f32 v20, v20, v28
  v_mul_f32 v21, v21, v29
  v_mul_f32 v22, v22, v30
  v_mul_f32 v23, v23, v31
  v_cvt_pk_bf16_f32 v96, v16, v17
  v_cvt_pk_bf16_f32 v97, v18, v19
  v_cvt_pk_bf16_f32 v98, v20, v21
  v_cvt_pk_bf16_f32 v99, v22, v23
  ds_write_b128 v8, v[96:99]
  s_waitcnt lgkmcnt(0)
  s_barrier
  ds_read_b128 v[104:107], v10 offset:0
  ds_read_b128 v[108:111], v10 offset:1024
  ds_read_b128 v[112:115], v10 offset:2048
  ds_read_b128 v[116:119], v10 offset:3072
  s_waitcnt lgkmcnt(3)
  v_mfma_f32_16x16x32_bf16 v[32:35], v[128:131], v[104:107], 0
  v_mfma_f32_16x16x32_bf16 v[36:39], v[144:147], v[104:107], 0
  s_waitcnt lgkmcnt(2)
  v_mfma_f32_16x16x32_bf16 v[32:35], v[132:135], v[108:111], v[32:35]
  v_mfma_f32_16x16x32_bf16 v[36:39], v[148:151], v[108:111], v[36:39]
  s_waitcnt lgkmcnt(1)
  v_mfma_f32_16x16x32_bf16 v[32:35], v[136:139], v[112:115], v[32:35]
  v_mfma_f32_16x16x32_bf16 v[36:39], v[152:155], v[112:115], v[36:39]
  s_waitcnt lgkmcnt(0)
  v_mfma_f32_16x16x32_bf16 v[32:35], v[140:143], v[116:119], v[32:35]
  v_mfma_f32_16x16x32_bf16 v[36:39], v[156:159], v[116:119], v[36:39]
  v_mfma_f32_16x16x32_bf16 v[40:43], v[160:163], v[104:107], 0
  v_mfma_f32_16x16x32_bf16 v[44:47], v[176:179], v[104:107], 0
  s_nop 4
  v_cvt_pk_bf16_f32 v120, v32, v33
  v_mfma_f32_16x16x32_bf16 v[40:43], v[164:167], v[108:111], v[40:43]
  v_cvt_pk_bf16_f32 v121, v34, v35
  v_mfma_f32_16x16x32_bf16 v[44:47], v[180:183], v[108:111], v[44:47]
  v_cvt_pk_bf16_f32 v122, v36, v37
  v_mfma_f32_16x16x32_bf16 v[40:43], v[168:171], v[112:115], v[40:43]
  v_cvt_pk_bf16_f32 v123, v38, v39
  v_mfma_f32_16x16x32_bf16 v[44:47], v[184:187], v[112:115], v[44:47]
  buffer_store_dwordx4 v[120:123], v6, s[8:11], s76 offen offset:0 sc1
  v_mfma_f32_16x16x32_bf16 v[40:43], v[172:175], v[116:119], v[40:43]
  v_mfma_f32_16x16x32_bf16 v[44:47], v[188:191], v[116:119], v[44:47]
  v_mfma_f32_16x16x32_bf16 v[48:51], v[192:195], v[104:107], 0
  v_mfma_f32_16x16x32_bf16 v[52:55], v[208:211], v[104:107], 0
  s_nop 4
  v_cvt_pk_bf16_f32 v124, v40, v41
  v_mfma_f32_16x16x32_bf16 v[48:51], v[196:199], v[108:111], v[48:51]
  v_cvt_pk_bf16_f32 v125, v42, v43
  v_mfma_f32_16x16x32_bf16 v[52:55], v[212:215], v[108:111], v[52:55]
  v_cvt_pk_bf16_f32 v126, v44, v45
  v_mfma_f32_16x16x32_bf16 v[48:51], v[200:203], v[112:115], v[48:51]
  v_cvt_pk_bf16_f32 v127, v46, v47
  v_mfma_f32_16x16x32_bf16 v[52:55], v[216:219], v[112:115], v[52:55]
  buffer_store_dwordx4 v[124:127], v6, s[8:11], s76 offen offset:64 sc1
  v_mfma_f32_16x16x32_bf16 v[48:51], v[204:207], v[116:119], v[48:51]
  v_mfma_f32_16x16x32_bf16 v[52:55], v[220:223], v[116:119], v[52:55]
  v_mfma_f32_16x16x32_bf16 v[56:59], v[224:227], v[104:107], 0
  v_mfma_f32_16x16x32_bf16 v[60:63], v[240:243], v[104:107], 0
  s_nop 4
  v_cvt_pk_bf16_f32 v120, v48, v49
  v_mfma_f32_16x16x32_bf16 v[56:59], v[228:231], v[108:111], v[56:59]
  v_cvt_pk_bf16_f32 v121, v50, v51
  v_mfma_f32_16x16x32_bf16 v[60:63], v[244:247], v[108:111], v[60:63]
  v_cvt_pk_bf16_f32 v122, v52, v53
  v_mfma_f32_16x16x32_bf16 v[56:59], v[232:235], v[112:115], v[56:59]
  v_cvt_pk_bf16_f32 v123, v54, v55
  v_mfma_f32_16x16x32_bf16 v[60:63], v[248:251], v[112:115], v[60:63]
  buffer_store_dwordx4 v[120:123], v6, s[8:11], s76 offen offset:128 sc1
  v_mfma_f32_16x16x32_bf16 v[56:59], v[236:239], v[116:119], v[56:59]
  v_mfma_f32_16x16x32_bf16 v[60:63], v[252:255], v[116:119], v[60:63]
  s_nop 6
  v_cvt_pk_bf16_f32 v124, v56, v57
  v_cvt_pk_bf16_f32 v125, v58, v59
  v_cvt_pk_bf16_f32 v126, v60, v61
  v_cvt_pk_bf16_f32 v127, v62, v63
  buffer_store_dwordx4 v[124:127], v6, s[8:11], s76 offen offset:192 sc1
  s_xor_b32 s86, s86, 16384
  s_add_u32 s72, s72, 1
  s_cmp_lt_u32 s72, 64
  s_cbranch_scc1 F_LOOPG
  s_waitcnt vmcnt(0)
  s_mov_b64 exec, 1
  buffer_store_dword v4, v7, s[8:11], s92 offen sc1
  s_mov_b64 exec, -1
  s_mov_b32 s92, 268435456
  s_endpgm
ROLE_R:
  s_call_b64 s[100:101], VERIFY
  s_cbranch_scc1 VER_OK_52
  v_mov_b32 v0, v116
  s_waitcnt vmcnt(0) lgkmcnt(0)
  s_barrier
  s_branch DISPATCH
VER_OK_52:
  v_and_b32 v14, 63, v0
  v_and_b32 v15, 15, v14
  v_lshrrev_b32 v13, 4, v14
  v_lshrrev_b32 v12, 1, v13
  v_and_b32 v7, 1, v13
  v_lshlrev_b32 v1, 10, v12
  v_lshl_add_u32 v1, v7, 15, v1
  v_lshl_add_u32 v1, v15, 4, v1
  v_lshlrev_b32 v5, 10, v12
  v_lshl_add_u32 v5, v15, 4, v5
  v_lshl_add_u32 v5, v7, 3, v5
  v_mov_b32 v3, 1
  v_and_b32 v6, 1, v14
  v_lshlrev_b32 v6, 2, v6
  v_lshrrev_b32 v0, 3, v15
  v_cmp_eq_u32 vcc, v0, v12
  v_and_b32 v0, 1, v15
  v_lshlrev_b32 v0, 4, v0
  v_mov_b32 v4, 0x3f80
  v_lshlrev_b32 v4, v0, v4
  v_cndmask_b32 v4, 0, v4, vcc
  v_and_b32 v0, 7, v15
  v_lshrrev_b32 v0, 1, v0
  v_cmp_eq_u32 vcc, 0, v0
  s_nop 1
  v_cndmask_b32 v8, 0, v4, vcc
  v_cmp_eq_u32 vcc, 1, v0
  s_nop 1
  v_cndmask_b32 v9, 0, v4, vcc
  v_cmp_eq_u32 vcc, 2, v0
  s_nop 1
  v_cndmask_b32 v10, 0, v4, vcc
  v_cmp_eq_u32 vcc, 3, v0
  s_nop 1
  v_cndmask_b32 v11, 0, v4, vcc
  s_load_dwordx2 s[78:79], s[0:1], 0
  s_load_dwordx2 s[80:81], s[0:1], 88
  s_waitcnt lgkmcnt(0)
  s_mov_b32 s84, s78
  s_and_b32 s85, s79, 0xffff
  s_mov_b32 s86, 2097152
  s_mov_b32 s87, 0x20000
  s_mov_b32 s88, s80
  s_and_b32 s89, s81, 0xffff
  s_mov_b32 s90, 2097152
  s_mov_b32 s91, 0x20000
  s_lshr_b32 s71, s17, 6
  s_and_b32 s72, s17, 63
  s_mov_b32 s92, 268435456
  s_and_b32 s75, s71, 1
  s_cmp_ge_u32 s71, 2
  s_cbranch_scc1 R2_START
R1_START:
  v_lshlrev_b32 v2, 2, v14
R1_LOOP:
  s_lshr_b32 s76, s72, 4
  s_and_b32 s73, s72, 15
  s_lshl_b32 s73, s73, 1
  s_lshl_b32 s74, s75, 6
  s_add_u32 s74, s74, s76
  s_lshl_b32 s78, s74, 8
  s_add_u32 s78, s78, 24444928
  s_lshl_b32 s80, s74, 5
  s_add_u32 s80, s80, s73
  s_lshl_b32 s80, s80, 10
R1_FS:
  buffer_load_dword v4, v2, s[8:11], s78 offen sc1
  s_waitcnt vmcnt(0)
  s_mov_b64 exec, 1
  buffer_store_dword v3, v6, s[8:11], s92 offen sc1
  s_mov_b64 exec, -1
  s_mov_b32 s92, 268435456
  v_cmp_eq_u32 vcc, 0, v4
  s_nop 0
  s_cbranch_vccz R1_FO
  s_cmp_eq_u32 s19, 0
  s_cbranch_scc1 R1_FO
  s_sub_u32 s19, s19, 1
  s_branch R1_FS
R1_FO:
  s_lshl_b32 s78, s74, 18
  s_add_u32 s78, s78, 177242112
  s_lshl_b32 s79, s73, 10
  s_add_u32 s78, s78, s79
  buffer_load_dwordx4 v[32:35], v1, s[8:11], s78 offen offset:0 sc1
  buffer_load_dwordx4 v[36:39], v1, s[8:11], s78 offen offset:256 sc1
  buffer_load_dwordx4 v[40:43], v1, s[8:11], s78 offen offset:512 sc1
  buffer_load_dwordx4 v[44:47], v1, s[8:11], s78 offen offset:768 sc1
  s_add_u32 s78, s78, 65536
  buffer_load_dwordx4 v[48:51], v1, s[8:11], s78 offen offset:0 sc1
  buffer_load_dwordx4 v[52:55], v1, s[8:11], s78 offen offset:256 sc1
  buffer_load_dwordx4 v[56:59], v1, s[8:11], s78 offen offset:512 sc1
  buffer_load_dwordx4 v[60:63], v1, s[8:11], s78 offen offset:768 sc1
  s_add_u32 s78, s78, 65536
  buffer_load_dwordx4 v[64:67], v1, s[8:11], s78 offen offset:0 sc1
  buffer_load_dwordx4 v[68:71], v1, s[8:11], s78 offen offset:256 sc1
  buffer_load_dwordx4 v[72:75], v1, s[8:11], s78 offen offset:512 sc1
  buffer_load_dwordx4 v[76:79], v1, s[8:11], s78 offen offset:768 sc1
  s_add_u32 s78, s78, 65536
  buffer_load_dwordx4 v[80:83], v1, s[8:11], s78 offen offset:0 sc1
  buffer_load_dwordx4 v[84:87], v1, s[8:11], s78 offen offset:256 sc1
  buffer_load_dwordx4 v[88:91], v1, s[8:11], s78 offen offset:512 sc1
  buffer_load_dwordx4 v[92:95], v1, s[8:11], s78 offen offset:768 sc1
  s_cmp_eq_u32 s75, 0
  s_cbranch_scc0 R1_RES2
  buffer_load_dwordx2 v[160:161], v5, s[84:87], s80 offen offset:0
  buffer_load_dwordx2 v[162:163], v5, s[84:87], s80 offen offset:256
  buffer_load_dwordx2 v[164:165], v5, s[84:87], s80 offen offset:512
  buffer_load_dwordx2 v[166:167], v5, s[84:87], s80 offen offset:768
  s_branch R1_RESD
R1_RES2:
  s_add_u32 s78, s80, 30441472
  buffer_load_dwordx2 v[160:161], v5, s[8:11], s78 offen offset:0 sc1
  buffer_load_dwordx2 v[162:163], v5, s[8:11], s78 offen offset:256 sc1
  buffer_load_dwordx2 v[164:165], v5, s[8:11], s78 offen offset:512 sc1
  buffer_load_dwordx2 v[166:167], v5, s[8:11], s78 offen offset:768 sc1
R1_RESD:
  s_waitcnt vmcnt(0)
  s_add_u32 s78, s80, 34635776
  s_add_u32 s79, s80, 38830080
  v_mfma_f32_16x16x32_bf16 v[144:147], v[8:11], v[32:35], 0
  v_and_b32 v169, 0xffff0000, v160
  v_mfma_f32_16x16x32_bf16 v[148:151], v[8:11], v[36:39], 0
  v_and_b32 v171, 0xffff0000, v161
  v_mfma_f32_16x16x32_bf16 v[152:155], v[8:11], v[40:43], 0
  v_lshlrev_b32 v168, 16, v160
  v_lshlrev_b32 v170, 16, v161
  v_mfma_f32_16x16x32_bf16 v[144:147], v[8:11], v[48:51], v[144:147]
  v_and_b32 v173, 0xffff0000, v162
  v_mfma_f32_16x16x32_bf16 v[148:151], v[8:11], v[52:55], v[148:151]
  v_lshlrev_b32 v172, 16, v162
  v_and_b32 v175, 0xffff0000, v163
  v_mfma_f32_16x16x32_bf16 v[156:159], v[8:11], v[44:47], 0
  v_lshlrev_b32 v174, 16, v163
  v_and_b32 v177, 0xffff0000, v164
  v_mfma_f32_16x16x32_bf16 v[152:155], v[8:11], v[56:59], v[152:155]
  v_lshlrev_b32 v176, 16, v164
  v_and_b32 v179, 0xffff0000, v165
  v_mfma_f32_16x16x32_bf16 v[144:147], v[8:11], v[64:67], v[144:147]
  v_lshlrev_b32 v178, 16, v165
  v_and_b32 v181, 0xffff0000, v166
  v_mfma_f32_16x16x32_bf16 v[148:151], v[8:11], v[68:71], v[148:151]
  v_lshlrev_b32 v180, 16, v166
  v_and_b32 v183, 0xffff0000, v167
  v_mfma_f32_16x16x32_bf16 v[156:159], v[8:11], v[60:63], v[156:159]
  v_lshlrev_b32 v182, 16, v167
  v_mfma_f32_16x16x32_bf16 v[152:155], v[8:11], v[72:75], v[152:155]
  v_mfma_f32_16x16x32_bf16 v[144:147], v[8:11], v[80:83], v[144:147]
  v_mfma_f32_16x16x32_bf16 v[148:151], v[8:11], v[84:87], v[148:151]
  v_mfma_f32_16x16x32_bf16 v[156:159], v[8:11], v[76:79], v[156:159]
  v_mfma_f32_16x16x32_bf16 v[152:155], v[8:11], v[88:91], v[152:155]
  s_nop 4
  v_cvt_pk_bf16_f32 v184, v144, v145
  v_mfma_f32_16x16x32_bf16 v[156:159], v[8:11], v[92:95], v[156:159]
  v_cvt_pk_bf16_f32 v185, v146, v147
  v_cvt_pk_bf16_f32 v186, v148, v149
  v_and_b32 v145, 0xffff0000, v184
  v_and_b32 v147, 0xffff0000, v185
  v_cvt_pk_bf16_f32 v187, v150, v151
  v_lshlrev_b32 v144, 16, v184
  v_lshlrev_b32 v146, 16, v185
  v_and_b32 v149, 0xffff0000, v186
  v_cvt_pk_bf16_f32 v188, v152, v153
  v_lshlrev_b32 v148, 16, v186
  v_add_f32 v144, v144, v168
  v_add_f32 v145, v145, v169
  v_add_f32 v146, v146, v170
  v_add_f32 v147, v147, v171
  v_and_b32 v151, 0xffff0000, v187
  v_cvt_pk_bf16_f32 v189, v154, v155
  v_lshlrev_b32 v150, 16, v187
  v_add_f32 v148, v148, v172
  v_add_f32 v149, v149, v173
  v_cvt_pk_bf16_f32 v184, v144, v145
  v_cvt_pk_bf16_f32 v185, v146, v147
  v_and_b32 v153, 0xffff0000, v188
  v_cvt_pk_bf16_f32 v190, v156, v157
  v_lshlrev_b32 v152, 16, v188
  v_add_f32 v150, v150, v174
  v_add_f32 v151, v151, v175
  v_cvt_pk_bf16_f32 v186, v148, v149
  v_and_b32 v155, 0xffff0000, v189
  v_and_b32 v145, 0xffff0000, v184
  v_and_b32 v147, 0xffff0000, v185
  v_cvt_pk_bf16_f32 v191, v158, v159
  v_lshlrev_b32 v154, 16, v189
  v_add_f32 v152, v152, v176
  v_add_f32 v153, v153, v177
  v_cvt_pk_bf16_f32 v187, v150, v151
  v_lshlrev_b32 v144, 16, v184
  v_lshlrev_b32 v146, 16, v185
  v_and_b32 v157, 0xffff0000, v190
  v_and_b32 v149, 0xffff0000, v186
  v_lshlrev_b32 v156, 16, v190
  v_add_f32 v154, v154, v178
  v_add_f32 v155, v155, v179
  v_cvt_pk_bf16_f32 v188, v152, v153
  v_lshlrev_b32 v148, 16, v186
  v_add_f32 v200, v144, v145
  v_add_f32 v201, v146, v147
  v_and_b32 v159, 0xffff0000, v191
  v_and_b32 v151, 0xffff0000, v187
  v_lshlrev_b32 v158, 16, v191
  v_add_f32 v156, v156, v180
  v_add_f32 v157, v157, v181
  v_cvt_pk_bf16_f32 v189, v154, v155
  v_lshlrev_b32 v150, 16, v187
  v_add_f32 v200, v200, v148
  v_add_f32 v201, v201, v149
  v_and_b32 v153, 0xffff0000, v188
  v_add_f32 v158, v158, v182
  v_add_f32 v159, v159, v183
  v_cvt_pk_bf16_f32 v190, v156, v157
  v_lshlrev_b32 v152, 16, v188
  v_add_f32 v200, v200, v150
  v_add_f32 v201, v201, v151
  v_and_b32 v155, 0xffff0000, v189
  v_cvt_pk_bf16_f32 v191, v158, v159
  v_lshlrev_b32 v154, 16, v189
  v_add_f32 v200, v200, v152
  v_add_f32 v201, v201, v153
  v_and_b32 v157, 0xffff0000, v190
  v_lshlrev_b32 v156, 16, v190
  v_add_f32 v200, v200, v154
  v_add_f32 v201, v201, v155
  v_and_b32 v159, 0xffff0000, v191
  v_lshlrev_b32 v158, 16, v191
  v_add_f32 v200, v200, v156
  v_add_f32 v201, v201, v157
  v_add_f32 v200, v200, v158
  v_add_f32 v201, v201, v159
  v_add_f32 v200, v200, v201
  buffer_store_dwordx2 v[184:185], v5, s[8:11], s78 offen offset:0 sc1
  s_nop 0
  v_add_f32_dpp v200, v200, v200 row_ror:8 row_mask:0xf bank_mask:0xf
  s_nop 1
  v_add_f32_dpp v200, v200, v200 row_ror:4 row_mask:0xf bank_mask:0xf
  s_nop 1
  v_add_f32_dpp v200, v200, v200 row_ror:2 row_mask:0xf bank_mask:0xf
  s_nop 1
  v_add_f32_dpp v200, v200, v200 row_ror:1 row_mask:0xf bank_mask:0xf
  v_mov_b32 v201, v200
  buffer_store_dwordx2 v[186:187], v5, s[8:11], s78 offen offset:256 sc1
  s_nop 0
  v_permlane16_swap_b32 v200, v201
  v_add_f32 v200, v200, v201
  v_mul_f32 v202, 0x3b000000, v200
  v_sub_f32 v168, v144, v202
  v_sub_f32 v169, v145, v202
  v_sub_f32 v170, v146, v202
  v_sub_f32 v171, v147, v202
  v_mul_f32 v203, v168, v168
  v_mul_f32 v201, v169, v169
  v_sub_f32 v172, v148, v202
  v_sub_f32 v173, v149, v202
  v_fmac_f32 v203, v170, v170
  v_fmac_f32 v201, v171, v171
  v_sub_f32 v174, v150, v202
  v_sub_f32 v175, v151, v202
  v_fmac_f32 v203, v172, v172
  v_fmac_f32 v201, v173, v173
  v_sub_f32 v176, v152, v202
  v_sub_f32 v177, v153, v202
  v_fmac_f32 v203, v174, v174
  v_fmac_f32 v201, v175, v175
  v_sub_f32 v178, v154, v202
  v_sub_f32 v179, v155, v202
  v_fmac_f32 v203, v176, v176
  v_fmac_f32 v201, v177, v177
  v_sub_f32 v180, v156, v202
  v_sub_f32 v181, v157, v202
  v_fmac_f32 v203, v178, v178
  v_fmac_f32 v201, v179, v179
  v_sub_f32 v182, v158, v202
  v_sub_f32 v183, v159, v202
  v_fmac_f32 v203, v180, v180
  v_fmac_f32 v201, v181, v181
  v_fmac_f32 v203, v182, v182
  v_fmac_f32 v201, v183, v183
  v_add_f32 v203, v203, v201
  v_cvt_pk_bf16_f32 v202, v202, v202
  s_nop 0
  v_add_f32_dpp v203, v203, v203 row_ror:8 row_mask:0xf bank_mask:0xf
  v_lshlrev_b32 v202, 16, v202
  v_sub_f32 v144, v144, v202
  v_add_f32_dpp v203, v203, v203 row_ror:4 row_mask:0xf bank_mask:0xf
  v_sub_f32 v145, v145, v202
  v_sub_f32 v146, v146, v202
  v_add_f32_dpp v203, v203, v203 row_ror:2 row_mask:0xf bank_mask:0xf
  v_sub_f32 v147, v147, v202
  v_sub_f32 v148, v148, v202
  v_add_f32_dpp v203, v203, v203 row_ror:1 row_mask:0xf bank_mask:0xf
  v_mov_b32 v201, v203
  v_sub_f32 v149, v149, v202
  v_sub_f32 v150, v150, v202
  v_permlane16_swap_b32 v203, v201
  v_add_f32 v203, v203, v201
  v_mul_f32 v203, 0x3b000000, v203
  v_cvt_pk_bf16_f32 v203, v203, v203
  v_lshlrev_b32 v203, 16, v203
  v_add_f32 v203, 0x3727c5ac, v203
  v_cvt_pk_bf16_f32 v203, v203, v203
  v_lshlrev_b32 v203, 16, v203
  v_sqrt_f32 v203, v203
  v_sub_f32 v151, v151, v202
  v_cvt_pk_bf16_f32 v203, v203, v203
  v_lshlrev_b32 v203, 16, v203
  v_sub_f32 v152, v152, v202
  v_sub_f32 v153, v153, v202
  v_sub_f32 v154, v154, v202
  v_sub_f32 v155, v155, v202
  v_sub_f32 v156, v156, v202
  v_sub_f32 v157, v157, v202
  v_sub_f32 v158, v158, v202
  v_sub_f32 v159, v159, v202
  v_rcp_f32 v203, v203
  v_cvt_pk_bf16_f32 v192, v144, v145
  v_cvt_pk_bf16_f32 v193, v146, v147
  v_cvt_pk_bf16_f32 v194, v148, v149
  v_cvt_pk_bf16_f32 v195, v150, v151
  v_cvt_pk_bf16_f32 v196, v152, v153
  v_cvt_pk_bf16_f32 v197, v154, v155
  v_cvt_pk_bf16_f32 v198, v156, v157
  v_cvt_pk_bf16_f32 v199, v158, v159
  v_and_b32 v145, 0xffff0000, v192
  v_and_b32 v147, 0xffff0000, v193
  v_and_b32 v149, 0xffff0000, v194
  v_and_b32 v151, 0xffff0000, v195
  v_and_b32 v153, 0xffff0000, v196
  v_and_b32 v155, 0xffff0000, v197
  v_and_b32 v157, 0xffff0000, v198
  v_and_b32 v159, 0xffff0000, v199
  v_lshlrev_b32 v144, 16, v192
  v_lshlrev_b32 v146, 16, v193
  v_lshlrev_b32 v148, 16, v194
  v_lshlrev_b32 v150, 16, v195
  v_lshlrev_b32 v152, 16, v196
  v_lshlrev_b32 v154, 16, v197
  v_lshlrev_b32 v156, 16, v198
  v_lshlrev_b32 v158, 16, v199
  v_mul_f32 v144, v144, v203
  v_mul_f32 v145, v145, v203
  v_mul_f32 v146, v146, v203
  v_mul_f32 v147, v147, v203
  v_mul_f32 v148, v148, v203
  v_mul_f32 v149, v149, v203
  v_mul_f32 v150, v150, v203
  v_mul_f32 v151, v151, v203
  v_mul_f32 v152, v152, v203
  v_mul_f32 v153, v153, v203
  v_mul_f32 v154, v154, v203
  v_mul_f32 v155, v155, v203
  v_mul_f32 v156, v156, v203
  v_mul_f32 v157, v157, v203
  v_mul_f32 v158, v158, v203
  v_mul_f32 v159, v159, v203
  v_cvt_pk_bf16_f32 v192, v144, v145
  v_cvt_pk_bf16_f32 v193, v146, v147
  v_cvt_pk_bf16_f32 v194, v148, v149
  v_cvt_pk_bf16_f32 v195, v150, v151
  v_cvt_pk_bf16_f32 v196, v152, v153
  v_cvt_pk_bf16_f32 v197, v154, v155
  v_cvt_pk_bf16_f32 v198, v156, v157
  v_cvt_pk_bf16_f32 v199, v158, v159
  buffer_store_dwordx2 v[188:189], v5, s[8:11], s78 offen offset:512 sc1
  buffer_store_dwordx2 v[190:191], v5, s[8:11], s78 offen offset:768 sc1
  buffer_store_dwordx2 v[192:193], v5, s[8:11], s79 offen offset:0 sc1
  buffer_store_dwordx2 v[194:195], v5, s[8:11], s79 offen offset:256 sc1
  buffer_store_dwordx2 v[196:197], v5, s[8:11], s79 offen offset:512 sc1
  buffer_store_dwordx2 v[198:199], v5, s[8:11], s79 offen offset:768 sc1
  s_lshl_b32 s78, s74, 10
  s_add_u32 s78, s78, 24477696
  s_lshl_b32 s79, s73, 5
  s_add_u32 s78, s78, s79
  s_mov_b32 s92, s78
  s_add_u32 s72, s72, 32
  s_cmp_lt_u32 s72, 1024
  s_cbranch_scc1 R1_LOOP
  s_waitcnt vmcnt(0)
  s_mov_b64 exec, 1
  buffer_store_dword v3, v6, s[8:11], s92 offen sc1
  s_mov_b64 exec, -1
  s_mov_b32 s92, 268435456
  s_endpgm
R2_START:
  v_min_u32 v2, 55, v14
  v_lshlrev_b32 v2, 2, v2
R2_LOOP:
  s_lshr_b32 s76, s72, 4
  s_and_b32 s73, s72, 15
  s_lshl_b32 s73, s73, 1
  s_lshl_b32 s74, s75, 6
  s_add_u32 s74, s74, s76
  s_lshl_b32 s78, s74, 9
  s_lshr_b32 s79, s73, 4
  s_lshl_b32 s79, s79, 8
  s_add_u32 s78, s78, s79
  s_add_u32 s78, s78, 24608768
  s_lshl_b32 s80, s74, 5
  s_add_u32 s80, s80, s73
  s_lshl_b32 s80, s80, 10
R2_FS:
  buffer_load_dword v4, v2, s[8:11], s78 offen sc1
  s_waitcnt vmcnt(0)
  s_mov_b64 exec, 1
  buffer_store_dword v3, v6, s[8:11], s92 offen sc1
  s_mov_b64 exec, -1
  s_mov_b32 s92, 268435456
  v_cmp_eq_u32 vcc, 0, v4
  s_nop 0
  s_cbranch_vccz R2_FO
  s_cmp_eq_u32 s19, 0
  s_cbranch_scc1 R2_FO
  s_sub_u32 s19, s19, 1
  s_branch R2_FS
R2_FO:
  s_lshl_b32 s78, s74, 19
  s_add_u32 s78, s78, 43024384
  s_lshl_b32 s79, s73, 10
  s_add_u32 s78, s78, s79
  buffer_load_dwordx4 v[32:35], v1, s[8:11], s78 offen offset:0 sc1
  buffer_load_dwordx4 v[36:39], v1, s[8:11], s78 offen offset:256 sc1
  buffer_load_dwordx4 v[40:43], v1, s[8:11], s78 offen offset:512 sc1
  buffer_load_dwordx4 v[44:47], v1, s[8:11], s78 offen offset:768 sc1
  s_add_u32 s78, s78, 65536
  buffer_load_dwordx4 v[48:51], v1, s[8:11], s78 offen offset:0 sc1
  buffer_load_dwordx4 v[52:55], v1, s[8:11], s78 offen offset:256 sc1
  buffer_load_dwordx4 v[56:59], v1, s[8:11], s78 offen offset:512 sc1
  buffer_load_dwordx4 v[60:63], v1, s[8:11], s78 offen offset:768 sc1
  s_add_u32 s78, s78, 65536
  buffer_load_dwordx4 v[64:67], v1, s[8:11], s78 offen offset:0 sc1
  buffer_load_dwordx4 v[68:71], v1, s[8:11], s78 offen offset:256 sc1
  buffer_load_dwordx4 v[72:75], v1, s[8:11], s78 offen offset:512 sc1
  buffer_load_dwordx4 v[76:79], v1, s[8:11], s78 offen offset:768 sc1
  s_add_u32 s78, s78, 65536
  buffer_load_dwordx4 v[80:83], v1, s[8:11], s78 offen offset:0 sc1
  buffer_load_dwordx4 v[84:87], v1, s[8:11], s78 offen offset:256 sc1
  buffer_load_dwordx4 v[88:91], v1, s[8:11], s78 offen offset:512 sc1
  buffer_load_dwordx4 v[92:95], v1, s[8:11], s78 offen offset:768 sc1
  s_add_u32 s78, s78, 65536
  buffer_load_dwordx4 v[96:99], v1, s[8:11], s78 offen offset:0 sc1
  buffer_load_dwordx4 v[100:103], v1, s[8:11], s78 offen offset:256 sc1
  buffer_load_dwordx4 v[104:107], v1, s[8:11], s78 offen offset:512 sc1
  buffer_load_dwordx4 v[108:111], v1, s[8:11], s78 offen offset:768 sc1
  s_add_u32 s78, s78, 65536
  buffer_load_dwordx4 v[112:115], v1, s[8:11], s78 offen offset:0 sc1
  buffer_load_dwordx4 v[116:119], v1, s[8:11], s78 offen offset:256 sc1
  buffer_load_dwordx4 v[120:123], v1, s[8:11], s78 offen offset:512 sc1
  buffer_load_dwordx4 v[124:127], v1, s[8:11], s78 offen offset:768 sc1
  s_add_u32 s78, s78, 65536
  buffer_load_dwordx4 v[128:131], v1, s[8:11], s78 offen offset:0 sc1
  buffer_load_dwordx4 v[132:135], v1, s[8:11], s78 offen offset:256 sc1
  buffer_load_dwordx4 v[136:139], v1, s[8:11], s78 offen offset:512 sc1
  buffer_load_dwordx4 v[140:143], v1, s[8:11], s78 offen offset:768 sc1
  s_add_u32 s78, s80, 34635776
  buffer_load_dwordx2 v[160:161], v5, s[8:11], s78 offen offset:0 sc1
  buffer_load_dwordx2 v[162:163], v5, s[8:11], s78 offen offset:256 sc1
  buffer_load_dwordx2 v[164:165], v5, s[8:11], s78 offen offset:512 sc1
  buffer_load_dwordx2 v[166:167], v5, s[8:11], s78 offen offset:768 sc1
  s_waitcnt vmcnt(0)
  s_cmp_eq_u32 s75, 0
  s_cbranch_scc1 R2_L1
  s_sub_u32 s78, s80, 2097152
  v_mfma_f32_16x16x32_bf16 v[144:147], v[8:11], v[32:35], 0
  v_and_b32 v169, 0xffff0000, v160
  v_mfma_f32_16x16x32_bf16 v[148:151], v[8:11], v[36:39], 0
  v_and_b32 v171, 0xffff0000, v161
  v_mfma_f32_16x16x32_bf16 v[152:155], v[8:11], v[40:43], 0
  v_and_b32 v173, 0xffff0000, v162
  v_mfma_f32_16x16x32_bf16 v[156:159], v[8:11], v[44:47], 0
  v_and_b32 v175, 0xffff0000, v163
  v_mfma_f32_16x16x32_bf16 v[144:147], v[8:11], v[48:51], v[144:147]
  v_and_b32 v177, 0xffff0000, v164
  v_mfma_f32_16x16x32_bf16 v[148:151], v[8:11], v[52:55], v[148:151]
  v_and_b32 v179, 0xffff0000, v165
  v_mfma_f32_16x16x32_bf16 v[152:155], v[8:11], v[56:59], v[152:155]
  v_and_b32 v181, 0xffff0000, v166
  v_mfma_f32_16x16x32_bf16 v[156:159], v[8:11], v[60:63], v[156:159]
  v_and_b32 v183, 0xffff0000, v167
  v_mfma_f32_16x16x32_bf16 v[144:147], v[8:11], v[64:67], v[144:147]
  v_lshlrev_b32 v168, 16, v160
  v_lshlrev_b32 v170, 16, v161
  v_mfma_f32_16x16x32_bf16 v[148:151], v[8:11], v[68:71], v[148:151]
  v_lshlrev_b32 v172, 16, v162
  v_lshlrev_b32 v174, 16, v163
  v_mfma_f32_16x16x32_bf16 v[152:155], v[8:11], v[72:75], v[152:155]
  v_lshlrev_b32 v176, 16, v164
  v_lshlrev_b32 v178, 16, v165
  v_mfma_f32_16x16x32_bf16 v[156:159], v[8:11], v[76:79], v[156:159]
  v_lshlrev_b32 v180, 16, v166
  v_lshlrev_b32 v182, 16, v167
  v_mfma_f32_16x16x32_bf16 v[144:147], v[8:11], v[80:83], v[144:147]
  v_mfma_f32_16x16x32_bf16 v[148:151], v[8:11], v[84:87], v[148:151]
  v_mfma_f32_16x16x32_bf16 v[152:155], v[8:11], v[88:91], v[152:155]
  v_mfma_f32_16x16x32_bf16 v[156:159], v[8:11], v[92:95], v[156:159]
  v_mfma_f32_16x16x32_bf16 v[144:147], v[8:11], v[96:99], v[144:147]
  v_mfma_f32_16x16x32_bf16 v[148:151], v[8:11], v[100:103], v[148:151]
  v_mfma_f32_16x16x32_bf16 v[152:155], v[8:11], v[104:107], v[152:155]
  v_mfma_f32_16x16x32_bf16 v[156:159], v[8:11], v[108:111], v[156:159]
  v_mfma_f32_16x16x32_bf16 v[144:147], v[8:11], v[112:115], v[144:147]
  v_mfma_f32_16x16x32_bf16 v[148:151], v[8:11], v[116:119], v[148:151]
  v_mfma_f32_16x16x32_bf16 v[152:155], v[8:11], v[120:123], v[152:155]
  v_mfma_f32_16x16x32_bf16 v[156:159], v[8:11], v[124:127], v[156:159]
  v_mfma_f32_16x16x32_bf16 v[144:147], v[8:11], v[128:131], v[144:147]
  v_mfma_f32_16x16x32_bf16 v[148:151], v[8:11], v[132:135], v[148:151]
  v_mfma_f32_16x16x32_bf16 v[152:155], v[8:11], v[136:139], v[152:155]
  v_mfma_f32_16x16x32_bf16 v[156:159], v[8:11], v[140:143], v[156:159]
  s_nop 4
  v_cvt_pk_bf16_f32 v184, v144, v145
  v_cvt_pk_bf16_f32 v185, v146, v147
  v_cvt_pk_bf16_f32 v186, v148, v149
  v_cvt_pk_bf16_f32 v187, v150, v151
  v_and_b32 v145, 0xffff0000, v184
  v_cvt_pk_bf16_f32 v188, v152, v153
  v_cvt_pk_bf16_f32 v189, v154, v155
  v_cvt_pk_bf16_f32 v190, v156, v157
  v_cvt_pk_bf16_f32 v191, v158, v159
  v_and_b32 v147, 0xffff0000, v185
  v_and_b32 v149, 0xffff0000, v186
  v_and_b32 v151, 0xffff0000, v187
  v_and_b32 v153, 0xffff0000, v188
  v_and_b32 v155, 0xffff0000, v189
  v_and_b32 v157, 0xffff0000, v190
  v_and_b32 v159, 0xffff0000, v191
  v_lshlrev_b32 v144, 16, v184
  v_lshlrev_b32 v146, 16, v185
  v_lshlrev_b32 v148, 16, v186
  v_lshlrev_b32 v150, 16, v187
  v_lshlrev_b32 v152, 16, v188
  v_lshlrev_b32 v154, 16, v189
  v_lshlrev_b32 v156, 16, v190
  v_lshlrev_b32 v158, 16, v191
  v_add_f32 v144, v144, v168
  v_add_f32 v145, v145, v169
  v_add_f32 v146, v146, v170
  v_add_f32 v147, v147, v171
  v_add_f32 v148, v148, v172
  v_add_f32 v149, v149, v173
  v_add_f32 v150, v150, v174
  v_add_f32 v151, v151, v175
  v_add_f32 v152, v152, v176
  v_add_f32 v153, v153, v177
  v_add_f32 v154, v154, v178
  v_add_f32 v155, v155, v179
  v_add_f32 v156, v156, v180
  v_add_f32 v157, v157, v181
  v_add_f32 v158, v158, v182
  v_add_f32 v159, v159, v183
  v_cvt_pk_bf16_f32 v184, v144, v145
  v_cvt_pk_bf16_f32 v185, v146, v147
  v_cvt_pk_bf16_f32 v186, v148, v149
  v_cvt_pk_bf16_f32 v187, v150, v151
  v_cvt_pk_bf16_f32 v188, v152, v153
  v_cvt_pk_bf16_f32 v189, v154, v155
  v_cvt_pk_bf16_f32 v190, v156, v157
  v_cvt_pk_bf16_f32 v191, v158, v159
  buffer_store_dwordx2 v[184:185], v5, s[88:91], s78 offen offset:0
  buffer_store_dwordx2 v[186:187], v5, s[88:91], s78 offen offset:256
  buffer_store_dwordx2 v[188:189], v5, s[88:91], s78 offen offset:512
  buffer_store_dwordx2 v[190:191], v5, s[88:91], s78 offen offset:768
  s_branch R2_DN
R2_L1:
  s_add_u32 s78, s80, 32538624
  s_add_u32 s79, s80, 28344320
  v_mfma_f32_16x16x32_bf16 v[144:147], v[8:11], v[32:35], 0
  v_and_b32 v169, 0xffff0000, v160
  v_mfma_f32_16x16x32_bf16 v[148:151], v[8:11], v[36:39], 0
  v_and_b32 v171, 0xffff0000, v161
  v_mfma_f32_16x16x32_bf16 v[152:155], v[8:11], v[40:43], 0
  v_lshlrev_b32 v168, 16, v160
  v_lshlrev_b32 v170, 16, v161
  v_mfma_f32_16x16x32_bf16 v[144:147], v[8:11], v[48:51], v[144:147]
  v_and_b32 v173, 0xffff0000, v162
  v_mfma_f32_16x16x32_bf16 v[148:151], v[8:11], v[52:55], v[148:151]
  v_lshlrev_b32 v172, 16, v162
  v_and_b32 v175, 0xffff0000, v163
  v_mfma_f32_16x16x32_bf16 v[156:159], v[8:11], v[44:47], 0
  v_lshlrev_b32 v174, 16, v163
  v_and_b32 v177, 0xffff0000, v164
  v_mfma_f32_16x16x32_bf16 v[152:155], v[8:11], v[56:59], v[152:155]
  v_lshlrev_b32 v176, 16, v164
  v_and_b32 v179, 0xffff0000, v165
  v_mfma_f32_16x16x32_bf16 v[144:147], v[8:11], v[64:67], v[144:147]
  v_lshlrev_b32 v178, 16, v165
  v_and_b32 v181, 0xffff0000, v166
  v_mfma_f32_16x16x32_bf16 v[148:151], v[8:11], v[68:71], v[148:151]
  v_lshlrev_b32 v180, 16, v166
  v_and_b32 v183, 0xffff0000, v167
  v_mfma_f32_16x16x32_bf16 v[156:159], v[8:11], v[60:63], v[156:159]
  v_lshlrev_b32 v182, 16, v167
  v_mfma_f32_16x16x32_bf16 v[152:155], v[8:11], v[72:75], v[152:155]
  v_mfma_f32_16x16x32_bf16 v[144:147], v[8:11], v[80:83], v[144:147]
  v_mfma_f32_16x16x32_bf16 v[148:151], v[8:11], v[84:87], v[148:151]
  v_mfma_f32_16x16x32_bf16 v[156:159], v[8:11], v[76:79], v[156:159]
  v_mfma_f32_16x16x32_bf16 v[152:155], v[8:11], v[88:91], v[152:155]
  v_mfma_f32_16x16x32_bf16 v[144:147], v[8:11], v[96:99], v[144:147]
  v_mfma_f32_16x16x32_bf16 v[148:151], v[8:11], v[100:103], v[148:151]
  v_mfma_f32_16x16x32_bf16 v[156:159], v[8:11], v[92:95], v[156:159]
  v_mfma_f32_16x16x32_bf16 v[152:155], v[8:11], v[104:107], v[152:155]
  v_mfma_f32_16x16x32_bf16 v[144:147], v[8:11], v[112:115], v[144:147]
  v_mfma_f32_16x16x32_bf16 v[148:151], v[8:11], v[116:119], v[148:151]
  v_mfma_f32_16x16x32_bf16 v[156:159], v[8:11], v[108:111], v[156:159]
  v_mfma_f32_16x16x32_bf16 v[152:155], v[8:11], v[120:123], v[152:155]
  v_mfma_f32_16x16x32_bf16 v[144:147], v[8:11], v[128:131], v[144:147]
  v_mfma_f32_16x16x32_bf16 v[148:151], v[8:11], v[132:135], v[148:151]
  v_mfma_f32_16x16x32_bf16 v[156:159], v[8:11], v[124:127], v[156:159]
  v_mfma_f32_16x16x32_bf16 v[152:155], v[8:11], v[136:139], v[152:155]
  s_nop 4
  v_cvt_pk_bf16_f32 v184, v144, v145
  v_mfma_f32_16x16x32_bf16 v[156:159], v[8:11], v[140:143], v[156:159]
  v_cvt_pk_bf16_f32 v185, v146, v147
  v_cvt_pk_bf16_f32 v186, v148, v149
  v_and_b32 v145, 0xffff0000, v184
  v_and_b32 v147, 0xffff0000, v185
  v_cvt_pk_bf16_f32 v187, v150, v151
  v_lshlrev_b32 v144, 16, v184
  v_lshlrev_b32 v146, 16, v185
  v_and_b32 v149, 0xffff0000, v186
  v_cvt_pk_bf16_f32 v188, v152, v153
  v_lshlrev_b32 v148, 16, v186
  v_add_f32 v144, v144, v168
  v_add_f32 v145, v145, v169
  v_add_f32 v146, v146, v170
  v_add_f32 v147, v147, v171
  v_and_b32 v151, 0xffff0000, v187
  v_cvt_pk_bf16_f32 v189, v154, v155
  v_lshlrev_b32 v150, 16, v187
  v_add_f32 v148, v148, v172
  v_add_f32 v149, v149, v173
  v_cvt_pk_bf16_f32 v184, v144, v145
  v_cvt_pk_bf16_f32 v185, v146, v147
  v_and_b32 v153, 0xffff0000, v188
  v_cvt_pk_bf16_f32 v190, v156, v157
  v_lshlrev_b32 v152, 16, v188
  v_add_f32 v150, v150, v174
  v_add_f32 v151, v151, v175
  v_cvt_pk_bf16_f32 v186, v148, v149
  v_and_b32 v155, 0xffff0000, v189
  v_and_b32 v145, 0xffff0000, v184
  v_and_b32 v147, 0xffff0000, v185
  v_cvt_pk_bf16_f32 v191, v158, v159
  v_lshlrev_b32 v154, 16, v189
  v_add_f32 v152, v152, v176
  v_add_f32 v153, v153, v177
  v_cvt_pk_bf16_f32 v187, v150, v151
  v_lshlrev_b32 v144, 16, v184
  v_lshlrev_b32 v146, 16, v185
  v_and_b32 v157, 0xffff0000, v190
  v_and_b32 v149, 0xffff0000, v186
  v_lshlrev_b32 v156, 16, v190
  v_add_f32 v154, v154, v178
  v_add_f32 v155, v155, v179
  v_cvt_pk_bf16_f32 v188, v152, v153
  v_lshlrev_b32 v148, 16, v186
  v_add_f32 v200, v144, v145
  v_add_f32 v201, v146, v147
  v_and_b32 v159, 0xffff0000, v191
  v_and_b32 v151, 0xffff0000, v187
  v_lshlrev_b32 v158, 16, v191
  v_add_f32 v156, v156, v180
  v_add_f32 v157, v157, v181
  v_cvt_pk_bf16_f32 v189, v154, v155
  v_lshlrev_b32 v150, 16, v187
  v_add_f32 v200, v200, v148
  v_add_f32 v201, v201, v149
  v_and_b32 v153, 0xffff0000, v188
  v_add_f32 v158, v158, v182
  v_add_f32 v159, v159, v183
  v_cvt_pk_bf16_f32 v190, v156, v157
  v_lshlrev_b32 v152, 16, v188
  v_add_f32 v200, v200, v150
  v_add_f32 v201, v201, v151
  v_and_b32 v155, 0xffff0000, v189
  v_cvt_pk_bf16_f32 v191, v158, v159
  v_lshlrev_b32 v154, 16, v189
  v_add_f32 v200, v200, v152
  v_add_f32 v201, v201, v153
  v_and_b32 v157, 0xffff0000, v190
  v_lshlrev_b32 v156, 16, v190
  v_add_f32 v200, v200, v154
  v_add_f32 v201, v201, v155
  v_and_b32 v159, 0xffff0000, v191
  v_lshlrev_b32 v158, 16, v191
  v_add_f32 v200, v200, v156
  v_add_f32 v201, v201, v157
  v_add_f32 v200, v200, v158
  v_add_f32 v201, v201, v159
  v_add_f32 v200, v200, v201
  buffer_store_dwordx2 v[184:185], v5, s[8:11], s78 offen offset:0 sc1
  s_nop 0
  v_add_f32_dpp v200, v200, v200 row_ror:8 row_mask:0xf bank_mask:0xf
  s_nop 1
  v_add_f32_dpp v200, v200, v200 row_ror:4 row_mask:0xf bank_mask:0xf
  s_nop 1
  v_add_f32_dpp v200, v200, v200 row_ror:2 row_mask:0xf bank_mask:0xf
  s_nop 1
  v_add_f32_dpp v200, v200, v200 row_ror:1 row_mask:0xf bank_mask:0xf
  v_mov_b32 v201, v200
  buffer_store_dwordx2 v[186:187], v5, s[8:11], s78 offen offset:256 sc1
  s_nop 0
  v_permlane16_swap_b32 v200, v201
  v_add_f32 v200, v200, v201
  v_mul_f32 v202, 0x3b000000, v200
  v_sub_f32 v168, v144, v202
  v_sub_f32 v169, v145, v202
  v_sub_f32 v170, v146, v202
  v_sub_f32 v171, v147, v202
  v_mul_f32 v203, v168, v168
  v_mul_f32 v201, v169, v169
  v_sub_f32 v172, v148, v202
  v_sub_f32 v173, v149, v202
  v_fmac_f32 v203, v170, v170
  v_fmac_f32 v201, v171, v171
  v_sub_f32 v174, v150, v202
  v_sub_f32 v175, v151, v202
  v_fmac_f32 v203, v172, v172
  v_fmac_f32 v201, v173, v173
  v_sub_f32 v176, v152, v202
  v_sub_f32 v177, v153, v202
  v_fmac_f32 v203, v174, v174
  v_fmac_f32 v201, v175, v175
  v_sub_f32 v178, v154, v202
  v_sub_f32 v179, v155, v202
  v_fmac_f32 v203, v176, v176
  v_fmac_f32 v201, v177, v177
  v_sub_f32 v180, v156, v202
  v_sub_f32 v181, v157, v202
  v_fmac_f32 v203, v178, v178
  v_fmac_f32 v201, v179, v179
  v_sub_f32 v182, v158, v202
  v_sub_f32 v183, v159, v202
  v_fmac_f32 v203, v180, v180
  v_fmac_f32 v201, v181, v181
  v_fmac_f32 v203, v182, v182
  v_fmac_f32 v201, v183, v183
  v_add_f32 v203, v203, v201
  v_cvt_pk_bf16_f32 v202, v202, v202
  s_nop 0
  v_add_f32_dpp v203, v203, v203 row_ror:8 row_mask:0xf bank_mask:0xf
  v_lshlrev_b32 v202, 16, v202
  v_sub_f32 v144, v144, v202
  v_add_f32_dpp v203, v203, v203 row_ror:4 row_mask:0xf bank_mask:0xf
  v_sub_f32 v145, v145, v202
  v_sub_f32 v146, v146, v202
  v_add_f32_dpp v203, v203, v203 row_ror:2 row_mask:0xf bank_mask:0xf
  v_sub_f32 v147, v147, v202
  v_sub_f32 v148, v148, v202
  v_add_f32_dpp v203, v203, v203 row_ror:1 row_mask:0xf bank_mask:0xf
  v_mov_b32 v201, v203
  v_sub_f32 v149, v149, v202
  v_sub_f32 v150, v150, v202
  v_permlane16_swap_b32 v203, v201
  v_add_f32 v203, v203, v201
  v_mul_f32 v203, 0x3b000000, v203
  v_cvt_pk_bf16_f32 v203, v203, v203
  v_lshlrev_b32 v203, 16, v203
  v_add_f32 v203, 0x3727c5ac, v203
  v_cvt_pk_bf16_f32 v203, v203, v203
  v_lshlrev_b32 v203, 16, v203
  v_sqrt_f32 v203, v203
  v_sub_f32 v151, v151, v202
  v_cvt_pk_bf16_f32 v203, v203, v203
  v_lshlrev_b32 v203, 16, v203
  v_sub_f32 v152, v152, v202
  v_sub_f32 v153, v153, v202
  v_sub_f32 v154, v154, v202
  v_sub_f32 v155, v155, v202
  v_sub_f32 v156, v156, v202
  v_sub_f32 v157, v157, v202
  v_sub_f32 v158, v158, v202
  v_sub_f32 v159, v159, v202
  v_rcp_f32 v203, v203
  v_cvt_pk_bf16_f32 v192, v144, v145
  v_cvt_pk_bf16_f32 v193, v146, v147
  v_cvt_pk_bf16_f32 v194, v148, v149
  v_cvt_pk_bf16_f32 v195, v150, v151
  v_cvt_pk_bf16_f32 v196, v152, v153
  v_cvt_pk_bf16_f32 v197, v154, v155
  v_cvt_pk_bf16_f32 v198, v156, v157
  v_cvt_pk_bf16_f32 v199, v158, v159
  v_and_b32 v145, 0xffff0000, v192
  v_and_b32 v147, 0xffff0000, v193
  v_and_b32 v149, 0xffff0000, v194
  v_and_b32 v151, 0xffff0000, v195
  v_and_b32 v153, 0xffff0000, v196
  v_and_b32 v155, 0xffff0000, v197
  v_and_b32 v157, 0xffff0000, v198
  v_and_b32 v159, 0xffff0000, v199
  v_lshlrev_b32 v144, 16, v192
  v_lshlrev_b32 v146, 16, v193
  v_lshlrev_b32 v148, 16, v194
  v_lshlrev_b32 v150, 16, v195
  v_lshlrev_b32 v152, 16, v196
  v_lshlrev_b32 v154, 16, v197
  v_lshlrev_b32 v156, 16, v198
  v_lshlrev_b32 v158, 16, v199
  v_mul_f32 v144, v144, v203
  v_mul_f32 v145, v145, v203
  v_mul_f32 v146, v146, v203
  v_mul_f32 v147, v147, v203
  v_mul_f32 v148, v148, v203
  v_mul_f32 v149, v149, v203
  v_mul_f32 v150, v150, v203
  v_mul_f32 v151, v151, v203
  v_mul_f32 v152, v152, v203
  v_mul_f32 v153, v153, v203
  v_mul_f32 v154, v154, v203
  v_mul_f32 v155, v155, v203
  v_mul_f32 v156, v156, v203
  v_mul_f32 v157, v157, v203
  v_mul_f32 v158, v158, v203
  v_mul_f32 v159, v159, v203
  v_cvt_pk_bf16_f32 v192, v144, v145
  v_cvt_pk_bf16_f32 v193, v146, v147
  v_cvt_pk_bf16_f32 v194, v148, v149
  v_cvt_pk_bf16_f32 v195, v150, v151
  v_cvt_pk_bf16_f32 v196, v152, v153
  v_cvt_pk_bf16_f32 v197, v154, v155
  v_cvt_pk_bf16_f32 v198, v156, v157
  v_cvt_pk_bf16_f32 v199, v158, v159
  buffer_store_dwordx2 v[188:189], v5, s[8:11], s78 offen offset:512 sc1
  buffer_store_dwordx2 v[190:191], v5, s[8:11], s78 offen offset:768 sc1
  buffer_store_dwordx2 v[192:193], v5, s[8:11], s79 offen offset:0 sc1
  buffer_store_dwordx2 v[194:195], v5, s[8:11], s79 offen offset:256 sc1
  buffer_store_dwordx2 v[196:197], v5, s[8:11], s79 offen offset:512 sc1
  buffer_store_dwordx2 v[198:199], v5, s[8:11], s79 offen offset:768 sc1
R2_DN:
  s_add_u32 s78, s74, 64
  s_lshl_b32 s78, s78, 10
  s_add_u32 s78, s78, 24674304
  s_cmp_eq_u32 s75, 0
  s_cselect_b32 s78, s78, 268435456
  s_lshl_b32 s79, s73, 5
  s_add_u32 s78, s78, s79
  s_mov_b32 s92, s78
  s_add_u32 s72, s72, 16
  s_cmp_lt_u32 s72, 1024
  s_cbranch_scc1 R2_LOOP
  s_waitcnt vmcnt(0)
  s_mov_b64 exec, 1
  buffer_store_dword v3, v6, s[8:11], s92 offen sc1
  s_mov_b64 exec, -1
  s_mov_b32 s92, 268435456
  s_endpgm
MAIN_END:
  s_endpgm
VERIFY:
  s_bitcmp1_b32 s95, 1
  s_cbranch_scc0 VERIFY_RET
  s_load_dwordx2 s[48:49], s[0:1], 96
  s_waitcnt vmcnt(0) lgkmcnt(0)
  s_mov_b32 s44, s48
  s_and_b32 s45, s49, 0xffff
  s_mov_b32 s46, 256
  s_mov_b32 s47, 0x20000
  v_mbcnt_lo_u32_b32 v116, -1, 0
  v_mbcnt_hi_u32_b32 v116, -1, v116
  v_lshlrev_b32 v117, 2, v116
  s_add_u32 s48, s3, 1
PRO_SPIN:
  buffer_load_dword v118, v117, s[44:47], 0 offen sc1
  s_waitcnt vmcnt(0)
  v_subrev_u32 v119, 0x01010101, v118
  v_not_b32 v116, v118
  v_and_b32 v119, v119, v116
  v_and_b32 v119, 0x80808080, v119
  v_cmp_ne_u32 vcc, 0, v119
  s_nop 0
  s_cbranch_vccz PRO_ALL
  s_cmp_eq_u32 s19, 0
  s_cbranch_scc1 PRO_ALL
  s_sub_u32 s19, s19, 1
  s_sleep 8
  s_branch PRO_SPIN
PRO_ALL:
  s_mov_b32 s34, 0
  s_mov_b32 s35, 0
  s_mov_b32 s36, 0
  s_mov_b32 s37, 0
  s_mov_b32 s38, 0
  s_mov_b32 s39, 0
  s_mov_b32 s40, 0
  s_mov_b32 s41, 0
  s_mov_b32 s49, 0
  v_bfe_u32 v119, v118, 0, 8
  v_cmp_eq_u32 vcc, 1, v119
  s_nop 0
  s_bcnt1_i32_b64 s50, vcc
  s_add_u32 s34, s34, s50
  v_cmp_eq_u32 vcc, 2, v119
  s_nop 0
  s_bcnt1_i32_b64 s50, vcc
  s_add_u32 s35, s35, s50
  v_cmp_eq_u32 vcc, 3, v119
  s_nop 0
  s_bcnt1_i32_b64 s50, vcc
  s_add_u32 s36, s36, s50
  v_cmp_eq_u32 vcc, 4, v119
  s_nop 0
  s_bcnt1_i32_b64 s50, vcc
  s_add_u32 s37, s37, s50
  v_cmp_eq_u32 vcc, 5, v119
  s_nop 0
  s_bcnt1_i32_b64 s50, vcc
  s_add_u32 s38, s38, s50
  v_cmp_eq_u32 vcc, 6, v119
  s_nop 0
  s_bcnt1_i32_b64 s50, vcc
  s_add_u32 s39, s39, s50
  v_cmp_eq_u32 vcc, 7, v119
  s_nop 0
  s_bcnt1_i32_b64 s50, vcc
  s_add_u32 s40, s40, s50
  v_cmp_eq_u32 vcc, 8, v119
  s_nop 0
  s_bcnt1_i32_b64 s50, vcc
  s_add_u32 s41, s41, s50
  v_add_u32 v116, 0, v117
  v_cmp_gt_u32 s[42:43], s2, v116
  v_cmp_eq_u32 vcc, s48, v119
  s_nop 0
  s_and_b64 vcc, vcc, s[42:43]
  s_bcnt1_i32_b64 s50, vcc
  s_add_u32 s49, s49, s50
  v_bfe_u32 v119, v118, 8, 8
  v_cmp_eq_u32 vcc, 1, v119
  s_nop 0
  s_bcnt1_i32_b64 s50, vcc
  s_add_u32 s34, s34, s50
  v_cmp_eq_u32 vcc, 2, v119
  s_nop 0
  s_bcnt1_i32_b64 s50, vcc
  s_add_u32 s35, s35, s50
  v_cmp_eq_u32 vcc, 3, v119
  s_nop 0
  s_bcnt1_i32_b64 s50, vcc
  s_add_u32 s36, s36, s50
  v_cmp_eq_u32 vcc, 4, v119
  s_nop 0
  s_bcnt1_i32_b64 s50, vcc
  s_add_u32 s37, s37, s50
  v_cmp_eq_u32 vcc, 5, v119
  s_nop 0
  s_bcnt1_i32_b64 s50, vcc
  s_add_u32 s38, s38, s50
  v_cmp_eq_u32 vcc, 6, v119
  s_nop 0
  s_bcnt1_i32_b64 s50, vcc
  s_add_u32 s39, s39, s50
  v_cmp_eq_u32 vcc, 7, v119
  s_nop 0
  s_bcnt1_i32_b64 s50, vcc
  s_add_u32 s40, s40, s50
  v_cmp_eq_u32 vcc, 8, v119
  s_nop 0
  s_bcnt1_i32_b64 s50, vcc
  s_add_u32 s41, s41, s50
  v_add_u32 v116, 1, v117
  v_cmp_gt_u32 s[42:43], s2, v116
  v_cmp_eq_u32 vcc, s48, v119
  s_nop 0
  s_and_b64 vcc, vcc, s[42:43]
  s_bcnt1_i32_b64 s50, vcc
  s_add_u32 s49, s49, s50
  v_bfe_u32 v119, v118, 16, 8
  v_cmp_eq_u32 vcc, 1, v119
  s_nop 0
  s_bcnt1_i32_b64 s50, vcc
  s_add_u32 s34, s34, s50
  v_cmp_eq_u32 vcc, 2, v119
  s_nop 0
  s_bcnt1_i32_b64 s50, vcc
  s_add_u32 s35, s35, s50
  v_cmp_eq_u32 vcc, 3, v119
  s_nop 0
  s_bcnt1_i32_b64 s50, vcc
  s_add_u32 s36, s36, s50
  v_cmp_eq_u32 vcc, 4, v119
  s_nop 0
  s_bcnt1_i32_b64 s50, vcc
  s_add_u32 s37, s37, s50
  v_cmp_eq_u32 vcc, 5, v119
  s_nop 0
  s_bcnt1_i32_b64 s50, vcc
  s_add_u32 s38, s38, s50
  v_cmp_eq_u32 vcc, 6, v119
  s_nop 0
  s_bcnt1_i32_b64 s50, vcc
  s_add_u32 s39, s39, s50
  v_cmp_eq_u32 vcc, 7, v119
  s_nop 0
  s_bcnt1_i32_b64 s50, vcc
  s_add_u32 s40, s40, s50
  v_cmp_eq_u32 vcc, 8, v119
  s_nop 0
  s_bcnt1_i32_b64 s50, vcc
  s_add_u32 s41, s41, s50
  v_add_u32 v116, 2, v117
  v_cmp_gt_u32 s[42:43], s2, v116
  v_cmp_eq_u32 vcc, s48, v119
  s_nop 0
  s_and_b64 vcc, vcc, s[42:43]
  s_bcnt1_i32_b64 s50, vcc
  s_add_u32 s49, s49, s50
  v_bfe_u32 v119, v118, 24, 8
  v_cmp_eq_u32 vcc, 1, v119
  s_nop 0
  s_bcnt1_i32_b64 s50, vcc
  s_add_u32 s34, s34, s50
  v_cmp_eq_u32 vcc, 2, v119
  s_nop 0
  s_bcnt1_i32_b64 s50, vcc
  s_add_u32 s35, s35, s50
  v_cmp_eq_u32 vcc, 3, v119
  s_nop 0
  s_bcnt1_i32_b64 s50, vcc
  s_add_u32 s36, s36, s50
  v_cmp_eq_u32 vcc, 4, v119
  s_nop 0
  s_bcnt1_i32_b64 s50, vcc
  s_add_u32 s37, s37, s50
  v_cmp_eq_u32 vcc, 5, v119
  s_nop 0
  s_bcnt1_i32_b64 s50, vcc
  s_add_u32 s38, s38, s50
  v_cmp_eq_u32 vcc, 6, v119
  s_nop 0
  s_bcnt1_i32_b64 s50, vcc
  s_add_u32 s39, s39, s50
  v_cmp_eq_u32 vcc, 7, v119
  s_nop 0
  s_bcnt1_i32_b64 s50, vcc
  s_add_u32 s40, s40, s50
  v_cmp_eq_u32 vcc, 8, v119
  s_nop 0
  s_bcnt1_i32_b64 s50, vcc
  s_add_u32 s41, s41, s50
  v_add_u32 v116, 3, v117
  v_cmp_gt_u32 s[42:43], s2, v116
  v_cmp_eq_u32 vcc, s48, v119
  s_nop 0
  s_and_b64 vcc, vcc, s[42:43]
  s_bcnt1_i32_b64 s50, vcc
  s_add_u32 s49, s49, s50
  s_mov_b32 s51, 8
  s_mov_b32 s46, 8
  s_cmp_ge_u32 s41, 32
  s_cselect_b32 s46, s51, s46
  s_cselect_b32 s51, 7, s51
  s_cmp_ge_u32 s40, 32
  s_cselect_b32 s46, s51, s46
  s_cselect_b32 s51, 6, s51
  s_cmp_ge_u32 s39, 32
  s_cselect_b32 s46, s51, s46
  s_cselect_b32 s51, 5, s51
  s_cmp_ge_u32 s38, 32
  s_cselect_b32 s46, s51, s46
  s_cselect_b32 s51, 4, s51
  s_cmp_ge_u32 s37, 32
  s_cselect_b32 s46, s51, s46
  s_cselect_b32 s51, 3, s51
  s_cmp_ge_u32 s36, 32
  s_cselect_b32 s46, s51, s46
  s_cselect_b32 s51, 2, s51
  s_cmp_ge_u32 s35, 32
  s_cselect_b32 s46, s51, s46
  s_cselect_b32 s51, 1, s51
  s_cmp_ge_u32 s34, 32
  s_cselect_b32 s46, s51, s46
  s_cselect_b32 s51, 0, s51
  s_mov_b32 s42, 0
  s_cmp_eq_u32 s51, 0
  s_cselect_b32 s43, 32, 0
  s_cmp_eq_u32 s46, 0
  s_cselect_b32 s43, 32, s43
  s_sub_u32 s43, s34, s43
  s_cmp_gt_u32 s3, 0
  s_cselect_b32 s43, s43, 0
  s_add_u32 s42, s42, s43
  s_cmp_eq_u32 s51, 1
  s_cselect_b32 s43, 32, 0
  s_cmp_eq_u32 s46, 1
  s_cselect_b32 s43, 32, s43
  s_sub_u32 s43, s35, s43
  s_cmp_gt_u32 s3, 1
  s_cselect_b32 s43, s43, 0
  s_add_u32 s42, s42, s43
  s_cmp_eq_u32 s51, 2
  s_cselect_b32 s43, 32, 0
  s_cmp_eq_u32 s46, 2
  s_cselect_b32 s43, 32, s43
  s_sub_u32 s43, s36, s43
  s_cmp_gt_u32 s3, 2
  s_cselect_b32 s43, s43, 0
  s_add_u32 s42, s42, s43
  s_cmp_eq_u32 s51, 3
  s_cselect_b32 s43, 32, 0
  s_cmp_eq_u32 s46, 3
  s_cselect_b32 s43, 32, s43
  s_sub_u32 s43, s37, s43
  s_cmp_gt_u32 s3, 3
  s_cselect_b32 s43, s43, 0
  s_add_u32 s42, s42, s43
  s_cmp_eq_u32 s51, 4
  s_cselect_b32 s43, 32, 0
  s_cmp_eq_u32 s46, 4
  s_cselect_b32 s43, 32, s43
  s_sub_u32 s43, s38, s43
  s_cmp_gt_u32 s3, 4
  s_cselect_b32 s43, s43, 0
  s_add_u32 s42, s42, s43
  s_cmp_eq_u32 s51, 5
  s_cselect_b32 s43, 32, 0
  s_cmp_eq_u32 s46, 5
  s_cselect_b32 s43, 32, s43
  s_sub_u32 s43, s39, s43
  s_cmp_gt_u32 s3, 5
  s_cselect_b32 s43, s43, 0
  s_add_u32 s42, s42, s43
  s_cmp_eq_u32 s51, 6
  s_cselect_b32 s43, 32, 0
  s_cmp_eq_u32 s46, 6
  s_cselect_b32 s43, 32, s43
  s_sub_u32 s43, s40, s43
  s_cmp_gt_u32 s3, 6
  s_cselect_b32 s43, s43, 0
  s_add_u32 s42, s42, s43
  s_cmp_eq_u32 s51, 7
  s_cselect_b32 s43, 32, 0
  s_cmp_eq_u32 s46, 7
  s_cselect_b32 s43, 32, s43
  s_sub_u32 s43, s41, s43
  s_cmp_gt_u32 s3, 7
  s_cselect_b32 s43, s43, 0
  s_add_u32 s42, s42, s43
  s_cmp_eq_u32 s3, s51
  s_cselect_b32 s43, 1, 0
  s_cmp_eq_u32 s3, s46
  s_cselect_b32 s47, 1, 0
  s_or_b32 s43, s43, s47
  s_cmp_lt_u32 s49, 32
  s_cselect_b32 s44, 1, 0
  s_and_b32 s44, s44, s43
  s_lshl_b32 s43, s43, 5
  s_sub_u32 s45, s49, s43
  s_add_u32 s45, s45, s42
  s_add_u32 s45, s45, 64
  s_lshl_b32 s47, s47, 5
  s_add_u32 s47, s47, s49
  s_cmp_lg_u32 s44, 0
  s_cselect_b32 s45, s47, s45
  s_mov_b32 s43, 1
  s_cmp_eq_u32 s34, 32
  s_cselect_b32 s43, s43, 0
  s_cmp_eq_u32 s35, 32
  s_cselect_b32 s43, s43, 0
  s_cmp_eq_u32 s36, 32
  s_cselect_b32 s43, s43, 0
  s_cmp_eq_u32 s37, 32
  s_cselect_b32 s43, s43, 0
  s_cmp_eq_u32 s38, 32
  s_cselect_b32 s43, s43, 0
  s_cmp_eq_u32 s39, 32
  s_cselect_b32 s43, s43, 0
  s_cmp_eq_u32 s40, 32
  s_cselect_b32 s43, s43, 0
  s_cmp_eq_u32 s41, 32
  s_cselect_b32 s43, s43, 0
  s_cmp_eq_u32 s45, s94
  s_cselect_b32 s44, s43, 0
  s_mov_b32 s94, s45
  s_mov_b32 s95, s43
  v_mbcnt_lo_u32_b32 v116, -1, 0
  v_mbcnt_hi_u32_b32 v116, -1, v116
  s_lshl_b32 s48, s16, 6
  v_add_u32 v116, s48, v116
  s_cmp_eq_u32 s44, 1
  s_setpc_b64 s[100:101]
VERIFY_RET:
  s_cmp_eq_u32 s3, s3
  s_setpc_b64 s[100:101]
TEXT_END:
.section .rodata,"a"
.p2align 6
.amdhsa_kernel interleave_layers__memory_aug_recurrent_mem_tr__swiglu_ffn__prompt_kernel
  .amdhsa_next_free_vgpr 512
  .amdhsa_next_free_sgpr 102
  .amdhsa_accum_offset 256
  .amdhsa_group_segment_fixed_size 0
  .amdhsa_kernarg_size 112
  .amdhsa_user_sgpr_count 2
  .amdhsa_user_sgpr_kernarg_segment_ptr 1
  .amdhsa_system_sgpr_workgroup_id_x 1
  .amdhsa_float_denorm_mode_32 3
  .amdhsa_float_denorm_mode_16_64 3
.end_amdhsa_kernel
```
